```python
import torch

def _softmax(x, axis=-1):
    return torch.softmax(x, dim=axis)

def _gelu(x):
    return torch.nn.functional.gelu(x, approximate='tanh')

def _silu(x):
    return torch.nn.functional.silu(x)

def _sigmoid(x):
    return torch.sigmoid(x)

def _layernorm(x, axis=-1, eps=1e-05):
    m = x.mean(dim=axis, keepdim=True)
    v = x.var(dim=axis, keepdim=True, unbiased=False)
    return (x - m) / torch.sqrt(v + eps)

def _scatter_add(tgt, idx, src, axis=0):
    return tgt.clone().index_add_(axis, idx, src)

def _segment_sum(src, seg, n):
    out = torch.zeros((n,) + src.shape[1:], dtype=src.dtype)
    return out.index_add_(0, seg, src)

def _pad(x, pw):
    flat = tuple((v for pair in reversed(pw) for v in pair))
    return torch.nn.functional.pad(x, flat)
kernel_name = 'interleave_layers__memory_aug_recurrent_mem_tr__dense_activation_gelu__prompt'

def setup_inputs():

    _w = lambda a: (lambda t: t.to(torch.bfloat16) if t.is_floating_point() else t)(torch.as_tensor(a))

    def _A_setup():
        B, S, Dm = (1, 2048, 576)
        H, Dh = (32, 128)
        M, seg = (8, 32)
        seg = min(seg, S)
        S = S // seg * seg
        return {'x': _w((lambda *s: torch.randn(*s, dtype=torch.bfloat16) * 0.05)(B, S, Dm)), 'mem0': _w((lambda *s: torch.randn(*s, dtype=torch.bfloat16) * 0.2)(B, M, Dm)), 'Wq': _w((lambda *s: torch.randn(*s, dtype=torch.bfloat16) * 1.6)(Dm, H, Dh) * Dm ** (-0.5)), 'Wk': _w((lambda *s: torch.randn(*s, dtype=torch.bfloat16) * 1.6)(Dm, H, Dh) * Dm ** (-0.5)), 'Wv': _w((lambda *s: torch.randn(*s, dtype=torch.bfloat16) * 0.2)(Dm, H, Dh) * Dm ** (-0.5)), 'Wo': _w((lambda *s: torch.randn(*s, dtype=torch.bfloat16) * 0.2)(H, Dh, Dm) * (H * Dh) ** (-0.5)), 'seg_len': seg}
    _A_in = _A_setup()

    def _B_setup():
        B, S, D, F = (1, 2048, 576, 4608)
        return {'x': _w((lambda *s: torch.randn(*s, dtype=torch.bfloat16) * 0.05)(B, S, D)), 'w1': _w((lambda *s: torch.randn(*s, dtype=torch.bfloat16) * 0.4)(D, F) * D ** (-0.5)), 'b1': _w((lambda *s: torch.randn(*s, dtype=torch.bfloat16) * 12.8)(F) * 0.01), 'w2': _w((lambda *s: torch.randn(*s, dtype=torch.bfloat16) * 0.1)(F, D) * F ** (-0.5)), 'b2': _w((lambda *s: torch.randn(*s, dtype=torch.bfloat16) * 0.8)(D) * 0.01)}
    _B_in = _B_setup()
    return {'A_x': _A_in['x'], 'A_mem0': _A_in['mem0'], 'A_Wq': _A_in['Wq'], 'A_Wk': _A_in['Wk'], 'A_Wv': _A_in['Wv'], 'A_Wo': _A_in['Wo'], 'A_seg_len': _A_in['seg_len'], 'B_x': _B_in['x'], 'B_w1': _B_in['w1'], 'B_b1': _B_in['b1'], 'B_w2': _B_in['w2'], 'B_b2': _B_in['b2']}

def reference(A_x, A_mem0, A_Wq, A_Wk, A_Wv, A_Wo, A_seg_len, B_x, B_w1, B_b1, B_w2, B_b2):

    def _A_ref(x, mem0, Wq, Wk, Wv, Wo, seg_len):
        B, S, Dm = x.shape
        H, Dh = (Wq.shape[1], Wq.shape[2])
        M = mem0.shape[1]
        scale = Dh ** (-0.5)
        n_seg = S // seg_len
        L = M + seg_len
        idx = torch.arange(L)
        mask = (idx[:, None] < M) | (idx[:, None] >= idx[None, :])
        mem = mem0
        outs = []
        for s in range(n_seg):
            xs = x[:, s * seg_len:(s + 1) * seg_len, :].clone()
            h = torch.concatenate([mem, xs], axis=1)
            q = torch.einsum('btd,dhe->bhte', h, Wq)
            k = torch.einsum('btd,dhe->bhte', h, Wk)
            v = torch.einsum('btd,dhe->bhte', h, Wv)
            scores = torch.einsum('bhqe,bhke->bhqk', q, k) * scale
            scores = torch.where(mask[None, None], scores, -1000000000.0)
            p = _softmax(scores, axis=-1)
            o = torch.einsum('bhqk,bhke->bhqe', p, v)
            o = torch.einsum('bhte,hed->btd', o, Wo)
            mem = o[:, :M, :].clone()
            outs.append(o[:, M:, :])
        return torch.concatenate(outs, axis=1)

    def _B_ref(x, w1, b1, w2, b2):
        h = torch.einsum('bsd,df->bsf', x, w1) + b1
        h = _gelu(h)
        return torch.einsum('bsf,fd->bsd', h, w2) + b2
    x = A_x
    x = x + _A_ref(_layernorm(x, axis=-1), A_mem0, A_Wq, A_Wk, A_Wv, A_Wo, A_seg_len)
    x = x + _B_ref(_layernorm(x, axis=-1), B_w1, B_b1, B_w2, B_b2)
    x = x + _A_ref(_layernorm(x, axis=-1), A_mem0, A_Wq, A_Wk, A_Wv, A_Wo, A_seg_len)
    x = x + _B_ref(_layernorm(x, axis=-1), B_w1, B_b1, B_w2, B_b2)
    return x
```

```asm
; @launch grid=(256,1,1) block=(256,1,1) lds=163840
.amdgcn_target "amdgcn-amd-amdhsa--gfx950"
.text
.globl interleave_layers__memory_aug_recurrent_mem_tr__dense_activation_gelu__prompt_kernel
.p2align 8
.type interleave_layers__memory_aug_recurrent_mem_tr__dense_activation_gelu__prompt_kernel,@function
interleave_layers__memory_aug_recurrent_mem_tr__dense_activation_gelu__prompt_kernel:
s_cmp_ge_u32 s2, 256
s_cbranch_scc1 L_end
s_load_dwordx16 s[64:79], s[0:1], 0
s_load_dwordx8 s[80:87], s[0:1], 64
s_load_dwordx4 s[88:91], s[0:1], 96
s_load_dwordx2 s[92:93], s[0:1], 112
v_lshrrev_b32 v1, 6, v0
v_and_b32 v0, 63, v0
v_readfirstlane_b32 s35, v1
s_getreg_b32 s3, hwreg(HW_REG_XCC_ID)
s_mov_b32 s37, 60000
s_waitcnt lgkmcnt(0)
s_and_b32 s1, s2, 7
s_mov_b32 s0, 0
L_restart:
s_and_b32 s3, s3, 7
s_lshl_b32 s3, s3, 2
s_lshr_b32 s3, 0x36521470, s3
s_and_b32 s3, s3, 7
s_andn2_b32 s2, s2, 7
s_or_b32 s2, s2, s3
s_and_b32 s32, s2, 3
s_bfe_u32 s33, s2, 0x10002
s_lshr_b32 s34, s2, 3
s_mov_b32 s4, s92
s_and_b32 s5, s93, 0xffff
s_mov_b32 s6, 268435456
s_mov_b32 s7, 0x20000
s_mov_b32 s24, s90
s_and_b32 s25, s91, 0xffff
s_mov_b32 s26, 256
s_mov_b32 s27, 0x20000
s_mov_b32 s28, s64
s_and_b32 s29, s65, 0xffff
s_mov_b32 s30, 2359296
s_mov_b32 s31, 0x20000
s_mov_b32 s8, s92
s_and_b32 s9, s93, 0xffff
s_mov_b32 s10, 268435456
s_mov_b32 s11, 0x20000
s_mov_b32 s12, s92
s_and_b32 s13, s93, 0xffff
s_mov_b32 s14, 268435456
s_mov_b32 s15, 0x20000
s_mov_b32 s16, s92
s_and_b32 s17, s93, 0xffff
s_mov_b32 s18, 268435456
s_mov_b32 s19, 0x20000
s_mov_b32 s20, s92
s_and_b32 s21, s93, 0xffff
s_mov_b32 s22, 268435456
s_mov_b32 s23, 0x20000
s_cmp_eq_u32 s33, 0
s_cbranch_scc1 L_census
s_lshl_b32 s40, s32, 5
s_add_u32 s40, s40, s34
v_lshrrev_b32 v2, 4, v0
v_and_b32 v3, 15, v0
s_lshl_b32 s41, s40, 2
s_add_u32 s41, s41, s35
s_mul_i32 s41, s41, 4608
v_mul_u32_u24 v4, 1152, v2
v_lshl_add_u32 v5, v3, 4, v4
v_lshl_add_u32 v6, v3, 3, v4
buffer_load_dwordx4 v[8:11], v5, s[28:31], s41 offen offset:0
buffer_load_dwordx4 v[12:15], v5, s[28:31], s41 offen offset:256
buffer_load_dwordx4 v[16:19], v5, s[28:31], s41 offen offset:512
buffer_load_dwordx4 v[20:23], v5, s[28:31], s41 offen offset:768
buffer_load_dwordx2 v[24:25], v6, s[28:31], s41 offen offset:1024
v_lshl_add_u32 v7, s35, 6, v0
s_lshl_b32 s42, s40, 13
v_lshlrev_b32 v28, 4, v7
v_mov_b32 v32, 0
v_mov_b32 v33, 0
v_mov_b32 v34, 0
v_mov_b32 v35, 0
buffer_store_dwordx4 v[32:35], v28, s[4:7], s42 offen sc1
s_add_u32 s42, s42, 4096
buffer_store_dwordx4 v[32:35], v28, s[4:7], s42 offen sc1
s_lshl_b32 s42, s40, 10
s_add_u32 s42, s42, 1048576
v_lshlrev_b32 v28, 2, v7
v_mov_b32 v29, -1
buffer_store_dword v29, v28, s[4:7], s42 offen sc1
s_waitcnt vmcnt(7)
v_lshlrev_b32 v40, 16, v8
v_and_b32 v41, 0xffff0000, v8
v_lshlrev_b32 v42, 16, v9
v_and_b32 v43, 0xffff0000, v9
v_lshlrev_b32 v44, 16, v10
v_and_b32 v45, 0xffff0000, v10
v_lshlrev_b32 v46, 16, v11
v_and_b32 v47, 0xffff0000, v11
s_waitcnt vmcnt(6)
v_lshlrev_b32 v48, 16, v12
v_and_b32 v49, 0xffff0000, v12
v_lshlrev_b32 v50, 16, v13
v_and_b32 v51, 0xffff0000, v13
v_lshlrev_b32 v52, 16, v14
v_and_b32 v53, 0xffff0000, v14
v_lshlrev_b32 v54, 16, v15
v_and_b32 v55, 0xffff0000, v15
s_waitcnt vmcnt(5)
v_lshlrev_b32 v56, 16, v16
v_and_b32 v57, 0xffff0000, v16
v_lshlrev_b32 v58, 16, v17
v_and_b32 v59, 0xffff0000, v17
v_lshlrev_b32 v60, 16, v18
v_and_b32 v61, 0xffff0000, v18
v_lshlrev_b32 v62, 16, v19
v_and_b32 v63, 0xffff0000, v19
s_waitcnt vmcnt(4)
v_lshlrev_b32 v64, 16, v20
v_and_b32 v65, 0xffff0000, v20
v_lshlrev_b32 v66, 16, v21
v_and_b32 v67, 0xffff0000, v21
v_lshlrev_b32 v68, 16, v22
v_and_b32 v69, 0xffff0000, v22
v_lshlrev_b32 v70, 16, v23
v_and_b32 v71, 0xffff0000, v23
s_waitcnt vmcnt(3)
v_lshlrev_b32 v72, 16, v24
v_and_b32 v73, 0xffff0000, v24
v_lshlrev_b32 v74, 16, v25
v_and_b32 v75, 0xffff0000, v25
v_add_f32 v30, v40, v41
v_add_f32 v30, v30, v42
v_add_f32 v30, v30, v43
v_add_f32 v30, v30, v44
v_add_f32 v30, v30, v45
v_add_f32 v30, v30, v46
v_add_f32 v30, v30, v47
v_add_f32 v30, v30, v48
v_add_f32 v30, v30, v49
v_add_f32 v30, v30, v50
v_add_f32 v30, v30, v51
v_add_f32 v30, v30, v52
v_add_f32 v30, v30, v53
v_add_f32 v30, v30, v54
v_add_f32 v30, v30, v55
v_add_f32 v30, v30, v56
v_add_f32 v30, v30, v57
v_add_f32 v30, v30, v58
v_add_f32 v30, v30, v59
v_add_f32 v30, v30, v60
v_add_f32 v30, v30, v61
v_add_f32 v30, v30, v62
v_add_f32 v30, v30, v63
v_add_f32 v30, v30, v64
v_add_f32 v30, v30, v65
v_add_f32 v30, v30, v66
v_add_f32 v30, v30, v67
v_add_f32 v30, v30, v68
v_add_f32 v30, v30, v69
v_add_f32 v30, v30, v70
v_add_f32 v30, v30, v71
v_add_f32 v30, v30, v72
v_add_f32 v30, v30, v73
v_add_f32 v30, v30, v74
v_add_f32 v30, v30, v75
s_nop 1
v_add_f32_dpp v30, v30, v30 row_ror:8 row_mask:0xf bank_mask:0xf
s_nop 1
v_add_f32_dpp v30, v30, v30 row_ror:4 row_mask:0xf bank_mask:0xf
s_nop 1
v_add_f32_dpp v30, v30, v30 row_ror:2 row_mask:0xf bank_mask:0xf
s_nop 1
v_add_f32_dpp v30, v30, v30 row_ror:1 row_mask:0xf bank_mask:0xf
v_mul_f32 v30, 0x3ae38e39, v30
v_mov_b32 v31, 0
v_sub_f32 v36, v40, v30
v_fmac_f32 v31, v36, v36
v_sub_f32 v36, v41, v30
v_fmac_f32 v31, v36, v36
v_sub_f32 v36, v42, v30
v_fmac_f32 v31, v36, v36
v_sub_f32 v36, v43, v30
v_fmac_f32 v31, v36, v36
v_sub_f32 v36, v44, v30
v_fmac_f32 v31, v36, v36
v_sub_f32 v36, v45, v30
v_fmac_f32 v31, v36, v36
v_sub_f32 v36, v46, v30
v_fmac_f32 v31, v36, v36
v_sub_f32 v36, v47, v30
v_fmac_f32 v31, v36, v36
v_sub_f32 v36, v48, v30
v_fmac_f32 v31, v36, v36
v_sub_f32 v36, v49, v30
v_fmac_f32 v31, v36, v36
v_sub_f32 v36, v50, v30
v_fmac_f32 v31, v36, v36
v_sub_f32 v36, v51, v30
v_fmac_f32 v31, v36, v36
v_sub_f32 v36, v52, v30
v_fmac_f32 v31, v36, v36
v_sub_f32 v36, v53, v30
v_fmac_f32 v31, v36, v36
v_sub_f32 v36, v54, v30
v_fmac_f32 v31, v36, v36
v_sub_f32 v36, v55, v30
v_fmac_f32 v31, v36, v36
v_sub_f32 v36, v56, v30
v_fmac_f32 v31, v36, v36
v_sub_f32 v36, v57, v30
v_fmac_f32 v31, v36, v36
v_sub_f32 v36, v58, v30
v_fmac_f32 v31, v36, v36
v_sub_f32 v36, v59, v30
v_fmac_f32 v31, v36, v36
v_sub_f32 v36, v60, v30
v_fmac_f32 v31, v36, v36
v_sub_f32 v36, v61, v30
v_fmac_f32 v31, v36, v36
v_sub_f32 v36, v62, v30
v_fmac_f32 v31, v36, v36
v_sub_f32 v36, v63, v30
v_fmac_f32 v31, v36, v36
v_sub_f32 v36, v64, v30
v_fmac_f32 v31, v36, v36
v_sub_f32 v36, v65, v30
v_fmac_f32 v31, v36, v36
v_sub_f32 v36, v66, v30
v_fmac_f32 v31, v36, v36
v_sub_f32 v36, v67, v30
v_fmac_f32 v31, v36, v36
v_sub_f32 v36, v68, v30
v_fmac_f32 v31, v36, v36
v_sub_f32 v36, v69, v30
v_fmac_f32 v31, v36, v36
v_sub_f32 v36, v70, v30
v_fmac_f32 v31, v36, v36
v_sub_f32 v36, v71, v30
v_fmac_f32 v31, v36, v36
v_sub_f32 v36, v72, v30
v_fmac_f32 v31, v36, v36
v_sub_f32 v36, v73, v30
v_fmac_f32 v31, v36, v36
v_sub_f32 v36, v74, v30
v_fmac_f32 v31, v36, v36
v_sub_f32 v36, v75, v30
v_fmac_f32 v31, v36, v36
s_nop 1
v_add_f32_dpp v31, v31, v31 row_ror:8 row_mask:0xf bank_mask:0xf
s_nop 1
v_add_f32_dpp v31, v31, v31 row_ror:4 row_mask:0xf bank_mask:0xf
s_nop 1
v_add_f32_dpp v31, v31, v31 row_ror:2 row_mask:0xf bank_mask:0xf
s_nop 1
v_add_f32_dpp v31, v31, v31 row_ror:1 row_mask:0xf bank_mask:0xf
v_mul_f32 v31, 0x3ae38e39, v31
v_cvt_pk_bf16_f32 v30, v30, v31
v_and_b32 v31, 0xffff0000, v30
v_lshlrev_b32 v30, 16, v30
v_add_f32 v31, 0x3727c5ac, v31
v_cvt_pk_bf16_f32 v31, v31, v31
v_and_b32 v31, 0xffff0000, v31
v_sqrt_f32 v31, v31
s_nop 0
v_cvt_pk_bf16_f32 v31, v31, v31
v_and_b32 v31, 0xffff0000, v31
v_rcp_f32 v31, v31
v_sub_f32 v40, v40, v30
v_sub_f32 v41, v41, v30
v_cvt_pk_bf16_f32 v41, v40, v41
v_lshlrev_b32 v40, 16, v41
v_and_b32 v41, 0xffff0000, v41
v_mul_f32 v40, v40, v31
v_mul_f32 v41, v41, v31
v_cvt_pk_bf16_f32 v8, v40, v41
v_sub_f32 v42, v42, v30
v_sub_f32 v43, v43, v30
v_cvt_pk_bf16_f32 v43, v42, v43
v_lshlrev_b32 v42, 16, v43
v_and_b32 v43, 0xffff0000, v43
v_mul_f32 v42, v42, v31
v_mul_f32 v43, v43, v31
v_cvt_pk_bf16_f32 v9, v42, v43
v_sub_f32 v44, v44, v30
v_sub_f32 v45, v45, v30
v_cvt_pk_bf16_f32 v45, v44, v45
v_lshlrev_b32 v44, 16, v45
v_and_b32 v45, 0xffff0000, v45
v_mul_f32 v44, v44, v31
v_mul_f32 v45, v45, v31
v_cvt_pk_bf16_f32 v10, v44, v45
v_sub_f32 v46, v46, v30
v_sub_f32 v47, v47, v30
v_cvt_pk_bf16_f32 v47, v46, v47
v_lshlrev_b32 v46, 16, v47
v_and_b32 v47, 0xffff0000, v47
v_mul_f32 v46, v46, v31
v_mul_f32 v47, v47, v31
v_cvt_pk_bf16_f32 v11, v46, v47
v_sub_f32 v48, v48, v30
v_sub_f32 v49, v49, v30
v_cvt_pk_bf16_f32 v49, v48, v49
v_lshlrev_b32 v48, 16, v49
v_and_b32 v49, 0xffff0000, v49
v_mul_f32 v48, v48, v31
v_mul_f32 v49, v49, v31
v_cvt_pk_bf16_f32 v12, v48, v49
v_sub_f32 v50, v50, v30
v_sub_f32 v51, v51, v30
v_cvt_pk_bf16_f32 v51, v50, v51
v_lshlrev_b32 v50, 16, v51
v_and_b32 v51, 0xffff0000, v51
v_mul_f32 v50, v50, v31
v_mul_f32 v51, v51, v31
v_cvt_pk_bf16_f32 v13, v50, v51
v_sub_f32 v52, v52, v30
v_sub_f32 v53, v53, v30
v_cvt_pk_bf16_f32 v53, v52, v53
v_lshlrev_b32 v52, 16, v53
v_and_b32 v53, 0xffff0000, v53
v_mul_f32 v52, v52, v31
v_mul_f32 v53, v53, v31
v_cvt_pk_bf16_f32 v14, v52, v53
v_sub_f32 v54, v54, v30
v_sub_f32 v55, v55, v30
v_cvt_pk_bf16_f32 v55, v54, v55
v_lshlrev_b32 v54, 16, v55
v_and_b32 v55, 0xffff0000, v55
v_mul_f32 v54, v54, v31
v_mul_f32 v55, v55, v31
v_cvt_pk_bf16_f32 v15, v54, v55
v_sub_f32 v56, v56, v30
v_sub_f32 v57, v57, v30
v_cvt_pk_bf16_f32 v57, v56, v57
v_lshlrev_b32 v56, 16, v57
v_and_b32 v57, 0xffff0000, v57
v_mul_f32 v56, v56, v31
v_mul_f32 v57, v57, v31
v_cvt_pk_bf16_f32 v16, v56, v57
v_sub_f32 v58, v58, v30
v_sub_f32 v59, v59, v30
v_cvt_pk_bf16_f32 v59, v58, v59
v_lshlrev_b32 v58, 16, v59
v_and_b32 v59, 0xffff0000, v59
v_mul_f32 v58, v58, v31
v_mul_f32 v59, v59, v31
v_cvt_pk_bf16_f32 v17, v58, v59
v_sub_f32 v60, v60, v30
v_sub_f32 v61, v61, v30
v_cvt_pk_bf16_f32 v61, v60, v61
v_lshlrev_b32 v60, 16, v61
v_and_b32 v61, 0xffff0000, v61
v_mul_f32 v60, v60, v31
v_mul_f32 v61, v61, v31
v_cvt_pk_bf16_f32 v18, v60, v61
v_sub_f32 v62, v62, v30
v_sub_f32 v63, v63, v30
v_cvt_pk_bf16_f32 v63, v62, v63
v_lshlrev_b32 v62, 16, v63
v_and_b32 v63, 0xffff0000, v63
v_mul_f32 v62, v62, v31
v_mul_f32 v63, v63, v31
v_cvt_pk_bf16_f32 v19, v62, v63
v_sub_f32 v64, v64, v30
v_sub_f32 v65, v65, v30
v_cvt_pk_bf16_f32 v65, v64, v65
v_lshlrev_b32 v64, 16, v65
v_and_b32 v65, 0xffff0000, v65
v_mul_f32 v64, v64, v31
v_mul_f32 v65, v65, v31
v_cvt_pk_bf16_f32 v20, v64, v65
v_sub_f32 v66, v66, v30
v_sub_f32 v67, v67, v30
v_cvt_pk_bf16_f32 v67, v66, v67
v_lshlrev_b32 v66, 16, v67
v_and_b32 v67, 0xffff0000, v67
v_mul_f32 v66, v66, v31
v_mul_f32 v67, v67, v31
v_cvt_pk_bf16_f32 v21, v66, v67
v_sub_f32 v68, v68, v30
v_sub_f32 v69, v69, v30
v_cvt_pk_bf16_f32 v69, v68, v69
v_lshlrev_b32 v68, 16, v69
v_and_b32 v69, 0xffff0000, v69
v_mul_f32 v68, v68, v31
v_mul_f32 v69, v69, v31
v_cvt_pk_bf16_f32 v22, v68, v69
v_sub_f32 v70, v70, v30
v_sub_f32 v71, v71, v30
v_cvt_pk_bf16_f32 v71, v70, v71
v_lshlrev_b32 v70, 16, v71
v_and_b32 v71, 0xffff0000, v71
v_mul_f32 v70, v70, v31
v_mul_f32 v71, v71, v31
v_cvt_pk_bf16_f32 v23, v70, v71
v_sub_f32 v72, v72, v30
v_sub_f32 v73, v73, v30
v_cvt_pk_bf16_f32 v73, v72, v73
v_lshlrev_b32 v72, 16, v73
v_and_b32 v73, 0xffff0000, v73
v_mul_f32 v72, v72, v31
v_mul_f32 v73, v73, v31
v_cvt_pk_bf16_f32 v24, v72, v73
v_sub_f32 v74, v74, v30
v_sub_f32 v75, v75, v30
v_cvt_pk_bf16_f32 v75, v74, v75
v_lshlrev_b32 v74, 16, v75
v_and_b32 v75, 0xffff0000, v75
v_mul_f32 v74, v74, v31
v_mul_f32 v75, v75, v31
v_cvt_pk_bf16_f32 v25, v74, v75
s_add_u32 s41, s41, 2097152
buffer_store_dwordx4 v[8:11], v5, s[4:7], s41 offen offset:0 sc1
buffer_store_dwordx4 v[12:15], v5, s[4:7], s41 offen offset:256 sc1
buffer_store_dwordx4 v[16:19], v5, s[4:7], s41 offen offset:512 sc1
buffer_store_dwordx4 v[20:23], v5, s[4:7], s41 offen offset:768 sc1
buffer_store_dwordx2 v[24:25], v6, s[4:7], s41 offen offset:1024 sc1
s_waitcnt vmcnt(0)
s_barrier
L_census:
s_cmp_lg_u32 s35, 0
s_cbranch_scc1 L_dispatch
s_getreg_b32 s40, hwreg(HW_REG_XCC_ID)
s_and_b32 s40, s40, 7
s_lshl_b32 s40, s40, 3
s_lshl_b64 s[42:43], 1, s40
s_lshl_b32 s41, s1, 3
v_mov_b32 v2, s42
v_mov_b32 v3, s43
v_mov_b32 v4, s41
s_mov_b64 exec, 1
buffer_atomic_add_x2 v[2:3], v4, s[24:27], s0 offen
s_mov_b64 exec, -1
L_dispatch:
s_cmp_eq_u32 s33, 0
s_cbranch_scc1 L_go
v_lshl_add_u32 v8, s35, 6, v0
v_lshlrev_b32 v8, 20, v8
buffer_load_dword v10, v8, s[4:7], 0 offen
buffer_load_dword v10, v8, s[16:19], 0 offen
v_and_b32 v8, 7, v0
v_lshlrev_b32 v8, 3, v8
L_e_cen1:
buffer_load_dwordx2 v[10:11], v8, s[24:27], s0 offen sc1
s_waitcnt vmcnt(0)
v_sad_u8 v9, v10, 0, 0
v_sad_u8 v9, v11, 0, v9
v_cmp_ne_u32 vcc, 32, v9
s_nop 0
s_cbranch_vccz L_e_cend2
s_sleep 16
s_sub_u32 s37, s37, 1
s_cbranch_scc0 L_e_cen1
s_movk_i32 s39, 5
s_branch L_bail
L_e_cend2:
v_bcnt_u32_b32 v9, v10, 0
v_bcnt_u32_b32 v9, v11, v9
v_cmp_ne_u32 vcc, 1, v9
v_readlane_b32 s41, v9, s1
s_cbranch_vccz L_e_cok3
s_cmp_eq_u32 s0, 0
s_cbranch_scc1 L_redo
L_e_cok3:
s_cmp_eq_u32 s41, 1
s_cselect_b32 s36, 1, 0
s_lshl_b32 s42, s34, 7
v_mov_b32 v8, 0
L_e_poll4:
buffer_load_dword v9, v8, s[4:7], s42 offen sc1
s_waitcnt vmcnt(0)
v_cmp_gt_u32 vcc, 1, v9
s_nop 0
s_cbranch_vccz L_e_pd5
s_sleep 8
s_sub_u32 s37, s37, 1
s_cbranch_scc0 L_e_poll4
s_movk_i32 s39, 6
s_branch L_bail
L_e_pd5:
L_go:
s_cmp_eq_u32 s32, 0
s_cbranch_scc1 L_CH_far
s_cmp_eq_u32 s32, 1
s_cbranch_scc1 L_KV_far
s_cmp_eq_u32 s32, 2
s_cbranch_scc1 L_AT_far
s_branch L_ML_far
L_redo:
s_waitcnt vmcnt(0) lgkmcnt(0)
s_barrier
s_movk_i32 s0, 128
s_mov_b32 s3, s1
s_branch L_restart
L_bail:
v_mov_b32 v2, s39
s_lshl_b32 s39, s2, 8
v_or_b32 v2, s39, v2
v_mov_b32 v3, 64
s_mov_b64 exec, 1
buffer_store_dword v2, v3, s[24:27], 0 offen sc1
L_end:
s_endpgm
L_CH_far:
s_branch L_CH
L_KV_far:
s_branch L_KV
L_AT_far:
s_branch L_AT
L_ML_far:
s_branch L_ML
.p2align 6
L_CH:
s_getpc_b64 s[40:41]
L_CH_pc:
v_lshl_add_u32 v2, s35, 6, v0
v_lshlrev_b32 v2, 7, v2
v_min_u32 v3, L_CH_end-L_CH_pc-4, v2
global_load_dword a255, v3, s[40:41]
v_add_u32 v2, 0x8000, v2
v_min_u32 v3, L_CH_end-L_CH_pc-4, v2
global_load_dword a255, v3, s[40:41]
s_mov_b32 s8, s68
s_and_b32 s9, s69, 0xffff
s_mov_b32 s10, 4718592
s_mov_b32 s11, 0x20000
s_mov_b32 s12, s70
s_and_b32 s13, s71, 0xffff
s_mov_b32 s14, 4718592
s_mov_b32 s15, 0x20000
s_mov_b32 s16, s72
s_and_b32 s17, s73, 0xffff
s_mov_b32 s18, 4718592
s_mov_b32 s19, 0x20000
s_mov_b32 s20, s74
s_and_b32 s21, s75, 0xffff
s_mov_b32 s22, 4718592
s_mov_b32 s23, 0x20000
s_mov_b32 s28, s66
s_and_b32 s29, s67, 0xffff
s_mov_b32 s30, 9216
s_mov_b32 s31, 0x20000
s_lshl_b32 s46, s34, 8
v_lshrrev_b32 v1, 4, v0
v_lshlrev_b32 v1, 2, v1
v_bfe_u32 v2, v0, 2, 1
v_add_u32 v1, v1, v2
v_mul_u32_u24 v1, 1056, v1
v_bfe_u32 v2, v0, 3, 1
v_lshl_add_u32 v1, v2, 5, v1
v_and_b32 v2, 3, v0
v_lshl_add_u32 v1, v2, 3, v1
v_lshl_add_u32 v1, s35, 6, v1
v_add_u32 v2, 50688, v1
v_add_u32 v3, 101376, v1
v_bfe_u32 v10, v0, 3, 1
v_lshlrev_b32 v10, 3, v10
v_bfe_u32 v11, v0, 2, 1
v_add_u32 v10, v10, v11
v_bfe_u32 v11, v0, 4, 1
v_lshl_add_u32 v10, v11, 2, v10
v_mul_u32_u24 v10, 1056, v10
v_lshrrev_b32 v11, 5, v0
v_lshl_add_u32 v10, v11, 8, v10
v_and_b32 v11, 3, v0
v_lshl_add_u32 v10, v11, 3, v10
v_lshl_add_u32 v10, s35, 6, v10
v_add_u32 v11, 50688, v10
v_add_u32 v12, 101376, v10
s_mul_i32 s45, s35, 4224
v_lshrrev_b32 v4, 4, v0
v_lshlrev_b32 v4, 2, v4
v_add_u32 v4, s35, v4
v_mul_u32_u24 v4, 32768, v4
v_and_b32 v7, 15, v0
v_lshl_add_u32 v4, v7, 4, v4
v_add_u32 v4, s46, v4
v_lshrrev_b32 v5, 4, v0
v_lshlrev_b32 v5, 2, v5
v_add_u32 v5, s35, v5
v_mul_u32_u24 v5, 32768, v5
v_and_b32 v7, 15, v0
v_lshl_add_u32 v5, v7, 4, v5
v_add_u32 v5, s46, v5
v_lshrrev_b32 v6, 4, v0
v_lshlrev_b32 v6, 2, v6
v_add_u32 v6, s35, v6
v_mul_u32_u24 v6, 32768, v6
v_and_b32 v7, 15, v0
v_lshl_add_u32 v6, v7, 4, v6
v_add_u32 v6, s46, v6
s_mov_b32 s44, 0
s_add_u32 m0, s45, 0
s_nop 0
buffer_load_dwordx4 v4, s[8:11], s44 offen offset:0 lds
s_mov_b32 s44, 8192
s_add_u32 m0, s45, 1056
s_nop 0
buffer_load_dwordx4 v4, s[8:11], s44 offen offset:0 lds
s_mov_b32 s44, 16384
s_add_u32 m0, s45, 2112
s_nop 0
buffer_load_dwordx4 v4, s[8:11], s44 offen offset:0 lds
s_mov_b32 s44, 24576
s_add_u32 m0, s45, 3168
s_nop 0
buffer_load_dwordx4 v4, s[8:11], s44 offen offset:0 lds
s_mov_b32 s44, 524288
s_add_u32 m0, s45, 16896
s_nop 0
buffer_load_dwordx4 v4, s[8:11], s44 offen offset:0 lds
s_mov_b32 s44, 532480
s_add_u32 m0, s45, 17952
s_nop 0
buffer_load_dwordx4 v4, s[8:11], s44 offen offset:0 lds
s_mov_b32 s44, 540672
s_add_u32 m0, s45, 19008
s_nop 0
buffer_load_dwordx4 v4, s[8:11], s44 offen offset:0 lds
s_mov_b32 s44, 548864
s_add_u32 m0, s45, 20064
s_nop 0
buffer_load_dwordx4 v4, s[8:11], s44 offen offset:0 lds
s_mov_b32 s44, 1048576
s_add_u32 m0, s45, 33792
s_nop 0
buffer_load_dwordx4 v4, s[8:11], s44 offen offset:0 lds
s_mov_b32 s44, 1056768
s_add_u32 m0, s45, 34848
s_nop 0
buffer_load_dwordx4 v4, s[8:11], s44 offen offset:0 lds
s_mov_b32 s44, 1064960
s_add_u32 m0, s45, 35904
s_nop 0
buffer_load_dwordx4 v4, s[8:11], s44 offen offset:0 lds
s_mov_b32 s44, 1073152
s_add_u32 m0, s45, 36960
s_nop 0
buffer_load_dwordx4 v4, s[8:11], s44 offen offset:0 lds
s_mov_b32 s44, 1572864
s_add_u32 m0, s45, 50688
s_nop 0
buffer_load_dwordx4 v4, s[8:11], s44 offen offset:0 lds
s_mov_b32 s44, 1581056
s_add_u32 m0, s45, 51744
s_nop 0
buffer_load_dwordx4 v4, s[8:11], s44 offen offset:0 lds
s_mov_b32 s44, 1589248
s_add_u32 m0, s45, 52800
s_nop 0
buffer_load_dwordx4 v4, s[8:11], s44 offen offset:0 lds
s_mov_b32 s44, 1597440
s_add_u32 m0, s45, 53856
s_nop 0
buffer_load_dwordx4 v4, s[8:11], s44 offen offset:0 lds
s_mov_b32 s44, 2097152
s_add_u32 m0, s45, 67584
s_nop 0
buffer_load_dwordx4 v4, s[8:11], s44 offen offset:0 lds
s_mov_b32 s44, 2105344
s_add_u32 m0, s45, 68640
s_nop 0
buffer_load_dwordx4 v4, s[8:11], s44 offen offset:0 lds
s_mov_b32 s44, 2113536
s_add_u32 m0, s45, 69696
s_nop 0
buffer_load_dwordx4 v4, s[8:11], s44 offen offset:0 lds
s_mov_b32 s44, 2121728
s_add_u32 m0, s45, 70752
s_nop 0
buffer_load_dwordx4 v4, s[8:11], s44 offen offset:0 lds
s_mov_b32 s44, 2621440
s_add_u32 m0, s45, 84480
s_nop 0
buffer_load_dwordx4 v4, s[8:11], s44 offen offset:0 lds
s_mov_b32 s44, 2629632
s_add_u32 m0, s45, 85536
s_nop 0
buffer_load_dwordx4 v4, s[8:11], s44 offen offset:0 lds
s_mov_b32 s44, 2637824
s_add_u32 m0, s45, 86592
s_nop 0
buffer_load_dwordx4 v4, s[8:11], s44 offen offset:0 lds
s_mov_b32 s44, 2646016
s_add_u32 m0, s45, 87648
s_nop 0
buffer_load_dwordx4 v4, s[8:11], s44 offen offset:0 lds
s_mov_b32 s44, 3145728
s_add_u32 m0, s45, 101376
s_nop 0
buffer_load_dwordx4 v4, s[8:11], s44 offen offset:0 lds
s_mov_b32 s44, 3153920
s_add_u32 m0, s45, 102432
s_nop 0
buffer_load_dwordx4 v4, s[8:11], s44 offen offset:0 lds
s_mov_b32 s44, 3162112
s_add_u32 m0, s45, 103488
s_nop 0
buffer_load_dwordx4 v4, s[8:11], s44 offen offset:0 lds
s_mov_b32 s44, 3170304
s_add_u32 m0, s45, 104544
s_nop 0
buffer_load_dwordx4 v4, s[8:11], s44 offen offset:0 lds
s_mov_b32 s44, 3670016
s_add_u32 m0, s45, 118272
s_nop 0
buffer_load_dwordx4 v4, s[8:11], s44 offen offset:0 lds
s_mov_b32 s44, 3678208
s_add_u32 m0, s45, 119328
s_nop 0
buffer_load_dwordx4 v4, s[8:11], s44 offen offset:0 lds
s_mov_b32 s44, 3686400
s_add_u32 m0, s45, 120384
s_nop 0
buffer_load_dwordx4 v4, s[8:11], s44 offen offset:0 lds
s_mov_b32 s44, 3694592
s_add_u32 m0, s45, 121440
s_nop 0
buffer_load_dwordx4 v4, s[8:11], s44 offen offset:0 lds
s_mov_b32 s44, 4194304
s_add_u32 m0, s45, 135168
s_nop 0
buffer_load_dwordx4 v4, s[8:11], s44 offen offset:0 lds
s_mov_b32 s44, 4202496
s_add_u32 m0, s45, 136224
s_nop 0
buffer_load_dwordx4 v4, s[8:11], s44 offen offset:0 lds
s_mov_b32 s44, 4210688
s_add_u32 m0, s45, 137280
s_nop 0
buffer_load_dwordx4 v4, s[8:11], s44 offen offset:0 lds
s_mov_b32 s44, 4218880
s_add_u32 m0, s45, 138336
s_nop 0
buffer_load_dwordx4 v4, s[8:11], s44 offen offset:0 lds
s_waitcnt vmcnt(24)
s_barrier
ds_read_b64_tr_b16 v[160:161], v1 offset:0
ds_read_b64_tr_b16 v[162:163], v1 offset:2112
ds_read_b64_tr_b16 v[164:165], v1 offset:256
ds_read_b64_tr_b16 v[166:167], v1 offset:2368
ds_read_b64_tr_b16 v[168:169], v1 offset:512
ds_read_b64_tr_b16 v[170:171], v1 offset:2624
ds_read_b64_tr_b16 v[172:173], v1 offset:768
ds_read_b64_tr_b16 v[174:175], v1 offset:2880
ds_read_b64_tr_b16 v[176:177], v1 offset:16896
ds_read_b64_tr_b16 v[178:179], v1 offset:19008
ds_read_b64_tr_b16 v[180:181], v1 offset:17152
ds_read_b64_tr_b16 v[182:183], v1 offset:19264
ds_read_b64_tr_b16 a[0:1], v1 offset:17408
ds_read_b64_tr_b16 a[2:3], v1 offset:19520
ds_read_b64_tr_b16 a[4:5], v1 offset:17664
ds_read_b64_tr_b16 a[6:7], v1 offset:19776
ds_read_b64_tr_b16 a[8:9], v1 offset:33792
ds_read_b64_tr_b16 a[10:11], v1 offset:35904
ds_read_b64_tr_b16 a[12:13], v1 offset:34048
ds_read_b64_tr_b16 a[14:15], v1 offset:36160
ds_read_b64_tr_b16 a[16:17], v1 offset:34304
ds_read_b64_tr_b16 a[18:19], v1 offset:36416
ds_read_b64_tr_b16 a[20:21], v1 offset:34560
ds_read_b64_tr_b16 a[22:23], v1 offset:36672
s_waitcnt lgkmcnt(0)
s_barrier
s_mov_b32 s44, 0
s_add_u32 m0, s45, 0
s_nop 0
buffer_load_dwordx4 v5, s[12:15], s44 offen offset:0 lds
s_mov_b32 s44, 8192
s_add_u32 m0, s45, 1056
s_nop 0
buffer_load_dwordx4 v5, s[12:15], s44 offen offset:0 lds
s_mov_b32 s44, 16384
s_add_u32 m0, s45, 2112
s_nop 0
buffer_load_dwordx4 v5, s[12:15], s44 offen offset:0 lds
s_mov_b32 s44, 24576
s_add_u32 m0, s45, 3168
s_nop 0
buffer_load_dwordx4 v5, s[12:15], s44 offen offset:0 lds
s_mov_b32 s44, 524288
s_add_u32 m0, s45, 16896
s_nop 0
buffer_load_dwordx4 v5, s[12:15], s44 offen offset:0 lds
s_mov_b32 s44, 532480
s_add_u32 m0, s45, 17952
s_nop 0
buffer_load_dwordx4 v5, s[12:15], s44 offen offset:0 lds
s_mov_b32 s44, 540672
s_add_u32 m0, s45, 19008
s_nop 0
buffer_load_dwordx4 v5, s[12:15], s44 offen offset:0 lds
s_mov_b32 s44, 548864
s_add_u32 m0, s45, 20064
s_nop 0
buffer_load_dwordx4 v5, s[12:15], s44 offen offset:0 lds
s_mov_b32 s44, 1048576
s_add_u32 m0, s45, 33792
s_nop 0
buffer_load_dwordx4 v5, s[12:15], s44 offen offset:0 lds
s_mov_b32 s44, 1056768
s_add_u32 m0, s45, 34848
s_nop 0
buffer_load_dwordx4 v5, s[12:15], s44 offen offset:0 lds
s_mov_b32 s44, 1064960
s_add_u32 m0, s45, 35904
s_nop 0
buffer_load_dwordx4 v5, s[12:15], s44 offen offset:0 lds
s_mov_b32 s44, 1073152
s_add_u32 m0, s45, 36960
s_nop 0
buffer_load_dwordx4 v5, s[12:15], s44 offen offset:0 lds
s_waitcnt vmcnt(24)
s_barrier
ds_read_b64_tr_b16 v[184:185], v2 offset:0
ds_read_b64_tr_b16 v[186:187], v2 offset:2112
ds_read_b64_tr_b16 v[188:189], v2 offset:256
ds_read_b64_tr_b16 v[190:191], v2 offset:2368
ds_read_b64_tr_b16 a[24:25], v2 offset:512
ds_read_b64_tr_b16 a[26:27], v2 offset:2624
ds_read_b64_tr_b16 a[28:29], v2 offset:768
ds_read_b64_tr_b16 a[30:31], v2 offset:2880
ds_read_b64_tr_b16 a[32:33], v2 offset:16896
ds_read_b64_tr_b16 a[34:35], v2 offset:19008
ds_read_b64_tr_b16 a[36:37], v2 offset:17152
ds_read_b64_tr_b16 a[38:39], v2 offset:19264
ds_read_b64_tr_b16 v[192:193], v2 offset:17408
ds_read_b64_tr_b16 v[194:195], v2 offset:19520
ds_read_b64_tr_b16 v[196:197], v2 offset:17664
ds_read_b64_tr_b16 v[198:199], v2 offset:19776
ds_read_b64_tr_b16 a[40:41], v2 offset:33792
ds_read_b64_tr_b16 a[42:43], v2 offset:35904
ds_read_b64_tr_b16 a[44:45], v2 offset:34048
ds_read_b64_tr_b16 a[46:47], v2 offset:36160
ds_read_b64_tr_b16 a[48:49], v2 offset:34304
ds_read_b64_tr_b16 a[50:51], v2 offset:36416
ds_read_b64_tr_b16 a[52:53], v2 offset:34560
ds_read_b64_tr_b16 a[54:55], v2 offset:36672
s_waitcnt lgkmcnt(0)
s_barrier
s_mov_b32 s44, 1572864
s_add_u32 m0, s45, 50688
s_nop 0
buffer_load_dwordx4 v5, s[12:15], s44 offen offset:0 lds
s_mov_b32 s44, 1581056
s_add_u32 m0, s45, 51744
s_nop 0
buffer_load_dwordx4 v5, s[12:15], s44 offen offset:0 lds
s_mov_b32 s44, 1589248
s_add_u32 m0, s45, 52800
s_nop 0
buffer_load_dwordx4 v5, s[12:15], s44 offen offset:0 lds
s_mov_b32 s44, 1597440
s_add_u32 m0, s45, 53856
s_nop 0
buffer_load_dwordx4 v5, s[12:15], s44 offen offset:0 lds
s_mov_b32 s44, 2097152
s_add_u32 m0, s45, 67584
s_nop 0
buffer_load_dwordx4 v5, s[12:15], s44 offen offset:0 lds
s_mov_b32 s44, 2105344
s_add_u32 m0, s45, 68640
s_nop 0
buffer_load_dwordx4 v5, s[12:15], s44 offen offset:0 lds
s_mov_b32 s44, 2113536
s_add_u32 m0, s45, 69696
s_nop 0
buffer_load_dwordx4 v5, s[12:15], s44 offen offset:0 lds
s_mov_b32 s44, 2121728
s_add_u32 m0, s45, 70752
s_nop 0
buffer_load_dwordx4 v5, s[12:15], s44 offen offset:0 lds
s_mov_b32 s44, 2621440
s_add_u32 m0, s45, 84480
s_nop 0
buffer_load_dwordx4 v5, s[12:15], s44 offen offset:0 lds
s_mov_b32 s44, 2629632
s_add_u32 m0, s45, 85536
s_nop 0
buffer_load_dwordx4 v5, s[12:15], s44 offen offset:0 lds
s_mov_b32 s44, 2637824
s_add_u32 m0, s45, 86592
s_nop 0
buffer_load_dwordx4 v5, s[12:15], s44 offen offset:0 lds
s_mov_b32 s44, 2646016
s_add_u32 m0, s45, 87648
s_nop 0
buffer_load_dwordx4 v5, s[12:15], s44 offen offset:0 lds
s_waitcnt vmcnt(24)
s_barrier
ds_read_b64_tr_b16 v[200:201], v3 offset:0
ds_read_b64_tr_b16 v[202:203], v3 offset:2112
ds_read_b64_tr_b16 v[204:205], v3 offset:256
ds_read_b64_tr_b16 v[206:207], v3 offset:2368
ds_read_b64_tr_b16 a[56:57], v3 offset:512
ds_read_b64_tr_b16 a[58:59], v3 offset:2624
ds_read_b64_tr_b16 a[60:61], v3 offset:768
ds_read_b64_tr_b16 a[62:63], v3 offset:2880
ds_read_b64_tr_b16 a[64:65], v3 offset:16896
ds_read_b64_tr_b16 a[66:67], v3 offset:19008
ds_read_b64_tr_b16 a[68:69], v3 offset:17152
ds_read_b64_tr_b16 a[70:71], v3 offset:19264
ds_read_b64_tr_b16 v[208:209], v3 offset:17408
ds_read_b64_tr_b16 v[210:211], v3 offset:19520
ds_read_b64_tr_b16 v[212:213], v3 offset:17664
ds_read_b64_tr_b16 v[214:215], v3 offset:19776
ds_read_b64_tr_b16 a[72:73], v3 offset:33792
ds_read_b64_tr_b16 a[74:75], v3 offset:35904
ds_read_b64_tr_b16 a[76:77], v3 offset:34048
ds_read_b64_tr_b16 a[78:79], v3 offset:36160
ds_read_b64_tr_b16 a[80:81], v3 offset:34304
ds_read_b64_tr_b16 a[82:83], v3 offset:36416
ds_read_b64_tr_b16 a[84:85], v3 offset:34560
ds_read_b64_tr_b16 a[86:87], v3 offset:36672
s_waitcnt lgkmcnt(0)
s_barrier
s_mov_b32 s44, 3145728
s_add_u32 m0, s45, 101376
s_nop 0
buffer_load_dwordx4 v5, s[12:15], s44 offen offset:0 lds
s_mov_b32 s44, 3153920
s_add_u32 m0, s45, 102432
s_nop 0
buffer_load_dwordx4 v5, s[12:15], s44 offen offset:0 lds
s_mov_b32 s44, 3162112
s_add_u32 m0, s45, 103488
s_nop 0
buffer_load_dwordx4 v5, s[12:15], s44 offen offset:0 lds
s_mov_b32 s44, 3170304
s_add_u32 m0, s45, 104544
s_nop 0
buffer_load_dwordx4 v5, s[12:15], s44 offen offset:0 lds
s_mov_b32 s44, 3670016
s_add_u32 m0, s45, 118272
s_nop 0
buffer_load_dwordx4 v5, s[12:15], s44 offen offset:0 lds
s_mov_b32 s44, 3678208
s_add_u32 m0, s45, 119328
s_nop 0
buffer_load_dwordx4 v5, s[12:15], s44 offen offset:0 lds
s_mov_b32 s44, 3686400
s_add_u32 m0, s45, 120384
s_nop 0
buffer_load_dwordx4 v5, s[12:15], s44 offen offset:0 lds
s_mov_b32 s44, 3694592
s_add_u32 m0, s45, 121440
s_nop 0
buffer_load_dwordx4 v5, s[12:15], s44 offen offset:0 lds
s_mov_b32 s44, 4194304
s_add_u32 m0, s45, 135168
s_nop 0
buffer_load_dwordx4 v5, s[12:15], s44 offen offset:0 lds
s_mov_b32 s44, 4202496
s_add_u32 m0, s45, 136224
s_nop 0
buffer_load_dwordx4 v5, s[12:15], s44 offen offset:0 lds
s_mov_b32 s44, 4210688
s_add_u32 m0, s45, 137280
s_nop 0
buffer_load_dwordx4 v5, s[12:15], s44 offen offset:0 lds
s_mov_b32 s44, 4218880
s_add_u32 m0, s45, 138336
s_nop 0
buffer_load_dwordx4 v5, s[12:15], s44 offen offset:0 lds
s_waitcnt vmcnt(24)
s_barrier
ds_read_b64_tr_b16 a[88:89], v1 offset:0
ds_read_b64_tr_b16 a[90:91], v1 offset:2112
ds_read_b64_tr_b16 a[92:93], v1 offset:256
ds_read_b64_tr_b16 a[94:95], v1 offset:2368
ds_read_b64_tr_b16 a[96:97], v1 offset:512
ds_read_b64_tr_b16 a[98:99], v1 offset:2624
ds_read_b64_tr_b16 a[100:101], v1 offset:768
ds_read_b64_tr_b16 a[102:103], v1 offset:2880
ds_read_b64_tr_b16 a[104:105], v1 offset:16896
ds_read_b64_tr_b16 a[106:107], v1 offset:19008
ds_read_b64_tr_b16 a[108:109], v1 offset:17152
ds_read_b64_tr_b16 a[110:111], v1 offset:19264
ds_read_b64_tr_b16 a[112:113], v1 offset:17408
ds_read_b64_tr_b16 a[114:115], v1 offset:19520
ds_read_b64_tr_b16 a[116:117], v1 offset:17664
ds_read_b64_tr_b16 a[118:119], v1 offset:19776
ds_read_b64_tr_b16 a[120:121], v1 offset:33792
ds_read_b64_tr_b16 a[122:123], v1 offset:35904
ds_read_b64_tr_b16 a[124:125], v1 offset:34048
ds_read_b64_tr_b16 a[126:127], v1 offset:36160
ds_read_b64_tr_b16 a[128:129], v1 offset:34304
ds_read_b64_tr_b16 a[130:131], v1 offset:36416
ds_read_b64_tr_b16 a[132:133], v1 offset:34560
ds_read_b64_tr_b16 a[134:135], v1 offset:36672
s_waitcnt lgkmcnt(0)
s_barrier
s_mov_b32 s44, 0
s_add_u32 m0, s45, 0
s_nop 0
buffer_load_dwordx4 v6, s[16:19], s44 offen offset:0 lds
s_mov_b32 s44, 8192
s_add_u32 m0, s45, 1056
s_nop 0
buffer_load_dwordx4 v6, s[16:19], s44 offen offset:0 lds
s_mov_b32 s44, 16384
s_add_u32 m0, s45, 2112
s_nop 0
buffer_load_dwordx4 v6, s[16:19], s44 offen offset:0 lds
s_mov_b32 s44, 24576
s_add_u32 m0, s45, 3168
s_nop 0
buffer_load_dwordx4 v6, s[16:19], s44 offen offset:0 lds
s_mov_b32 s44, 524288
s_add_u32 m0, s45, 16896
s_nop 0
buffer_load_dwordx4 v6, s[16:19], s44 offen offset:0 lds
s_mov_b32 s44, 532480
s_add_u32 m0, s45, 17952
s_nop 0
buffer_load_dwordx4 v6, s[16:19], s44 offen offset:0 lds
s_mov_b32 s44, 540672
s_add_u32 m0, s45, 19008
s_nop 0
buffer_load_dwordx4 v6, s[16:19], s44 offen offset:0 lds
s_mov_b32 s44, 548864
s_add_u32 m0, s45, 20064
s_nop 0
buffer_load_dwordx4 v6, s[16:19], s44 offen offset:0 lds
s_mov_b32 s44, 1048576
s_add_u32 m0, s45, 33792
s_nop 0
buffer_load_dwordx4 v6, s[16:19], s44 offen offset:0 lds
s_mov_b32 s44, 1056768
s_add_u32 m0, s45, 34848
s_nop 0
buffer_load_dwordx4 v6, s[16:19], s44 offen offset:0 lds
s_mov_b32 s44, 1064960
s_add_u32 m0, s45, 35904
s_nop 0
buffer_load_dwordx4 v6, s[16:19], s44 offen offset:0 lds
s_mov_b32 s44, 1073152
s_add_u32 m0, s45, 36960
s_nop 0
buffer_load_dwordx4 v6, s[16:19], s44 offen offset:0 lds
s_waitcnt vmcnt(24)
s_barrier
ds_read_b64_tr_b16 a[136:137], v2 offset:0
ds_read_b64_tr_b16 a[138:139], v2 offset:2112
ds_read_b64_tr_b16 a[140:141], v2 offset:256
ds_read_b64_tr_b16 a[142:143], v2 offset:2368
ds_read_b64_tr_b16 a[144:145], v2 offset:512
ds_read_b64_tr_b16 a[146:147], v2 offset:2624
ds_read_b64_tr_b16 a[148:149], v2 offset:768
ds_read_b64_tr_b16 a[150:151], v2 offset:2880
ds_read_b64_tr_b16 a[152:153], v2 offset:16896
ds_read_b64_tr_b16 a[154:155], v2 offset:19008
ds_read_b64_tr_b16 a[156:157], v2 offset:17152
ds_read_b64_tr_b16 a[158:159], v2 offset:19264
ds_read_b64_tr_b16 a[160:161], v2 offset:17408
ds_read_b64_tr_b16 a[162:163], v2 offset:19520
ds_read_b64_tr_b16 a[164:165], v2 offset:17664
ds_read_b64_tr_b16 a[166:167], v2 offset:19776
ds_read_b64_tr_b16 a[168:169], v2 offset:33792
ds_read_b64_tr_b16 a[170:171], v2 offset:35904
ds_read_b64_tr_b16 a[172:173], v2 offset:34048
ds_read_b64_tr_b16 a[174:175], v2 offset:36160
ds_read_b64_tr_b16 a[176:177], v2 offset:34304
ds_read_b64_tr_b16 a[178:179], v2 offset:36416
ds_read_b64_tr_b16 a[180:181], v2 offset:34560
ds_read_b64_tr_b16 a[182:183], v2 offset:36672
s_waitcnt lgkmcnt(0)
s_barrier
s_mov_b32 s44, 1572864
s_add_u32 m0, s45, 50688
s_nop 0
buffer_load_dwordx4 v6, s[16:19], s44 offen offset:0 lds
s_mov_b32 s44, 1581056
s_add_u32 m0, s45, 51744
s_nop 0
buffer_load_dwordx4 v6, s[16:19], s44 offen offset:0 lds
s_mov_b32 s44, 1589248
s_add_u32 m0, s45, 52800
s_nop 0
buffer_load_dwordx4 v6, s[16:19], s44 offen offset:0 lds
s_mov_b32 s44, 1597440
s_add_u32 m0, s45, 53856
s_nop 0
buffer_load_dwordx4 v6, s[16:19], s44 offen offset:0 lds
s_mov_b32 s44, 2097152
s_add_u32 m0, s45, 67584
s_nop 0
buffer_load_dwordx4 v6, s[16:19], s44 offen offset:0 lds
s_mov_b32 s44, 2105344
s_add_u32 m0, s45, 68640
s_nop 0
buffer_load_dwordx4 v6, s[16:19], s44 offen offset:0 lds
s_mov_b32 s44, 2113536
s_add_u32 m0, s45, 69696
s_nop 0
buffer_load_dwordx4 v6, s[16:19], s44 offen offset:0 lds
s_mov_b32 s44, 2121728
s_add_u32 m0, s45, 70752
s_nop 0
buffer_load_dwordx4 v6, s[16:19], s44 offen offset:0 lds
s_mov_b32 s44, 2621440
s_add_u32 m0, s45, 84480
s_nop 0
buffer_load_dwordx4 v6, s[16:19], s44 offen offset:0 lds
s_mov_b32 s44, 2629632
s_add_u32 m0, s45, 85536
s_nop 0
buffer_load_dwordx4 v6, s[16:19], s44 offen offset:0 lds
s_mov_b32 s44, 2637824
s_add_u32 m0, s45, 86592
s_nop 0
buffer_load_dwordx4 v6, s[16:19], s44 offen offset:0 lds
s_mov_b32 s44, 2646016
s_add_u32 m0, s45, 87648
s_nop 0
buffer_load_dwordx4 v6, s[16:19], s44 offen offset:0 lds
s_waitcnt vmcnt(24)
s_barrier
ds_read_b64_tr_b16 a[184:185], v3 offset:0
ds_read_b64_tr_b16 a[186:187], v3 offset:2112
ds_read_b64_tr_b16 a[188:189], v3 offset:256
ds_read_b64_tr_b16 a[190:191], v3 offset:2368
ds_read_b64_tr_b16 a[192:193], v3 offset:512
ds_read_b64_tr_b16 a[194:195], v3 offset:2624
ds_read_b64_tr_b16 a[196:197], v3 offset:768
ds_read_b64_tr_b16 a[198:199], v3 offset:2880
ds_read_b64_tr_b16 a[200:201], v3 offset:16896
ds_read_b64_tr_b16 a[202:203], v3 offset:19008
ds_read_b64_tr_b16 a[204:205], v3 offset:17152
ds_read_b64_tr_b16 a[206:207], v3 offset:19264
ds_read_b64_tr_b16 a[208:209], v3 offset:17408
ds_read_b64_tr_b16 a[210:211], v3 offset:19520
ds_read_b64_tr_b16 a[212:213], v3 offset:17664
ds_read_b64_tr_b16 a[214:215], v3 offset:19776
ds_read_b64_tr_b16 a[216:217], v3 offset:33792
ds_read_b64_tr_b16 a[218:219], v3 offset:35904
ds_read_b64_tr_b16 a[220:221], v3 offset:34048
ds_read_b64_tr_b16 a[222:223], v3 offset:36160
ds_read_b64_tr_b16 a[224:225], v3 offset:34304
ds_read_b64_tr_b16 a[226:227], v3 offset:36416
ds_read_b64_tr_b16 a[228:229], v3 offset:34560
ds_read_b64_tr_b16 a[230:231], v3 offset:36672
s_waitcnt lgkmcnt(0)
s_barrier
s_mov_b32 s44, 3145728
s_add_u32 m0, s45, 101376
s_nop 0
buffer_load_dwordx4 v6, s[16:19], s44 offen offset:0 lds
s_mov_b32 s44, 3153920
s_add_u32 m0, s45, 102432
s_nop 0
buffer_load_dwordx4 v6, s[16:19], s44 offen offset:0 lds
s_mov_b32 s44, 3162112
s_add_u32 m0, s45, 103488
s_nop 0
buffer_load_dwordx4 v6, s[16:19], s44 offen offset:0 lds
s_mov_b32 s44, 3170304
s_add_u32 m0, s45, 104544
s_nop 0
buffer_load_dwordx4 v6, s[16:19], s44 offen offset:0 lds
s_mov_b32 s44, 3670016
s_add_u32 m0, s45, 118272
s_nop 0
buffer_load_dwordx4 v6, s[16:19], s44 offen offset:0 lds
s_mov_b32 s44, 3678208
s_add_u32 m0, s45, 119328
s_nop 0
buffer_load_dwordx4 v6, s[16:19], s44 offen offset:0 lds
s_mov_b32 s44, 3686400
s_add_u32 m0, s45, 120384
s_nop 0
buffer_load_dwordx4 v6, s[16:19], s44 offen offset:0 lds
s_mov_b32 s44, 3694592
s_add_u32 m0, s45, 121440
s_nop 0
buffer_load_dwordx4 v6, s[16:19], s44 offen offset:0 lds
s_mov_b32 s44, 4194304
s_add_u32 m0, s45, 135168
s_nop 0
buffer_load_dwordx4 v6, s[16:19], s44 offen offset:0 lds
s_mov_b32 s44, 4202496
s_add_u32 m0, s45, 136224
s_nop 0
buffer_load_dwordx4 v6, s[16:19], s44 offen offset:0 lds
s_mov_b32 s44, 4210688
s_add_u32 m0, s45, 137280
s_nop 0
buffer_load_dwordx4 v6, s[16:19], s44 offen offset:0 lds
s_mov_b32 s44, 4218880
s_add_u32 m0, s45, 138336
s_nop 0
buffer_load_dwordx4 v6, s[16:19], s44 offen offset:0 lds
s_waitcnt vmcnt(24)
s_barrier
ds_read_b64_tr_b16 v[216:217], v10 offset:0
ds_read_b64_tr_b16 v[218:219], v10 offset:2112
ds_read_b64_tr_b16 v[220:221], v10 offset:512
ds_read_b64_tr_b16 v[222:223], v10 offset:2624
ds_read_b64_tr_b16 a[232:233], v10 offset:32
ds_read_b64_tr_b16 a[234:235], v10 offset:2144
ds_read_b64_tr_b16 a[236:237], v10 offset:544
ds_read_b64_tr_b16 a[238:239], v10 offset:2656
ds_read_b64_tr_b16 a[240:241], v10 offset:16896
ds_read_b64_tr_b16 a[242:243], v10 offset:19008
ds_read_b64_tr_b16 a[244:245], v10 offset:17408
ds_read_b64_tr_b16 a[246:247], v10 offset:19520
ds_read_b64_tr_b16 a[248:249], v10 offset:16928
ds_read_b64_tr_b16 a[250:251], v10 offset:19040
ds_read_b64_tr_b16 a[252:253], v10 offset:17440
ds_read_b64_tr_b16 a[254:255], v10 offset:19552
ds_read_b64_tr_b16 v[80:81], v10 offset:33792
ds_read_b64_tr_b16 v[82:83], v10 offset:35904
ds_read_b64_tr_b16 v[84:85], v10 offset:34304
ds_read_b64_tr_b16 v[86:87], v10 offset:36416
ds_read_b64_tr_b16 v[88:89], v10 offset:33824
ds_read_b64_tr_b16 v[90:91], v10 offset:35936
ds_read_b64_tr_b16 v[92:93], v10 offset:34336
ds_read_b64_tr_b16 v[94:95], v10 offset:36448
s_waitcnt vmcnt(12)
s_barrier
ds_read_b64_tr_b16 v[224:225], v11 offset:0
ds_read_b64_tr_b16 v[226:227], v11 offset:2112
ds_read_b64_tr_b16 v[228:229], v11 offset:512
ds_read_b64_tr_b16 v[230:231], v11 offset:2624
ds_read_b64_tr_b16 v[96:97], v11 offset:32
ds_read_b64_tr_b16 v[98:99], v11 offset:2144
ds_read_b64_tr_b16 v[100:101], v11 offset:544
ds_read_b64_tr_b16 v[102:103], v11 offset:2656
ds_read_b64_tr_b16 v[104:105], v11 offset:16896
ds_read_b64_tr_b16 v[106:107], v11 offset:19008
ds_read_b64_tr_b16 v[108:109], v11 offset:17408
ds_read_b64_tr_b16 v[110:111], v11 offset:19520
ds_read_b64_tr_b16 v[232:233], v11 offset:16928
ds_read_b64_tr_b16 v[234:235], v11 offset:19040
ds_read_b64_tr_b16 v[236:237], v11 offset:17440
ds_read_b64_tr_b16 v[238:239], v11 offset:19552
ds_read_b64_tr_b16 v[112:113], v11 offset:33792
ds_read_b64_tr_b16 v[114:115], v11 offset:35904
ds_read_b64_tr_b16 v[116:117], v11 offset:34304
ds_read_b64_tr_b16 v[118:119], v11 offset:36416
ds_read_b64_tr_b16 v[120:121], v11 offset:33824
ds_read_b64_tr_b16 v[122:123], v11 offset:35936
ds_read_b64_tr_b16 v[124:125], v11 offset:34336
ds_read_b64_tr_b16 v[126:127], v11 offset:36448
s_waitcnt vmcnt(0)
s_barrier
ds_read_b64_tr_b16 v[240:241], v12 offset:0
ds_read_b64_tr_b16 v[242:243], v12 offset:2112
ds_read_b64_tr_b16 v[244:245], v12 offset:512
ds_read_b64_tr_b16 v[246:247], v12 offset:2624
ds_read_b64_tr_b16 v[128:129], v12 offset:32
ds_read_b64_tr_b16 v[130:131], v12 offset:2144
ds_read_b64_tr_b16 v[132:133], v12 offset:544
ds_read_b64_tr_b16 v[134:135], v12 offset:2656
ds_read_b64_tr_b16 v[136:137], v12 offset:16896
ds_read_b64_tr_b16 v[138:139], v12 offset:19008
ds_read_b64_tr_b16 v[140:141], v12 offset:17408
ds_read_b64_tr_b16 v[142:143], v12 offset:19520
ds_read_b64_tr_b16 v[248:249], v12 offset:16928
ds_read_b64_tr_b16 v[250:251], v12 offset:19040
ds_read_b64_tr_b16 v[252:253], v12 offset:17440
ds_read_b64_tr_b16 v[254:255], v12 offset:19552
ds_read_b64_tr_b16 v[144:145], v12 offset:33792
ds_read_b64_tr_b16 v[146:147], v12 offset:35904
ds_read_b64_tr_b16 v[148:149], v12 offset:34304
ds_read_b64_tr_b16 v[150:151], v12 offset:36416
ds_read_b64_tr_b16 v[152:153], v12 offset:33824
ds_read_b64_tr_b16 v[154:155], v12 offset:35936
ds_read_b64_tr_b16 v[156:157], v12 offset:34336
ds_read_b64_tr_b16 v[158:159], v12 offset:36448
s_waitcnt lgkmcnt(0)
s_barrier
v_lshlrev_b32 v4, 4, v0
s_mul_i32 s45, s35, 36864
s_add_u32 s45, s45, 16384
s_mul_i32 s46, s34, 147456
s_mul_i32 s47, s35, 18432
s_add_u32 s46, s46, s47
s_add_u32 s44, s46, 0
s_add_u32 m0, s45, 0
s_nop 0
buffer_load_dwordx4 v4, s[20:23], s44 offen offset:0 lds
buffer_load_dwordx4 v4, s[20:23], s44 offen offset:1024 lds
buffer_load_dwordx4 v4, s[20:23], s44 offen offset:2048 lds
buffer_load_dwordx4 v4, s[20:23], s44 offen offset:3072 lds
s_add_u32 s44, s46, 4096
s_add_u32 m0, s45, 4096
s_nop 0
buffer_load_dwordx4 v4, s[20:23], s44 offen offset:0 lds
buffer_load_dwordx4 v4, s[20:23], s44 offen offset:1024 lds
buffer_load_dwordx4 v4, s[20:23], s44 offen offset:2048 lds
buffer_load_dwordx4 v4, s[20:23], s44 offen offset:3072 lds
s_add_u32 s44, s46, 8192
s_add_u32 m0, s45, 8192
s_nop 0
buffer_load_dwordx4 v4, s[20:23], s44 offen offset:0 lds
buffer_load_dwordx4 v4, s[20:23], s44 offen offset:1024 lds
buffer_load_dwordx4 v4, s[20:23], s44 offen offset:2048 lds
buffer_load_dwordx4 v4, s[20:23], s44 offen offset:3072 lds
s_add_u32 s44, s46, 12288
s_add_u32 m0, s45, 12288
s_nop 0
buffer_load_dwordx4 v4, s[20:23], s44 offen offset:0 lds
buffer_load_dwordx4 v4, s[20:23], s44 offen offset:1024 lds
buffer_load_dwordx4 v4, s[20:23], s44 offen offset:2048 lds
buffer_load_dwordx4 v4, s[20:23], s44 offen offset:3072 lds
s_add_u32 s44, s46, 16384
s_add_u32 m0, s45, 16384
s_nop 0
buffer_load_dwordx4 v4, s[20:23], s44 offen offset:0 lds
buffer_load_dwordx4 v4, s[20:23], s44 offen offset:1024 lds
s_add_u32 s44, s46, 73728
s_add_u32 m0, s45, 18432
s_nop 0
buffer_load_dwordx4 v4, s[20:23], s44 offen offset:0 lds
buffer_load_dwordx4 v4, s[20:23], s44 offen offset:1024 lds
buffer_load_dwordx4 v4, s[20:23], s44 offen offset:2048 lds
buffer_load_dwordx4 v4, s[20:23], s44 offen offset:3072 lds
s_add_u32 s44, s46, 77824
s_add_u32 m0, s45, 22528
s_nop 0
buffer_load_dwordx4 v4, s[20:23], s44 offen offset:0 lds
buffer_load_dwordx4 v4, s[20:23], s44 offen offset:1024 lds
buffer_load_dwordx4 v4, s[20:23], s44 offen offset:2048 lds
buffer_load_dwordx4 v4, s[20:23], s44 offen offset:3072 lds
s_add_u32 s44, s46, 81920
s_add_u32 m0, s45, 26624
s_nop 0
buffer_load_dwordx4 v4, s[20:23], s44 offen offset:0 lds
buffer_load_dwordx4 v4, s[20:23], s44 offen offset:1024 lds
buffer_load_dwordx4 v4, s[20:23], s44 offen offset:2048 lds
buffer_load_dwordx4 v4, s[20:23], s44 offen offset:3072 lds
s_add_u32 s44, s46, 86016
s_add_u32 m0, s45, 30720
s_nop 0
buffer_load_dwordx4 v4, s[20:23], s44 offen offset:0 lds
buffer_load_dwordx4 v4, s[20:23], s44 offen offset:1024 lds
buffer_load_dwordx4 v4, s[20:23], s44 offen offset:2048 lds
buffer_load_dwordx4 v4, s[20:23], s44 offen offset:3072 lds
s_add_u32 s44, s46, 90112
s_add_u32 m0, s45, 34816
s_nop 0
buffer_load_dwordx4 v4, s[20:23], s44 offen offset:0 lds
buffer_load_dwordx4 v4, s[20:23], s44 offen offset:1024 lds
v_lshrrev_b32 v1, 5, v0
v_lshlrev_b32 v1, 2, v1
v_bfe_u32 v2, v0, 2, 1
v_add_u32 v1, v1, v2
v_mul_u32_u24 v1, 1152, v1
v_bfe_u32 v2, v0, 4, 1
v_mul_u32_u24 v2, 36864, v2
v_add_u32 v1, v1, v2
v_and_b32 v2, 3, v0
v_lshl_add_u32 v1, v2, 3, v1
s_mul_i32 s44, s35, 288
s_add_u32 s44, s44, 16384
v_add_u32 v1, s44, v1
v_bfe_u32 v2, v0, 3, 1
v_mul_u32_u24 v3, 73728, v2
v_add_u32 v3, v3, v1
v_lshl_add_u32 v1, v2, 5, v1
v_add_u32 v2, 73728, v1
v_add_u32 v5, s45, v4
s_waitcnt vmcnt(0)
s_barrier
ds_read_b64_tr_b16 v[8:9], v1 offset:0
ds_read_b64_tr_b16 v[10:11], v1 offset:2304
ds_read_b64_tr_b16 v[12:13], v1 offset:9216
ds_read_b64_tr_b16 v[14:15], v1 offset:11520
ds_read_b64_tr_b16 v[16:17], v2 offset:0
ds_read_b64_tr_b16 v[18:19], v2 offset:2304
ds_read_b64_tr_b16 v[20:21], v2 offset:9216
ds_read_b64_tr_b16 v[22:23], v2 offset:11520
ds_read_b64_tr_b16 v[24:25], v1 offset:64
ds_read_b64_tr_b16 v[26:27], v1 offset:2368
ds_read_b64_tr_b16 v[28:29], v1 offset:9280
ds_read_b64_tr_b16 v[30:31], v1 offset:11584
ds_read_b64_tr_b16 v[32:33], v2 offset:64
ds_read_b64_tr_b16 v[34:35], v2 offset:2368
ds_read_b64_tr_b16 v[36:37], v2 offset:9280
ds_read_b64_tr_b16 v[38:39], v2 offset:11584
ds_read_b64_tr_b16 v[40:41], v1 offset:128
ds_read_b64_tr_b16 v[42:43], v1 offset:2432
ds_read_b64_tr_b16 v[44:45], v1 offset:9344
ds_read_b64_tr_b16 v[46:47], v1 offset:11648
ds_read_b64_tr_b16 v[48:49], v2 offset:128
ds_read_b64_tr_b16 v[50:51], v2 offset:2432
ds_read_b64_tr_b16 v[52:53], v2 offset:9344
ds_read_b64_tr_b16 v[54:55], v2 offset:11648
ds_read_b64_tr_b16 v[56:57], v1 offset:192
ds_read_b64_tr_b16 v[58:59], v1 offset:2496
ds_read_b64_tr_b16 v[60:61], v1 offset:9408
ds_read_b64_tr_b16 v[62:63], v1 offset:11712
ds_read_b64_tr_b16 v[64:65], v2 offset:192
ds_read_b64_tr_b16 v[66:67], v2 offset:2496
ds_read_b64_tr_b16 v[68:69], v2 offset:9408
ds_read_b64_tr_b16 v[70:71], v2 offset:11712
ds_read_b64_tr_b16 v[72:73], v3 offset:256
ds_read_b64_tr_b16 v[74:75], v3 offset:2560
ds_read_b64_tr_b16 v[76:77], v3 offset:9472
ds_read_b64_tr_b16 v[78:79], v3 offset:11776
s_waitcnt lgkmcnt(0)
s_barrier
ds_write_b128 v5, v[160:163] offset:0
ds_write_b128 v5, v[164:167] offset:1024
ds_write_b128 v5, v[168:171] offset:2048
ds_write_b128 v5, v[172:175] offset:3072
ds_write_b128 v5, v[176:179] offset:4096
ds_write_b128 v5, v[180:183] offset:5120
ds_write_b128 v5, v[184:187] offset:6144
ds_write_b128 v5, v[188:191] offset:7168
ds_write_b128 v5, v[192:195] offset:8192
ds_write_b128 v5, v[196:199] offset:9216
ds_write_b128 v5, v[200:203] offset:10240
ds_write_b128 v5, v[204:207] offset:11264
ds_write_b128 v5, v[208:211] offset:12288
ds_write_b128 v5, v[212:215] offset:13312
ds_write_b128 v5, v[216:219] offset:14336
ds_write_b128 v5, v[220:223] offset:15360
ds_write_b128 v5, v[224:227] offset:16384
ds_write_b128 v5, v[228:231] offset:17408
ds_read_b64_tr_b16 v[160:161], v1 offset:18432
ds_read_b64_tr_b16 v[162:163], v1 offset:20736
ds_read_b64_tr_b16 v[164:165], v1 offset:27648
ds_read_b64_tr_b16 v[166:167], v1 offset:29952
ds_read_b64_tr_b16 v[168:169], v2 offset:18432
ds_read_b64_tr_b16 v[170:171], v2 offset:20736
ds_read_b64_tr_b16 v[172:173], v2 offset:27648
ds_read_b64_tr_b16 v[174:175], v2 offset:29952
ds_read_b64_tr_b16 v[176:177], v1 offset:18496
ds_read_b64_tr_b16 v[178:179], v1 offset:20800
ds_read_b64_tr_b16 v[180:181], v1 offset:27712
ds_read_b64_tr_b16 v[182:183], v1 offset:30016
ds_read_b64_tr_b16 v[184:185], v2 offset:18496
ds_read_b64_tr_b16 v[186:187], v2 offset:20800
ds_read_b64_tr_b16 v[188:189], v2 offset:27712
ds_read_b64_tr_b16 v[190:191], v2 offset:30016
ds_read_b64_tr_b16 v[192:193], v1 offset:18560
ds_read_b64_tr_b16 v[194:195], v1 offset:20864
ds_read_b64_tr_b16 v[196:197], v1 offset:27776
ds_read_b64_tr_b16 v[198:199], v1 offset:30080
ds_read_b64_tr_b16 v[200:201], v2 offset:18560
ds_read_b64_tr_b16 v[202:203], v2 offset:20864
ds_read_b64_tr_b16 v[204:205], v2 offset:27776
ds_read_b64_tr_b16 v[206:207], v2 offset:30080
ds_read_b64_tr_b16 v[208:209], v1 offset:18624
ds_read_b64_tr_b16 v[210:211], v1 offset:20928
ds_read_b64_tr_b16 v[212:213], v1 offset:27840
ds_read_b64_tr_b16 v[214:215], v1 offset:30144
ds_read_b64_tr_b16 v[216:217], v2 offset:18624
ds_read_b64_tr_b16 v[218:219], v2 offset:20928
ds_read_b64_tr_b16 v[220:221], v2 offset:27840
ds_read_b64_tr_b16 v[222:223], v2 offset:30144
ds_read_b64_tr_b16 v[224:225], v3 offset:18688
ds_read_b64_tr_b16 v[226:227], v3 offset:20992
ds_read_b64_tr_b16 v[228:229], v3 offset:27904
ds_read_b64_tr_b16 v[230:231], v3 offset:30208
s_waitcnt lgkmcnt(0)
s_barrier
ds_write_b128 v5, v[232:235] offset:18432
ds_write_b128 v5, v[236:239] offset:19456
ds_write_b128 v5, v[240:243] offset:20480
ds_write_b128 v5, v[244:247] offset:21504
ds_write_b128 v5, v[248:251] offset:22528
ds_write_b128 v5, v[252:255] offset:23552
ds_write_b128 v5, v[72:75] offset:24576
ds_write_b128 v5, v[76:79] offset:25600
ds_write_b128 v5, v[8:11] offset:26624
ds_write_b128 v5, v[12:15] offset:27648
ds_write_b128 v5, v[16:19] offset:28672
ds_write_b128 v5, v[20:23] offset:29696
ds_write_b128 v5, v[32:35] offset:30720
ds_write_b128 v5, v[36:39] offset:31744
ds_write_b128 v5, v[48:51] offset:32768
ds_write_b128 v5, v[52:55] offset:33792
ds_write_b128 v5, v[64:67] offset:34816
ds_write_b128 v5, v[68:71] offset:35840
v_mov_b32 v232, v24
v_mov_b32 v233, v25
v_mov_b32 v234, v26
v_mov_b32 v235, v27
v_mov_b32 v236, v28
v_mov_b32 v237, v29
v_mov_b32 v238, v30
v_mov_b32 v239, v31
v_mov_b32 v240, v40
v_mov_b32 v241, v41
v_mov_b32 v242, v42
v_mov_b32 v243, v43
v_mov_b32 v244, v44
v_mov_b32 v245, v45
v_mov_b32 v246, v46
v_mov_b32 v247, v47
v_mov_b32 v248, v56
v_mov_b32 v249, v57
v_mov_b32 v250, v58
v_mov_b32 v251, v59
v_mov_b32 v252, v60
v_mov_b32 v253, v61
v_mov_b32 v254, v62
v_mov_b32 v255, v63
s_waitcnt lgkmcnt(0)
v_lshl_add_u32 v16, s35, 6, v0
v_lshlrev_b32 v16, 20, v16
buffer_load_dword v18, v16, s[4:7], 0 offen
buffer_load_dword v18, v16, s[16:19], 0 offen
v_and_b32 v16, 7, v0
v_lshlrev_b32 v16, 3, v16
L_ch_cen1:
buffer_load_dwordx2 v[18:19], v16, s[24:27], s0 offen sc1
s_waitcnt vmcnt(0)
v_sad_u8 v17, v18, 0, 0
v_sad_u8 v17, v19, 0, v17
v_cmp_ne_u32 vcc, 32, v17
s_nop 0
s_cbranch_vccz L_ch_cend2
s_sleep 16
s_sub_u32 s37, s37, 1
s_cbranch_scc0 L_ch_cen1
s_movk_i32 s39, 17
s_branch L_bail
L_ch_cend2:
v_bcnt_u32_b32 v17, v18, 0
v_bcnt_u32_b32 v17, v19, v17
v_cmp_ne_u32 vcc, 1, v17
v_readlane_b32 s41, v17, s1
s_cbranch_vccz L_ch_cok3
s_cmp_eq_u32 s0, 0
s_cbranch_scc1 L_redo
L_ch_cok3:
s_cmp_eq_u32 s41, 1
s_cselect_b32 s36, 1, 0
v_and_b32 v16, 15, v0
v_lshrrev_b32 v17, 4, v0
v_and_b32 v18, 7, v0
v_bfe_u32 v19, v0, 3, 1
v_mov_b32 v1, 0x4444
v_mul_u32_u24 v20, 0xaaaa, v19
v_add_u32 v1, v1, v20
v_lshlrev_b32 v2, 7, v17
v_lshl_add_u32 v2, v18, 4, v2
s_mul_i32 s96, s35, 1792
s_add_u32 s96, s96, 9216
v_lshrrev_b32 v20, 5, v0
v_lshl_add_u32 v3, v20, 4, v16
v_lshl_add_u32 v3, v3, 4, s96
v_bfe_u32 v21, v0, 4, 1
v_lshl_add_u32 v3, v21, 3, v3
v_bfe_u32 v22, v0, 2, 1
v_lshl_add_u32 v6, v22, 2, v17
v_lshl_add_u32 v6, v6, 2, v19
v_lshl_add_u32 v6, v6, 4, s96
v_and_b32 v22, 1, v0
v_lshl_add_u32 v6, v22, 3, v6
v_and_b32 v7, 31, v0
v_lshlrev_b32 v7, 3, v7
s_mov_b32 s54, 0xff00ff00
s_mov_b32 s55, 0xff00ff00
s_mov_b32 s98, 0x00ff00ff
s_mov_b32 s99, 0x00ff00ff
s_mov_b32 s56, 196611
s_mov_b32 s57, 196611
s_mov_b32 s58, 786444
s_mov_b32 s59, 786444
s_mov_b32 s60, 3145776
s_mov_b32 s61, 3145776
s_mov_b32 s62, 0x003f003f
s_mov_b32 s63, 0x003f003f
s_mov_b32 s47, 1040356334
s_mul_i32 s48, s33, 51118080
s_mul_i32 s45, s34, 1597440
s_add_u32 s48, s48, s45
s_lshl_b32 s45, s35, 10
s_add_u32 s48, s48, s45
s_add_u32 s48, s48, 58720256
s_add_u32 s65, s45, 8192
s_mul_i32 s50, s33, 393216
s_add_u32 s50, s50, 32768
s_mul_i32 s49, s34, 12288
s_mul_i32 s97, s35, 3072
s_add_u32 s49, s49, s97
s_add_u32 s49, s49, s50
s_lshl_b32 s51, s33, 15
s_add_u32 s51, s51, 1048576
s_add_u32 s52, s51, 9216
s_add_u32 s53, s52, 9216
s_mul_i32 s94, s33, 8519680
s_mul_i32 s45, s34, 266240
s_add_u32 s94, s94, s45
s_lshl_b32 s45, s35, 9
s_add_u32 s94, s94, s45
s_add_u32 s94, s94, 20971520
s_lshl_b32 s95, s33, 5
s_add_u32 s95, s95, s34
s_lshl_b32 s95, s95, 7
s_lshl_b32 s45, s35, 2
s_add_u32 s66, s95, s45
s_add_u32 s66, s66, 16
s_mov_b32 s38, 1
s_mov_b32 s67, 0
s_lshl_b32 s46, s33, 12
s_add_u32 s46, s46, 851968
s_lshl_b32 s32, s35, 8
s_add_u32 s32, s32, s46
s_lshl_b32 s45, s34, 2
s_add_u32 s32, s32, s45
v_lshlrev_b32 v26, 7, v0
v_min_u32 v27, 2944, v26
buffer_load_dword v28, v27, s[4:7], s49 offen sc1
v_lshl_add_u32 v26, s35, 13, v26
buffer_load_dword v28, v26, s[4:7], s51 offen sc1
s_cmp_eq_u32 s35, 3
s_cbranch_scc1 L_ch_P
v_lshl_add_u32 v20, v17, 1, v19
v_mul_u32_u24 v8, 12288, v20
v_lshl_add_u32 v8, v18, 4, v8
s_lshr_b32 s40, s34, 3
s_mul_i32 s41, s40, 3
s_add_u32 s41, s41, s35
s_lshl_b32 s42, s41, 10
s_and_b32 s43, s34, 7
s_lshl_b32 s43, s43, 7
s_add_u32 s42, s42, s43
v_add_u32 v8, s42, v8
v_mul_u32_u24 v21, 1152, v18
v_lshl_add_u32 v21, v20, 4, v21
s_mul_i32 s44, s35, 384
buffer_load_dwordx4 v[36:39], v21, s[28:31], s44 offen offset:0
buffer_load_dwordx4 v[40:43], v21, s[28:31], s44 offen offset:128
buffer_load_dwordx4 v[44:47], v21, s[28:31], s44 offen offset:256
s_bfe_u32 s42, s34, 0x10002
s_mul_i32 s43, s35, 3
v_lshrrev_b32 v22, 1, v16
v_add_u32 v22, s43, v22
v_and_b32 v23, -2, v22
v_add_u32 v23, s42, v23
v_lshlrev_b32 v23, 8, v23
v_and_b32 v24, 1, v22
v_lshl_add_u32 v23, v24, 5, v23
s_lshl_b32 s43, s42, 5
s_add_u32 s43, s43, 2048
v_mov_b32 v24, s43
v_cmp_eq_u32 vcc, 8, v22
s_nop 1
v_cndmask_b32 v23, v23, v24, vcc
s_mul_i32 s41, s40, 2304
s_bfe_u32 s42, s34, 0x10001
s_lshl_b32 s42, s42, 6
s_add_u32 s41, s41, s42
s_and_b32 s42, s34, 1
s_lshl_b32 s42, s42, 7
s_add_u32 s41, s41, s42
v_and_b32 v24, 1, v0
v_lshl_add_u32 v23, v24, 4, v23
v_bfe_u32 v24, v0, 4, 1
v_lshl_add_u32 v23, v24, 3, v23
v_lshrrev_b32 v24, 5, v0
v_lshl_add_u32 v23, v24, 2, v23
v_add_u32 v23, s41, v23
v_mov_b32 v24, 0x7ffffff0
v_cndmask_b32 v0, v24, v23, s[62:63]
s_mov_b32 s84, 0xaaaaaaaa
s_mov_b32 s85, 0xaaaaaaaa
s_add_u32 s40, s50, 98304
s_add_u32 s41, s50, 196608
s_add_u32 s42, s50, 294912
s_lshl_b32 s33, s34, 6
s_add_u32 s33, s33, s35
s_add_u32 s33, s33, s46
v_add_u32 v9, s97, v4
s_waitcnt vmcnt(2)
ds_write_b128 v9, v[36:39] offset:0
s_waitcnt vmcnt(1)
ds_write_b128 v9, v[40:43] offset:1024
s_waitcnt vmcnt(0)
ds_write_b128 v9, v[44:47] offset:2048
ds_read_b128 v[56:59], v5 offset:0
ds_read_b128 v[60:63], v5 offset:1024
ds_read_b128 v[64:67], v5 offset:2048
ds_read_b128 v[68:71], v5 offset:3072
ds_read_b128 v[72:75], v5 offset:4096
ds_read_b128 v[76:79], v5 offset:5120
v_mov_b32 v28, 0
v_mov_b32 v29, 0
v_mov_b32 v30, 0
v_mov_b32 v31, 0
v_mov_b32 v32, 0
v_mov_b32 v33, 0
v_mov_b32 v34, 0
v_mov_b32 v35, 0
L_chR_loop:
s_waitcnt lgkmcnt(0)
s_barrier
s_add_u32 s44, s48, 4096
v_add_u32 v9, s96, v4
v_add_u32 v23, s96, v7
s_add_u32 s43, s48, s65
ds_read_b128 v[36:39], v2 offset:0
ds_read_b128 v[40:43], v2 offset:512
ds_read_b128 v[44:47], v2 offset:1024
ds_read_b128 v[48:51], v2 offset:1536
ds_read_b128 v[52:55], v2 offset:2048
buffer_load_dwordx4 v[10:13], v4, s[4:7], s48 offen sc1
buffer_load_dwordx4 v[14:17], v4, s[4:7], s44 offen sc1
s_waitcnt lgkmcnt(4)
v_smfmac_f32_16x16x64_bf16 v[28:31], v[36:39], v[56:63], v1
ds_read_b128 v[60:63], v5 offset:7168
v_smfmac_f32_16x16x64_bf16 v[32:35], v[36:39], a[88:95], v1
buffer_load_dwordx4 v[18:21], v4, s[4:7], s43 offen offset:0 sc1
s_waitcnt lgkmcnt(4)
v_smfmac_f32_16x16x64_bf16 v[28:31], v[40:43], v[64:71], v1
ds_read_b128 v[36:39], v2 offset:2560
v_smfmac_f32_16x16x64_bf16 v[32:35], v[40:43], a[96:103], v1
buffer_load_dwordx4 v[24:27], v4, s[4:7], s43 offen offset:1024 sc1
ds_read_b128 v[56:59], v5 offset:6144
s_waitcnt lgkmcnt(5)
v_smfmac_f32_16x16x64_bf16 v[28:31], v[44:47], v[72:79], v1
ds_read_b128 v[40:43], v2 offset:3072
v_smfmac_f32_16x16x64_bf16 v[32:35], v[44:47], a[104:111], v1
s_waitcnt lgkmcnt(5)
v_smfmac_f32_16x16x64_bf16 v[28:31], v[48:51], a[0:7], v1
ds_read_b128 v[44:47], v2 offset:3584
v_smfmac_f32_16x16x64_bf16 v[32:35], v[48:51], a[112:119], v1
ds_read_b128 v[48:51], v2 offset:4096
s_waitcnt lgkmcnt(6)
v_smfmac_f32_16x16x64_bf16 v[28:31], v[52:55], a[8:15], v1
ds_read_b128 v[68:71], v5 offset:9216
v_smfmac_f32_16x16x64_bf16 v[32:35], v[52:55], a[120:127], v1
ds_read_b128 v[52:55], v2 offset:4608
s_waitcnt lgkmcnt(6)
v_smfmac_f32_16x16x64_bf16 v[32:35], v[36:39], a[128:135], v1
ds_read_b128 v[64:67], v5 offset:8192
v_smfmac_f32_16x16x64_bf16 v[28:31], v[36:39], a[16:23], v1
ds_read_b128 v[36:39], v2 offset:5120
s_waitcnt lgkmcnt(6)
v_smfmac_f32_16x16x64_bf16 v[28:31], v[40:43], v[56:63], v1
ds_read_b128 v[76:79], v5 offset:11264
v_smfmac_f32_16x16x64_bf16 v[32:35], v[40:43], a[136:143], v1
ds_read_b128 v[40:43], v2 offset:5632
s_waitcnt lgkmcnt(7)
v_smfmac_f32_16x16x64_bf16 v[32:35], v[44:47], a[144:151], v1
ds_read_b128 v[72:75], v5 offset:10240
v_smfmac_f32_16x16x64_bf16 v[28:31], v[44:47], a[24:31], v1
ds_read_b128 v[44:47], v2 offset:6144
s_waitcnt lgkmcnt(8)
v_smfmac_f32_16x16x64_bf16 v[28:31], v[48:51], a[32:39], v1
ds_read_b128 v[56:59], v5 offset:12288
v_smfmac_f32_16x16x64_bf16 v[32:35], v[48:51], a[152:159], v1
ds_read_b128 v[60:63], v5 offset:13312
s_waitcnt lgkmcnt(8)
v_smfmac_f32_16x16x64_bf16 v[32:35], v[52:55], a[160:167], v1
ds_read_b128 v[48:51], v2 offset:6656
s_waitcnt lgkmcnt(8)
v_smfmac_f32_16x16x64_bf16 v[28:31], v[52:55], v[64:71], v1
ds_read_b128 v[52:55], v2 offset:7168
s_waitcnt lgkmcnt(8)
v_smfmac_f32_16x16x64_bf16 v[28:31], v[36:39], a[40:47], v1
ds_read_b128 v[68:71], v5 offset:15360
v_smfmac_f32_16x16x64_bf16 v[32:35], v[36:39], a[168:175], v1
ds_read_b128 v[36:39], v2 offset:7680
s_waitcnt lgkmcnt(8)
v_smfmac_f32_16x16x64_bf16 v[32:35], v[40:43], a[176:183], v1
ds_read_b128 v[64:67], v5 offset:14336
v_smfmac_f32_16x16x64_bf16 v[28:31], v[40:43], a[48:55], v1
ds_read_b128 v[40:43], v2 offset:8192
s_waitcnt lgkmcnt(8)
v_smfmac_f32_16x16x64_bf16 v[32:35], v[44:47], a[184:191], v1
v_smfmac_f32_16x16x64_bf16 v[28:31], v[44:47], v[72:79], v1
ds_read_b128 v[44:47], v2 offset:8704
s_nop 0
v_mov_b32 v78, 0
v_mov_b32 v72, 0
v_mov_b32 v75, 0
v_mov_b32 v79, 0
s_waitcnt lgkmcnt(6)
v_smfmac_f32_16x16x64_bf16 v[28:31], v[48:51], a[56:63], v1
v_mov_b32 v77, 0
v_smfmac_f32_16x16x64_bf16 v[32:35], v[48:51], a[192:199], v1
ds_read_b128 v[48:51], v4 offset:1024
v_mov_b32 v73, 0
s_waitcnt lgkmcnt(6)
v_smfmac_f32_16x16x64_bf16 v[28:31], v[52:55], a[64:71], v1
v_mov_b32 v76, 0
v_smfmac_f32_16x16x64_bf16 v[32:35], v[52:55], a[200:207], v1
ds_read_b128 v[52:55], v4 offset:2048
v_mov_b32 v74, 0
s_waitcnt lgkmcnt(5)
v_smfmac_f32_16x16x64_bf16 v[28:31], v[36:39], v[56:63], v1
ds_read_b128 v[56:59], v4 offset:0
s_waitcnt lgkmcnt(4)
v_smfmac_f32_16x16x64_bf16 v[28:31], v[40:43], a[72:79], v1
v_smfmac_f32_16x16x64_bf16 v[32:35], v[36:39], a[208:215], v1
s_waitcnt lgkmcnt(3)
v_smfmac_f32_16x16x64_bf16 v[28:31], v[44:47], a[80:87], v1
v_smfmac_f32_16x16x64_bf16 v[32:35], v[40:43], a[216:223], v1
v_smfmac_f32_16x16x64_bf16 v[32:35], v[44:47], a[224:231], v1
v_cvt_pk_bf16_f32 v28, v28, v29
v_cvt_pk_bf16_f32 v29, v30, v31
ds_write_b64 v3, v[28:29] offset:0
s_nop 4
v_cvt_pk_bf16_f32 v32, v32, v33
ds_read_b64_tr_b16 v[28:29], v6 offset:0
v_cvt_pk_bf16_f32 v33, v34, v35
ds_read_b64_tr_b16 v[30:31], v6 offset:32
ds_write_b64 v3, v[32:33] offset:512
s_waitcnt lgkmcnt(4)
v_smfmac_f32_16x16x64_bf16 v[76:79], v[56:59], a[232:239], v1
ds_read_b64_tr_b16 v[34:35], v6 offset:544
v_smfmac_f32_16x16x64_bf16 v[72:75], v[56:59], v[64:71], v1
ds_read_b64_tr_b16 v[32:33], v6 offset:512
ds_read_b128 v[56:59], v4 offset:3072
v_smfmac_f32_16x16x64_bf16 v[76:79], v[48:51], a[248:255], v1
ds_read_b128 v[64:67], v5 offset:18432
v_smfmac_f32_16x16x64_bf16 v[72:75], v[48:51], a[240:247], v1
ds_read_b128 v[68:71], v5 offset:19456
v_smfmac_f32_16x16x64_bf16 v[76:79], v[52:55], v[88:95], v1
ds_read_b128 v[48:51], v4 offset:4096
v_smfmac_f32_16x16x64_bf16 v[72:75], v[52:55], v[80:87], v1
ds_read_b128 v[52:55], v4 offset:5120
s_waitcnt vmcnt(3) lgkmcnt(8)
v_mfma_f32_16x16x32_bf16 v[36:39], v[10:13], v[28:31], 0
ds_read_b128 v[10:13], v5 offset:16384
s_waitcnt vmcnt(2)
v_mfma_f32_16x16x32_bf16 v[40:43], v[14:17], v[28:31], 0
ds_read_b128 v[14:17], v5 offset:17408
s_waitcnt lgkmcnt(7)
v_mfma_f32_16x16x32_bf16 v[44:47], v[32:35], v[28:31], 0
s_nop 3
v_cndmask_b32 v37, v37, v41, s[54:55]
v_cndmask_b32 v38, v38, v42, s[54:55]
v_cndmask_b32 v39, v39, v43, s[54:55]
v_cndmask_b32 v36, v36, v40, s[54:55]
s_waitcnt lgkmcnt(6)
v_smfmac_f32_16x16x64_bf16 v[76:79], v[56:59], v[96:103], v1
ds_write_b128 v9, v[36:39]
v_cndmask_b32 v44, v44, v46, s[54:55]
v_cndmask_b32 v45, v45, v47, s[54:55]
v_and_b32 v9, 8, v1
v_add3_u32 v9, s96, v2, v9
s_waitcnt lgkmcnt(4)
v_smfmac_f32_16x16x64_bf16 v[76:79], v[48:51], v[64:71], v1
s_waitcnt lgkmcnt(3)
v_smfmac_f32_16x16x64_bf16 v[76:79], v[52:55], v[120:127], v1
ds_write_b64 v23, v[44:45] offset:1024
s_mov_b64 exec, s[98:99]
buffer_store_dwordx4 v[32:35], v2, s[4:7], s94 offen sc1
s_mov_b64 exec, -1
s_waitcnt lgkmcnt(2)
v_smfmac_f32_16x16x64_bf16 v[72:75], v[56:59], v[10:17], v1
ds_read_b128 v[14:17], v5 offset:21504
v_smfmac_f32_16x16x64_bf16 v[72:75], v[48:51], v[104:111], v1
ds_read_b128 v[10:13], v5 offset:20480
v_smfmac_f32_16x16x64_bf16 v[72:75], v[52:55], v[112:119], v1
ds_read_b128 v[56:59], v4 offset:6144
s_waitcnt lgkmcnt(3)
s_barrier
ds_read_b128 v[48:51], v4 offset:7168
ds_read_b128 v[68:71], v5 offset:23552
ds_read_b64 v[44:45], v7 offset:10240
ds_read_b64 v[46:47], v7 offset:12032
ds_read_b64 v[60:61], v7 offset:13824
ds_read_b64 v[62:63], v7 offset:15616
ds_read_b128 v[36:39], v4 offset:9216
ds_read_b128 v[40:43], v4 offset:11008
ds_read_b128 v[32:35], v4 offset:14592
s_waitcnt lgkmcnt(9)
v_smfmac_f32_16x16x64_bf16 v[72:75], v[56:59], v[10:17], v1
ds_read_b128 v[28:31], v4 offset:12800
v_smfmac_f32_16x16x64_bf16 v[76:79], v[56:59], v[128:135], v1
ds_read_b128 v[64:67], v5 offset:22528
s_waitcnt lgkmcnt(10)
v_smfmac_f32_16x16x64_bf16 v[72:75], v[48:51], v[136:143], v1
ds_read_b128 v[52:55], v4 offset:8192
v_lshrrev_b32 v56, 1, v4
s_waitcnt lgkmcnt(8)
v_add_f32 v44, v44, v46
v_add_f32 v45, v45, v47
v_mov_b32 v46, 0x3f803f80
v_mov_b32 v47, 0x3f803f80
s_waitcnt lgkmcnt(6)
v_add_f32 v61, v61, v63
v_add_f32 v60, v60, v62
ds_read_b128 v[10:13], v5 offset:28672
s_waitcnt lgkmcnt(5)
v_add_f32 v38, v38, v42
v_add_f32 v36, v36, v40
v_add_f32 v39, v39, v43
v_add_f32 v37, v37, v41
v_add_f32 v40, v44, v60
v_add_f32 v41, v45, v61
v_mov_b32 v44, 0x3f803f80
v_mov_b32 v45, 0x3f803f80
s_waitcnt lgkmcnt(3)
v_add_f32 v30, v30, v34
v_add_f32 v38, v38, v30
v_add_f32 v31, v31, v35
v_add_f32 v28, v28, v32
v_add_f32 v39, v39, v31
s_waitcnt lgkmcnt(2)
v_smfmac_f32_16x16x64_bf16 v[76:79], v[48:51], v[64:71], v1
v_add_f32 v36, v36, v28
v_max3_f32 v43, v39, v40, v41
v_add_f32 v29, v29, v33
v_mov_b32 v28, 0
s_waitcnt lgkmcnt(1)
v_smfmac_f32_16x16x64_bf16 v[72:75], v[52:55], v[144:151], v1
v_add_f32 v37, v37, v29
v_smfmac_f32_16x16x64_bf16 v[76:79], v[52:55], v[152:159], v1
v_max3_f32 v42, v36, v37, v38
v_mov_b32 v29, 0
v_max_f32 v42, v42, v43
v_mov_b32 v32, 0
v_mov_b32 v30, 0
v_max_f32_dpp v42, v42, v42 row_ror:8 row_mask:0xf bank_mask:0xf
v_mov_b32 v33, 0
v_mov_b32 v43, v42
v_mov_b32 v31, 0
v_permlane32_swap_b32 v74, v78
v_permlane16_swap_b32 v42, v43
v_max_f32 v42, v42, v43
v_permlane32_swap_b32 v73, v77
v_mov_b32 v43, v42
v_permlane32_swap_b32 v72, v76
s_nop 0
v_permlane32_swap_b32 v42, v43
v_max_f32 v42, v42, v43
v_add_f32 v74, v74, v78
v_add_f32 v72, v72, v76
v_mul_f32 v42, s47, v42
v_permlane32_swap_b32 v75, v79
v_fma_f32 v36, v36, s47, -v42
v_fma_f32 v37, v37, s47, -v42
v_fma_f32 v39, v39, s47, -v42
v_fma_f32 v40, v40, s47, -v42
v_fma_f32 v41, v41, s47, -v42
v_fma_f32 v38, v38, s47, -v42
v_exp_f32 v37, v37
v_exp_f32 v41, v41
v_exp_f32 v39, v39
v_exp_f32 v36, v36
v_exp_f32 v38, v38
v_exp_f32 v40, v40
v_cvt_pk_bf16_f32 v42, v36, v37
v_cvt_pk_bf16_f32 v40, v40, v41
v_cvt_pk_bf16_f32 v43, v38, v39
v_add_f32 v75, v75, v79
v_add_f32 v73, v73, v77
v_mov_b32_dpp v37, v43 row_ror:8 row_mask:0xf bank_mask:0xf
v_mov_b32_dpp v36, v42 row_ror:8 row_mask:0xf bank_mask:0xf
v_cndmask_b32 v39, v37, v43, s[54:55]
v_cvt_pk_bf16_f32 v23, v74, v75
v_cndmask_b32 v37, v43, v37, s[54:55]
v_cndmask_b32 v38, v36, v42, s[54:55]
v_cndmask_b32 v36, v42, v36, s[54:55]
v_cvt_pk_bf16_f32 v22, v72, v73
v_mov_b32_dpp v28, v40 quad_perm:[0,1,2,3] row_mask:0x3 bank_mask:0x3
s_waitcnt vmcnt(2)
v_mfma_f32_16x16x32_bf16 v[72:75], v[18:21], v[36:39], 0
v_mov_b32_dpp v33, v40 row_ror:8 row_mask:0xc bank_mask:0x3
v_mov_b32_dpp v32, v40 quad_perm:[0,1,2,3] row_mask:0xc bank_mask:0x3
v_mov_b32_dpp v28, v40 row_ror:8 row_mask:0x3 bank_mask:0xc
s_waitcnt vmcnt(1)
v_mfma_f32_16x16x32_bf16 v[76:79], v[24:27], v[36:39], 0
v_mov_b32_dpp v32, v40 row_ror:8 row_mask:0xc bank_mask:0xc
v_mfma_f32_16x16x32_bf16 v[60:63], v[44:47], v[36:39], 0
v_mov_b32_dpp v29, v40 row_ror:8 row_mask:0x3 bank_mask:0x3
v_mov_b32_dpp v33, v40 quad_perm:[0,1,2,3] row_mask:0xc bank_mask:0xc
ds_read_b128 v[48:51], v5 offset:24576
v_mov_b32_dpp v29, v40 quad_perm:[0,1,2,3] row_mask:0x3 bank_mask:0xc
v_mfma_f32_16x16x32_bf16 v[76:79], v[20:23], v[30:33], v[76:79]
ds_read_b128 v[14:17], v5 offset:29696
v_mov_b32 v26, 1792
v_mfma_f32_16x16x32_bf16 v[60:63], v[44:47], v[28:31], v[60:63]
ds_read_b128 v[52:55], v5 offset:25600
v_cndmask_b32 v26, 0, v26, s[54:55]
v_mfma_f32_16x16x32_bf16 v[72:75], v[22:25], v[28:31], v[72:75]
v_add_u32 v26, v26, v2
ds_read_b128 v[64:67], v5 offset:26624
v_mov_b32 v45, 0
s_nop 0
v_rcp_f32 v60, v60
ds_read_b128 v[68:71], v5 offset:27648
v_mov_b32 v46, 0
s_nop 0
v_cndmask_b32 v73, v73, v77, s[54:55]
v_cndmask_b32 v74, v74, v78, s[54:55]
v_mul_f32 v73, v73, v60
v_cndmask_b32 v72, v72, v76, s[54:55]
v_cndmask_b32 v75, v75, v79, s[54:55]
v_mul_f32 v72, v72, v60
v_mul_f32 v75, v75, v60
v_mul_f32 v74, v74, v60
v_cvt_pk_bf16_f32 v72, v72, v73
v_cvt_pk_bf16_f32 v73, v74, v75
v_mov_b32 v47, 0
ds_write_b64 v9, v[72:73] offset:1280
buffer_store_dwordx2 v[22:23], v56, s[4:7], s94 offen offset:2048 sc1
v_mov_b32 v44, 0
v_mov_b32 v31, 0
v_mov_b32 v29, 0
v_mov_b32 v28, 0
v_mov_b32 v30, 0
v_mov_b32 v35, 0
v_mov_b32 v33, 0
v_mov_b32 v34, 0
v_mov_b32 v32, 0
v_mov_b32 v38, 0
v_mov_b32 v36, 0
v_mov_b32 v39, 0
v_mov_b32 v37, 0
v_mov_b32 v42, 0
v_mov_b32 v40, 0
s_waitcnt lgkmcnt(0)
s_barrier
v_mov_b32 v27, s38
v_mov_b32 v43, 0
v_mov_b32 v41, 0
ds_read_b128 v[22:25], v26 offset:14080
ds_read_b128 v[18:21], v26 offset:10496
ds_read_b128 v[72:75], v2 offset:14080
ds_read_b128 v[76:79], v2 offset:15872
ds_read_b128 v[56:59], v2 offset:10496
ds_read_b128 v[60:63], v2 offset:12288
s_waitcnt lgkmcnt(5)
v_smfmac_f32_16x16x64_bf16 v[44:47], v[22:25], v[224:231], v1
s_nop 1
v_mov_b32 v25, s38
s_waitcnt lgkmcnt(4)
v_smfmac_f32_16x16x64_bf16 v[44:47], v[18:21], v[48:55], v1
ds_read_b128 v[48:51], v5 offset:30720
s_waitcnt lgkmcnt(4)
v_smfmac_f32_16x16x64_bf16 v[28:31], v[72:75], v[160:167], v1
ds_read_b128 v[52:55], v5 offset:31744
s_waitcnt lgkmcnt(4)
v_smfmac_f32_16x16x64_bf16 v[28:31], v[76:79], v[168:175], v1
v_mov_b32 v21, s38
s_waitcnt lgkmcnt(3)
v_smfmac_f32_16x16x64_bf16 v[28:31], v[56:59], v[64:71], v1
ds_read_b128 v[64:67], v5 offset:32768
s_waitcnt lgkmcnt(3)
v_smfmac_f32_16x16x64_bf16 v[28:31], v[60:63], v[10:17], v1
ds_read_b128 v[68:71], v5 offset:33792
v_smfmac_f32_16x16x64_bf16 v[32:35], v[72:75], v[176:183], v1
v_permlane32_swap_b32 v44, v46
v_smfmac_f32_16x16x64_bf16 v[32:35], v[76:79], v[184:191], v1
ds_read_b128 v[14:17], v5 offset:35840
v_cvt_pk_bf16_f32 v18, v28, v29
v_smfmac_f32_16x16x64_bf16 v[32:35], v[56:59], v[232:239], v1
ds_read_b128 v[10:13], v5 offset:34816
v_cvt_pk_bf16_f32 v19, v30, v31
v_permlane32_swap_b32 v45, v47
v_add_f32 v44, v44, v46
v_add_f32 v45, v45, v47
v_mov_b32 v47, s38
v_cvt_pk_bf16_f32 v46, v44, v45
s_waitcnt lgkmcnt(4)
v_smfmac_f32_16x16x64_bf16 v[32:35], v[60:63], v[48:55], v1
v_smfmac_f32_16x16x64_bf16 v[36:39], v[72:75], v[192:199], v1
v_smfmac_f32_16x16x64_bf16 v[36:39], v[76:79], v[200:207], v1
v_cvt_pk_bf16_f32 v20, v32, v33
v_cvt_pk_bf16_f32 v22, v34, v35
v_smfmac_f32_16x16x64_bf16 v[36:39], v[56:59], v[240:247], v1
buffer_store_dwordx4 v[18:21], v4, s[4:7], s49 offen offset:0
s_waitcnt lgkmcnt(2)
v_smfmac_f32_16x16x64_bf16 v[36:39], v[60:63], v[64:71], v1
v_smfmac_f32_16x16x64_bf16 v[40:43], v[72:75], v[208:215], v1
v_smfmac_f32_16x16x64_bf16 v[40:43], v[76:79], v[216:223], v1
v_cvt_pk_bf16_f32 v24, v38, v39
v_cvt_pk_bf16_f32 v23, v36, v37
v_smfmac_f32_16x16x64_bf16 v[40:43], v[56:59], v[248:255], v1
buffer_store_dwordx4 v[22:25], v4, s[4:7], s49 offen offset:1024
s_waitcnt lgkmcnt(0)
v_smfmac_f32_16x16x64_bf16 v[40:43], v[60:63], v[10:17], v1
s_nop 7
v_cvt_pk_bf16_f32 v45, v42, v43
v_cvt_pk_bf16_f32 v44, v40, v41
buffer_store_dwordx4 v[44:47], v4, s[4:7], s49 offen offset:2048
s_cmp_eq_u32 s36, 0
s_cbranch_scc1 L_slow1
L_ret1:
v_mov_b32 v55, 0x3f80
v_mov_b32 v54, 0x3f800000
v_cndmask_b32 v55, v55, v54, s[84:85]
v_cndmask_b32 v52, 0, v55, s[56:57]
v_cndmask_b32 v53, 0, v55, s[58:59]
v_cndmask_b32 v54, 0, v55, s[60:61]
v_mov_b32 v55, 0
v_mov_b32 v40, -1
s_add_u32 s44, s52, s97
v_add_u32 v9, s97, v4
v_mov_b32 v28, 0
v_mov_b32 v29, 0
v_mov_b32 v30, 0
v_mov_b32 v31, 0
v_mov_b32 v32, 0
v_mov_b32 v33, 0
v_mov_b32 v34, 0
v_mov_b32 v35, 0
ds_read_b128 v[56:59], v5 offset:0
ds_read_b128 v[60:63], v5 offset:1024
ds_read_b128 v[64:67], v5 offset:2048
ds_read_b128 v[68:71], v5 offset:3072
ds_read_b128 v[72:75], v5 offset:4096
ds_read_b128 v[76:79], v5 offset:5120
s_waitcnt vmcnt(0)
buffer_load_dwordx4 v[10:13], v8, s[4:7], s50 offen sc1
buffer_load_dwordx4 v[14:17], v8, s[4:7], s40 offen sc1
buffer_load_dwordx4 v[18:21], v8, s[4:7], s41 offen sc1
buffer_load_dwordx4 v[22:25], v8, s[4:7], s42 offen sc1
s_mov_b32 s67, s38
s_buffer_atomic_umax s67, s[4:7], s66
s_cmp_eq_u32 s38, 64
s_cbranch_scc1 L_chR_end
L_chR_e1:
s_waitcnt vmcnt(3)
v_mfma_f32_16x16x32_bf16 v[36:39], v[10:13], v[52:55], 0
v_cmp_ne_u32 s[86:87], s38, v13
s_waitcnt vmcnt(2)
v_mfma_f32_16x16x32_bf16 v[36:39], v[14:17], v[52:55], v[36:39]
v_cmp_ne_u32 s[88:89], s38, v17
s_waitcnt vmcnt(1)
v_mfma_f32_16x16x32_bf16 v[36:39], v[18:21], v[52:55], v[36:39]
v_cmp_ne_u32 s[90:91], s38, v21
s_or_b64 vcc, s[86:87], s[88:89]
s_waitcnt vmcnt(0)
v_mfma_f32_16x16x32_bf16 v[36:39], v[22:25], v[52:55], v[36:39]
v_cmp_ne_u32 s[92:93], s38, v25
s_or_b64 vcc, vcc, s[90:91]
s_or_b64 vcc, vcc, s[92:93]
s_cbranch_scc1 L_chR_e1r
s_cmp_lg_u32 s36, 0
s_nop 2
v_permlane32_swap_b32 v36, v38
v_permlane32_swap_b32 v37, v39
v_add_f32 v36, v36, v38
v_add_f32 v37, v37, v39
v_cvt_pk_bf16_f32 v36, v36, v37
v_min_u32 v36, -2, v36
s_cbranch_scc0 L_chR_slow2
buffer_store_dword v36, v0, s[4:7], s52 offen
buffer_store_dword v40, v0, s[4:7], s51 offen
L_chR_back2:
s_add_u32 s48, s48, 24576
s_add_u32 s94, s94, 4096
s_mov_b32 s45, s51
s_mov_b32 s51, s52
s_mov_b32 s52, s53
s_mov_b32 s53, s45
s_add_u32 s38, s38, 1
s_waitcnt vmcnt(0)
buffer_load_dwordx4 v[36:39], v4, s[4:7], s44 offen offset:0 sc1
buffer_load_dwordx4 v[40:43], v4, s[4:7], s44 offen offset:1024 sc1
buffer_load_dwordx4 v[44:47], v4, s[4:7], s44 offen offset:2048 sc1
L_chR_e2:
s_waitcnt vmcnt(2)
ds_write_b128 v9, v[36:39] offset:0
v_max3_u32 v26, v36, v37, v38
v_max_u32 v26, v26, v39
v_cmp_eq_u32 s[86:87], -1, v26
s_waitcnt vmcnt(1)
ds_write_b128 v9, v[40:43] offset:1024
v_max3_u32 v26, v40, v41, v42
v_max_u32 v26, v26, v43
v_cmp_eq_u32 s[88:89], -1, v26
s_waitcnt vmcnt(0)
ds_write_b128 v9, v[44:47] offset:2048
v_max3_u32 v26, v44, v45, v46
v_max_u32 v26, v26, v47
v_cmp_eq_u32 s[90:91], -1, v26
s_or_b64 vcc, s[86:87], s[88:89]
s_or_b64 vcc, vcc, s[90:91]
s_cbranch_scc1 L_chR_e2r
s_branch L_chR_loop
L_chR_end:
s_endpgm
L_ch_P:
s_waitcnt vmcnt(0)
v_and_b32 v0, 3, v0
v_lshlrev_b32 v0, 2, v0
s_lshr_b32 s33, s34, 3
s_mul_i32 s33, s33, 3072
s_add_u32 s33, s33, s50
s_and_b32 s45, s34, 7
s_lshl_b32 s45, s45, 7
s_add_u32 s33, s33, s45
s_add_u32 s33, s33, 2060
L_chp_sp1:
s_buffer_load_dwordx4 s[88:91], s[4:7], s95 glc
s_waitcnt lgkmcnt(0)
s_min_u32 s88, s88, s89
s_min_u32 s88, s88, s90
s_min_u32 s88, s88, s91
s_cmp_ge_u32 s88, s38
s_cbranch_scc1 L_chp_sd2
s_sleep 1
s_sub_u32 s37, s37, 1
s_cbranch_scc0 L_chp_sp1
s_movk_i32 s39, 20
s_branch L_bail
L_chp_sd2:
ds_read_b128 v[56:59], v5 offset:0
ds_read_b128 v[60:63], v5 offset:1024
ds_read_b128 v[64:67], v5 offset:2048
ds_read_b128 v[68:71], v5 offset:3072
ds_read_b128 v[72:75], v5 offset:4096
ds_read_b128 v[76:79], v5 offset:5120
v_mov_b32 v28, 0
v_mov_b32 v29, 0
v_mov_b32 v30, 0
v_mov_b32 v31, 0
v_mov_b32 v32, 0
v_mov_b32 v33, 0
v_mov_b32 v34, 0
v_mov_b32 v35, 0
s_waitcnt vmcnt(0)
L_chP_loop:
s_barrier
s_add_u32 s44, s48, 4096
v_add_u32 v9, s96, v4
v_add_u32 v23, s96, v7
s_add_u32 s43, s48, s65
v_lshlrev_b32 v8, 3, v4
s_sub_u32 s42, s48, 3072
ds_read_b128 v[36:39], v2 offset:0
s_add_u32 s42, s42, 24576
s_add_u32 s41, s42, 8192
ds_read_b128 v[40:43], v2 offset:512
ds_read_b128 v[44:47], v2 offset:1024
ds_read_b128 v[48:51], v2 offset:1536
ds_read_b128 v[52:55], v2 offset:2048
buffer_load_dwordx4 v[10:13], v4, s[4:7], s48 offen sc1
buffer_load_dwordx4 v[14:17], v4, s[4:7], s44 offen sc1
s_waitcnt lgkmcnt(4)
v_smfmac_f32_16x16x64_bf16 v[28:31], v[36:39], v[56:63], v1
ds_read_b128 v[60:63], v5 offset:7168
v_smfmac_f32_16x16x64_bf16 v[32:35], v[36:39], a[88:95], v1
buffer_load_dwordx4 v[18:21], v4, s[4:7], s43 offen offset:0 sc1
s_waitcnt lgkmcnt(4)
v_smfmac_f32_16x16x64_bf16 v[28:31], v[40:43], v[64:71], v1
ds_read_b128 v[36:39], v2 offset:2560
v_smfmac_f32_16x16x64_bf16 v[32:35], v[40:43], a[96:103], v1
buffer_load_dwordx4 v[24:27], v4, s[4:7], s43 offen offset:1024 sc1
ds_read_b128 v[56:59], v5 offset:6144
s_waitcnt lgkmcnt(5)
v_smfmac_f32_16x16x64_bf16 v[28:31], v[44:47], v[72:79], v1
ds_read_b128 v[40:43], v2 offset:3072
v_smfmac_f32_16x16x64_bf16 v[32:35], v[44:47], a[104:111], v1
buffer_load_dword v0, v8, s[4:7], s42 offen sc1
s_waitcnt lgkmcnt(5)
v_smfmac_f32_16x16x64_bf16 v[28:31], v[48:51], a[0:7], v1
buffer_load_dword v0, v8, s[4:7], s41 offen sc1
ds_read_b128 v[44:47], v2 offset:3584
v_smfmac_f32_16x16x64_bf16 v[32:35], v[48:51], a[112:119], v1
ds_read_b128 v[48:51], v2 offset:4096
s_waitcnt lgkmcnt(6)
v_smfmac_f32_16x16x64_bf16 v[28:31], v[52:55], a[8:15], v1
ds_read_b128 v[68:71], v5 offset:9216
v_smfmac_f32_16x16x64_bf16 v[32:35], v[52:55], a[120:127], v1
ds_read_b128 v[52:55], v2 offset:4608
s_waitcnt lgkmcnt(6)
v_smfmac_f32_16x16x64_bf16 v[32:35], v[36:39], a[128:135], v1
ds_read_b128 v[64:67], v5 offset:8192
v_smfmac_f32_16x16x64_bf16 v[28:31], v[36:39], a[16:23], v1
ds_read_b128 v[36:39], v2 offset:5120
s_waitcnt lgkmcnt(6)
v_smfmac_f32_16x16x64_bf16 v[28:31], v[40:43], v[56:63], v1
ds_read_b128 v[76:79], v5 offset:11264
v_smfmac_f32_16x16x64_bf16 v[32:35], v[40:43], a[136:143], v1
ds_read_b128 v[40:43], v2 offset:5632
s_waitcnt lgkmcnt(7)
v_smfmac_f32_16x16x64_bf16 v[32:35], v[44:47], a[144:151], v1
ds_read_b128 v[72:75], v5 offset:10240
v_smfmac_f32_16x16x64_bf16 v[28:31], v[44:47], a[24:31], v1
ds_read_b128 v[44:47], v2 offset:6144
s_waitcnt lgkmcnt(8)
v_smfmac_f32_16x16x64_bf16 v[28:31], v[48:51], a[32:39], v1
ds_read_b128 v[56:59], v5 offset:12288
v_smfmac_f32_16x16x64_bf16 v[32:35], v[48:51], a[152:159], v1
ds_read_b128 v[60:63], v5 offset:13312
s_waitcnt lgkmcnt(8)
v_smfmac_f32_16x16x64_bf16 v[32:35], v[52:55], a[160:167], v1
ds_read_b128 v[48:51], v2 offset:6656
s_waitcnt lgkmcnt(8)
v_smfmac_f32_16x16x64_bf16 v[28:31], v[52:55], v[64:71], v1
ds_read_b128 v[52:55], v2 offset:7168
s_waitcnt lgkmcnt(8)
v_smfmac_f32_16x16x64_bf16 v[28:31], v[36:39], a[40:47], v1
ds_read_b128 v[68:71], v5 offset:15360
v_smfmac_f32_16x16x64_bf16 v[32:35], v[36:39], a[168:175], v1
ds_read_b128 v[36:39], v2 offset:7680
s_waitcnt lgkmcnt(8)
v_smfmac_f32_16x16x64_bf16 v[32:35], v[40:43], a[176:183], v1
ds_read_b128 v[64:67], v5 offset:14336
v_smfmac_f32_16x16x64_bf16 v[28:31], v[40:43], a[48:55], v1
ds_read_b128 v[40:43], v2 offset:8192
s_waitcnt lgkmcnt(8)
v_smfmac_f32_16x16x64_bf16 v[32:35], v[44:47], a[184:191], v1
v_smfmac_f32_16x16x64_bf16 v[28:31], v[44:47], v[72:79], v1
ds_read_b128 v[44:47], v2 offset:8704
s_nop 0
v_mov_b32 v78, 0
v_mov_b32 v72, 0
v_mov_b32 v75, 0
v_mov_b32 v79, 0
s_waitcnt lgkmcnt(6)
v_smfmac_f32_16x16x64_bf16 v[28:31], v[48:51], a[56:63], v1
v_mov_b32 v77, 0
v_smfmac_f32_16x16x64_bf16 v[32:35], v[48:51], a[192:199], v1
ds_read_b128 v[48:51], v4 offset:1024
v_mov_b32 v73, 0
s_waitcnt lgkmcnt(6)
v_smfmac_f32_16x16x64_bf16 v[28:31], v[52:55], a[64:71], v1
v_mov_b32 v76, 0
v_smfmac_f32_16x16x64_bf16 v[32:35], v[52:55], a[200:207], v1
ds_read_b128 v[52:55], v4 offset:2048
v_mov_b32 v74, 0
s_waitcnt lgkmcnt(5)
v_smfmac_f32_16x16x64_bf16 v[28:31], v[36:39], v[56:63], v1
ds_read_b128 v[56:59], v4 offset:0
s_waitcnt lgkmcnt(4)
v_smfmac_f32_16x16x64_bf16 v[28:31], v[40:43], a[72:79], v1
v_smfmac_f32_16x16x64_bf16 v[32:35], v[36:39], a[208:215], v1
s_waitcnt lgkmcnt(3)
v_smfmac_f32_16x16x64_bf16 v[28:31], v[44:47], a[80:87], v1
v_smfmac_f32_16x16x64_bf16 v[32:35], v[40:43], a[216:223], v1
v_smfmac_f32_16x16x64_bf16 v[32:35], v[44:47], a[224:231], v1
v_cvt_pk_bf16_f32 v28, v28, v29
v_cvt_pk_bf16_f32 v29, v30, v31
ds_write_b64 v3, v[28:29] offset:0
s_nop 4
v_cvt_pk_bf16_f32 v32, v32, v33
ds_read_b64_tr_b16 v[28:29], v6 offset:0
v_cvt_pk_bf16_f32 v33, v34, v35
ds_read_b64_tr_b16 v[30:31], v6 offset:32
ds_write_b64 v3, v[32:33] offset:512
s_waitcnt lgkmcnt(4)
v_smfmac_f32_16x16x64_bf16 v[76:79], v[56:59], a[232:239], v1
ds_read_b64_tr_b16 v[34:35], v6 offset:544
v_smfmac_f32_16x16x64_bf16 v[72:75], v[56:59], v[64:71], v1
ds_read_b64_tr_b16 v[32:33], v6 offset:512
ds_read_b128 v[56:59], v4 offset:3072
v_smfmac_f32_16x16x64_bf16 v[76:79], v[48:51], a[248:255], v1
ds_read_b128 v[64:67], v5 offset:18432
v_smfmac_f32_16x16x64_bf16 v[72:75], v[48:51], a[240:247], v1
ds_read_b128 v[68:71], v5 offset:19456
v_smfmac_f32_16x16x64_bf16 v[76:79], v[52:55], v[88:95], v1
ds_read_b128 v[48:51], v4 offset:4096
v_smfmac_f32_16x16x64_bf16 v[72:75], v[52:55], v[80:87], v1
ds_read_b128 v[52:55], v4 offset:5120
s_waitcnt vmcnt(5) lgkmcnt(8)
v_mfma_f32_16x16x32_bf16 v[36:39], v[10:13], v[28:31], 0
ds_read_b128 v[10:13], v5 offset:16384
s_waitcnt vmcnt(4)
v_mfma_f32_16x16x32_bf16 v[40:43], v[14:17], v[28:31], 0
ds_read_b128 v[14:17], v5 offset:17408
s_waitcnt lgkmcnt(7)
v_mfma_f32_16x16x32_bf16 v[44:47], v[32:35], v[28:31], 0
s_nop 3
v_cndmask_b32 v37, v37, v41, s[54:55]
v_cndmask_b32 v38, v38, v42, s[54:55]
v_cndmask_b32 v39, v39, v43, s[54:55]
v_cndmask_b32 v36, v36, v40, s[54:55]
s_waitcnt lgkmcnt(6)
v_smfmac_f32_16x16x64_bf16 v[76:79], v[56:59], v[96:103], v1
ds_write_b128 v9, v[36:39]
v_cndmask_b32 v44, v44, v46, s[54:55]
v_cndmask_b32 v45, v45, v47, s[54:55]
v_and_b32 v9, 8, v1
v_add3_u32 v9, s96, v2, v9
s_waitcnt lgkmcnt(4)
v_smfmac_f32_16x16x64_bf16 v[76:79], v[48:51], v[64:71], v1
s_waitcnt lgkmcnt(3)
v_smfmac_f32_16x16x64_bf16 v[76:79], v[52:55], v[120:127], v1
ds_write_b64 v23, v[44:45] offset:1024
s_mov_b64 exec, s[98:99]
buffer_store_dwordx4 v[32:35], v2, s[4:7], s94 offen sc1
s_mov_b64 exec, -1
s_waitcnt lgkmcnt(2)
v_smfmac_f32_16x16x64_bf16 v[72:75], v[56:59], v[10:17], v1
ds_read_b128 v[14:17], v5 offset:21504
v_smfmac_f32_16x16x64_bf16 v[72:75], v[48:51], v[104:111], v1
ds_read_b128 v[10:13], v5 offset:20480
v_smfmac_f32_16x16x64_bf16 v[72:75], v[52:55], v[112:119], v1
ds_read_b128 v[56:59], v4 offset:6144
s_waitcnt lgkmcnt(3)
s_barrier
ds_read_b128 v[48:51], v4 offset:7168
ds_read_b128 v[68:71], v5 offset:23552
ds_read_b64 v[44:45], v7 offset:10240
ds_read_b64 v[46:47], v7 offset:12032
ds_read_b64 v[60:61], v7 offset:13824
ds_read_b64 v[62:63], v7 offset:15616
ds_read_b128 v[36:39], v4 offset:9216
ds_read_b128 v[40:43], v4 offset:11008
ds_read_b128 v[32:35], v4 offset:14592
s_waitcnt lgkmcnt(9)
v_smfmac_f32_16x16x64_bf16 v[72:75], v[56:59], v[10:17], v1
ds_read_b128 v[28:31], v4 offset:12800
v_smfmac_f32_16x16x64_bf16 v[76:79], v[56:59], v[128:135], v1
ds_read_b128 v[64:67], v5 offset:22528
s_waitcnt lgkmcnt(10)
v_smfmac_f32_16x16x64_bf16 v[72:75], v[48:51], v[136:143], v1
ds_read_b128 v[52:55], v4 offset:8192
v_lshrrev_b32 v56, 1, v4
s_waitcnt lgkmcnt(8)
v_add_f32 v44, v44, v46
v_add_f32 v45, v45, v47
v_mov_b32 v46, 0x3f803f80
v_mov_b32 v47, 0x3f803f80
s_waitcnt lgkmcnt(6)
v_add_f32 v61, v61, v63
v_add_f32 v60, v60, v62
ds_read_b128 v[10:13], v5 offset:28672
s_waitcnt lgkmcnt(5)
v_add_f32 v38, v38, v42
v_add_f32 v36, v36, v40
v_add_f32 v39, v39, v43
v_add_f32 v37, v37, v41
v_add_f32 v40, v44, v60
v_add_f32 v41, v45, v61
v_mov_b32 v44, 0x3f803f80
v_mov_b32 v45, 0x3f803f80
s_waitcnt lgkmcnt(3)
v_add_f32 v30, v30, v34
v_add_f32 v38, v38, v30
v_add_f32 v31, v31, v35
v_add_f32 v28, v28, v32
v_add_f32 v39, v39, v31
s_waitcnt lgkmcnt(2)
v_smfmac_f32_16x16x64_bf16 v[76:79], v[48:51], v[64:71], v1
v_add_f32 v36, v36, v28
v_max3_f32 v43, v39, v40, v41
v_add_f32 v29, v29, v33
v_mov_b32 v28, 0
s_waitcnt lgkmcnt(1)
v_smfmac_f32_16x16x64_bf16 v[72:75], v[52:55], v[144:151], v1
v_add_f32 v37, v37, v29
v_smfmac_f32_16x16x64_bf16 v[76:79], v[52:55], v[152:159], v1
v_max3_f32 v42, v36, v37, v38
v_mov_b32 v29, 0
v_max_f32 v42, v42, v43
v_mov_b32 v32, 0
v_mov_b32 v30, 0
v_max_f32_dpp v42, v42, v42 row_ror:8 row_mask:0xf bank_mask:0xf
v_mov_b32 v33, 0
v_mov_b32 v43, v42
v_mov_b32 v31, 0
v_permlane32_swap_b32 v74, v78
v_permlane16_swap_b32 v42, v43
v_max_f32 v42, v42, v43
v_permlane32_swap_b32 v73, v77
v_mov_b32 v43, v42
v_permlane32_swap_b32 v72, v76
s_nop 0
v_permlane32_swap_b32 v42, v43
v_max_f32 v42, v42, v43
v_add_f32 v74, v74, v78
v_add_f32 v72, v72, v76
v_mul_f32 v42, s47, v42
v_permlane32_swap_b32 v75, v79
v_fma_f32 v36, v36, s47, -v42
v_fma_f32 v37, v37, s47, -v42
v_fma_f32 v39, v39, s47, -v42
v_fma_f32 v40, v40, s47, -v42
v_fma_f32 v41, v41, s47, -v42
v_fma_f32 v38, v38, s47, -v42
v_exp_f32 v37, v37
v_exp_f32 v41, v41
v_exp_f32 v39, v39
v_exp_f32 v36, v36
v_exp_f32 v38, v38
v_exp_f32 v40, v40
v_cvt_pk_bf16_f32 v42, v36, v37
v_cvt_pk_bf16_f32 v40, v40, v41
v_cvt_pk_bf16_f32 v43, v38, v39
v_add_f32 v75, v75, v79
v_add_f32 v73, v73, v77
v_mov_b32_dpp v37, v43 row_ror:8 row_mask:0xf bank_mask:0xf
v_mov_b32_dpp v36, v42 row_ror:8 row_mask:0xf bank_mask:0xf
v_cndmask_b32 v39, v37, v43, s[54:55]
v_cvt_pk_bf16_f32 v23, v74, v75
v_cndmask_b32 v37, v43, v37, s[54:55]
v_cndmask_b32 v38, v36, v42, s[54:55]
v_cndmask_b32 v36, v42, v36, s[54:55]
v_cvt_pk_bf16_f32 v22, v72, v73
v_mov_b32_dpp v28, v40 quad_perm:[0,1,2,3] row_mask:0x3 bank_mask:0x3
s_waitcnt vmcnt(4)
v_mfma_f32_16x16x32_bf16 v[72:75], v[18:21], v[36:39], 0
v_mov_b32_dpp v33, v40 row_ror:8 row_mask:0xc bank_mask:0x3
v_mov_b32_dpp v32, v40 quad_perm:[0,1,2,3] row_mask:0xc bank_mask:0x3
v_mov_b32_dpp v28, v40 row_ror:8 row_mask:0x3 bank_mask:0xc
s_waitcnt vmcnt(3)
v_mfma_f32_16x16x32_bf16 v[76:79], v[24:27], v[36:39], 0
v_mov_b32_dpp v32, v40 row_ror:8 row_mask:0xc bank_mask:0xc
v_mfma_f32_16x16x32_bf16 v[60:63], v[44:47], v[36:39], 0
v_mov_b32_dpp v29, v40 row_ror:8 row_mask:0x3 bank_mask:0x3
v_mov_b32_dpp v33, v40 quad_perm:[0,1,2,3] row_mask:0xc bank_mask:0xc
ds_read_b128 v[48:51], v5 offset:24576
v_mov_b32_dpp v29, v40 quad_perm:[0,1,2,3] row_mask:0x3 bank_mask:0xc
v_mfma_f32_16x16x32_bf16 v[76:79], v[20:23], v[30:33], v[76:79]
ds_read_b128 v[14:17], v5 offset:29696
v_mov_b32 v26, 1792
v_mfma_f32_16x16x32_bf16 v[60:63], v[44:47], v[28:31], v[60:63]
ds_read_b128 v[52:55], v5 offset:25600
v_cndmask_b32 v26, 0, v26, s[54:55]
v_mfma_f32_16x16x32_bf16 v[72:75], v[22:25], v[28:31], v[72:75]
v_add_u32 v26, v26, v2
ds_read_b128 v[64:67], v5 offset:26624
v_mov_b32 v45, 0
s_nop 0
v_rcp_f32 v60, v60
ds_read_b128 v[68:71], v5 offset:27648
v_mov_b32 v46, 0
s_nop 0
v_cndmask_b32 v73, v73, v77, s[54:55]
v_cndmask_b32 v74, v74, v78, s[54:55]
v_mul_f32 v73, v73, v60
v_cndmask_b32 v72, v72, v76, s[54:55]
v_cndmask_b32 v75, v75, v79, s[54:55]
v_mul_f32 v72, v72, v60
v_mul_f32 v75, v75, v60
v_mul_f32 v74, v74, v60
v_cvt_pk_bf16_f32 v72, v72, v73
v_cvt_pk_bf16_f32 v73, v74, v75
v_mov_b32 v47, 0
ds_write_b64 v9, v[72:73] offset:1280
buffer_store_dwordx2 v[22:23], v56, s[4:7], s94 offen offset:2048 sc1
v_mov_b32 v44, 0
v_mov_b32 v31, 0
v_mov_b32 v29, 0
v_mov_b32 v28, 0
v_mov_b32 v30, 0
v_mov_b32 v35, 0
v_mov_b32 v33, 0
v_mov_b32 v34, 0
v_mov_b32 v32, 0
v_mov_b32 v38, 0
v_mov_b32 v36, 0
v_mov_b32 v39, 0
v_mov_b32 v37, 0
v_mov_b32 v42, 0
v_mov_b32 v40, 0
s_waitcnt lgkmcnt(0)
s_barrier
v_mov_b32 v27, s38
v_mov_b32 v43, 0
v_mov_b32 v41, 0
ds_read_b128 v[22:25], v26 offset:14080
ds_read_b128 v[18:21], v26 offset:10496
ds_read_b128 v[72:75], v2 offset:14080
ds_read_b128 v[76:79], v2 offset:15872
ds_read_b128 v[56:59], v2 offset:10496
ds_read_b128 v[60:63], v2 offset:12288
s_waitcnt lgkmcnt(5)
v_smfmac_f32_16x16x64_bf16 v[44:47], v[22:25], v[224:231], v1
s_nop 1
v_mov_b32 v25, s38
s_waitcnt lgkmcnt(4)
v_smfmac_f32_16x16x64_bf16 v[44:47], v[18:21], v[48:55], v1
ds_read_b128 v[48:51], v5 offset:30720
s_waitcnt lgkmcnt(4)
v_smfmac_f32_16x16x64_bf16 v[28:31], v[72:75], v[160:167], v1
ds_read_b128 v[52:55], v5 offset:31744
s_waitcnt lgkmcnt(4)
v_smfmac_f32_16x16x64_bf16 v[28:31], v[76:79], v[168:175], v1
v_mov_b32 v21, s38
s_waitcnt lgkmcnt(3)
v_smfmac_f32_16x16x64_bf16 v[28:31], v[56:59], v[64:71], v1
ds_read_b128 v[64:67], v5 offset:32768
s_waitcnt lgkmcnt(3)
v_smfmac_f32_16x16x64_bf16 v[28:31], v[60:63], v[10:17], v1
ds_read_b128 v[68:71], v5 offset:33792
v_smfmac_f32_16x16x64_bf16 v[32:35], v[72:75], v[176:183], v1
v_permlane32_swap_b32 v44, v46
v_smfmac_f32_16x16x64_bf16 v[32:35], v[76:79], v[184:191], v1
ds_read_b128 v[14:17], v5 offset:35840
v_cvt_pk_bf16_f32 v18, v28, v29
v_smfmac_f32_16x16x64_bf16 v[32:35], v[56:59], v[232:239], v1
ds_read_b128 v[10:13], v5 offset:34816
v_cvt_pk_bf16_f32 v19, v30, v31
v_permlane32_swap_b32 v45, v47
v_add_f32 v44, v44, v46
v_add_f32 v45, v45, v47
v_mov_b32 v47, s38
v_cvt_pk_bf16_f32 v46, v44, v45
s_waitcnt lgkmcnt(4)
v_smfmac_f32_16x16x64_bf16 v[32:35], v[60:63], v[48:55], v1
v_smfmac_f32_16x16x64_bf16 v[36:39], v[72:75], v[192:199], v1
v_smfmac_f32_16x16x64_bf16 v[36:39], v[76:79], v[200:207], v1
v_cvt_pk_bf16_f32 v20, v32, v33
v_cvt_pk_bf16_f32 v22, v34, v35
v_smfmac_f32_16x16x64_bf16 v[36:39], v[56:59], v[240:247], v1
buffer_store_dwordx4 v[18:21], v4, s[4:7], s49 offen offset:0
s_waitcnt lgkmcnt(2)
v_smfmac_f32_16x16x64_bf16 v[36:39], v[60:63], v[64:71], v1
v_smfmac_f32_16x16x64_bf16 v[40:43], v[72:75], v[208:215], v1
v_smfmac_f32_16x16x64_bf16 v[40:43], v[76:79], v[216:223], v1
v_cvt_pk_bf16_f32 v24, v38, v39
v_cvt_pk_bf16_f32 v23, v36, v37
v_smfmac_f32_16x16x64_bf16 v[40:43], v[56:59], v[248:255], v1
buffer_store_dwordx4 v[22:25], v4, s[4:7], s49 offen offset:1024
s_waitcnt lgkmcnt(0)
v_smfmac_f32_16x16x64_bf16 v[40:43], v[60:63], v[10:17], v1
s_nop 7
v_cvt_pk_bf16_f32 v45, v42, v43
v_cvt_pk_bf16_f32 v44, v40, v41
buffer_store_dwordx4 v[44:47], v4, s[4:7], s49 offen offset:2048
s_cmp_eq_u32 s36, 0
s_cbranch_scc1 L_slow2
L_ret2:
v_mul_u32_u24 v14, 1536, v7
v_lshlrev_b32 v15, 3, v7
s_mul_i32 s40, s38, 0x10101
s_mov_b64 exec, 0xffffffff
s_mov_b64 exec, -1
s_waitcnt vmcnt(3)
s_mov_b32 s67, s38
s_buffer_atomic_umax s67, s[4:7], s66
s_cmp_eq_u32 s38, 64
s_cbranch_scc1 L_chP_end
s_add_u32 s48, s48, 24576
s_add_u32 s94, s94, 4096
s_mov_b32 s45, s51
s_mov_b32 s51, s52
s_mov_b32 s52, s53
s_mov_b32 s53, s45
s_add_u32 s38, s38, 1
ds_read_b128 v[56:59], v5 offset:0
ds_read_b128 v[60:63], v5 offset:1024
ds_read_b128 v[64:67], v5 offset:2048
ds_read_b128 v[68:71], v5 offset:3072
ds_read_b128 v[72:75], v5 offset:4096
ds_read_b128 v[76:79], v5 offset:5120
v_mov_b32 v28, 0
v_mov_b32 v29, 0
v_mov_b32 v30, 0
v_mov_b32 v31, 0
v_mov_b32 v32, 0
v_mov_b32 v33, 0
v_mov_b32 v34, 0
v_mov_b32 v35, 0
s_mov_b64 exec, 0xffffffff
s_mov_b64 exec, -1
L_chp_sp3:
s_buffer_load_dwordx4 s[88:91], s[4:7], s95 glc
s_waitcnt lgkmcnt(0)
s_min_u32 s88, s88, s89
s_min_u32 s88, s88, s90
s_min_u32 s88, s88, s91
s_cmp_ge_u32 s88, s38
s_cbranch_scc1 L_chp_sd4
s_sleep 1
s_sub_u32 s37, s37, 1
s_cbranch_scc0 L_chp_sp3
s_movk_i32 s39, 21
s_branch L_bail
L_chp_sd4:
s_branch L_chP_loop
L_chP_end:
s_endpgm
L_slow1:
buffer_store_dwordx4 v[18:21], v4, s[4:7], s49 offen offset:0 sc1
buffer_store_dwordx4 v[22:25], v4, s[4:7], s49 offen offset:1024 sc1
buffer_store_dwordx4 v[44:47], v4, s[4:7], s49 offen offset:2048 sc1
s_waitcnt vmcnt(0)
s_branch L_ret1
L_chR_e1r:
s_or_b64 exec, s[86:87], 1
buffer_load_dwordx4 v[10:13], v8, s[4:7], s50 offen sc1
s_or_b64 exec, s[88:89], 1
buffer_load_dwordx4 v[14:17], v8, s[4:7], s40 offen sc1
s_or_b64 exec, s[90:91], 1
buffer_load_dwordx4 v[18:21], v8, s[4:7], s41 offen sc1
s_or_b64 exec, s[92:93], 1
buffer_load_dwordx4 v[22:25], v8, s[4:7], s42 offen sc1
s_mov_b64 exec, -1
s_waitcnt vmcnt(0)
s_sub_u32 s37, s37, 1
s_cbranch_scc0 L_chR_e1
s_movk_i32 s39, 18
s_branch L_bail
L_chR_e2r:
s_or_b64 exec, s[86:87], 1
buffer_load_dwordx4 v[36:39], v4, s[4:7], s44 offen offset:0 sc1
s_or_b64 exec, s[88:89], 1
buffer_load_dwordx4 v[40:43], v4, s[4:7], s44 offen offset:1024 sc1
s_or_b64 exec, s[90:91], 1
buffer_load_dwordx4 v[44:47], v4, s[4:7], s44 offen offset:2048 sc1
s_mov_b64 exec, -1
s_waitcnt vmcnt(0)
s_sub_u32 s37, s37, 1
s_cbranch_scc0 L_chR_e2
s_movk_i32 s39, 19
s_branch L_bail
L_chR_slow2:
buffer_store_dword v36, v0, s[4:7], s52 offen sc1
buffer_store_dword v40, v0, s[4:7], s51 offen sc1
s_branch L_chR_back2
L_slow2:
buffer_store_dwordx4 v[18:21], v4, s[4:7], s49 offen offset:0 sc1
buffer_store_dwordx4 v[22:25], v4, s[4:7], s49 offen offset:1024 sc1
buffer_store_dwordx4 v[44:47], v4, s[4:7], s49 offen offset:2048 sc1
s_waitcnt vmcnt(0)
s_branch L_ret2
L_CH_end:
.p2align 6
L_KV:
s_getpc_b64 s[40:41]
L_KV_pc:
v_lshl_add_u32 v2, s35, 6, v0
v_lshlrev_b32 v2, 7, v2
v_min_u32 v3, L_KV_end-L_KV_pc-4, v2
global_load_dword a255, v3, s[40:41]
v_add_u32 v2, 0x8000, v2
v_min_u32 v3, L_KV_end-L_KV_pc-4, v2
global_load_dword a255, v3, s[40:41]
s_mov_b32 s8, s70
s_and_b32 s9, s71, 0xffff
s_mov_b32 s10, 4718592
s_mov_b32 s11, 0x20000
s_mov_b32 s12, s72
s_and_b32 s13, s73, 0xffff
s_mov_b32 s14, 4718592
s_mov_b32 s15, 0x20000
s_mov_b32 s16, s68
s_and_b32 s17, s69, 0xffff
s_mov_b32 s18, 4718592
s_mov_b32 s19, 0x20000
s_lshl_b32 s46, s34, 8
v_bfe_u32 v8, v0, 4, 1
v_lshlrev_b32 v8, 3, v8
v_bfe_u32 v9, v0, 2, 2
v_add_u32 v8, v8, v9
v_mul_u32_u24 v8, 1056, v8
v_lshrrev_b32 v9, 5, v0
v_lshl_add_u32 v8, v9, 8, v8
v_and_b32 v9, 3, v0
v_lshl_add_u32 v8, v9, 3, v8
v_lshl_add_u32 v8, s35, 6, v8
v_add_u32 v9, 50688, v8
v_add_u32 v10, 101376, v8
s_mul_i32 s45, s35, 4224
v_lshrrev_b32 v11, 4, v0
v_lshlrev_b32 v11, 2, v11
v_add_u32 v11, s35, v11
v_mul_u32_u24 v11, 32768, v11
v_and_b32 v14, 15, v0
v_lshl_add_u32 v11, v14, 4, v11
v_add_u32 v11, s46, v11
v_lshrrev_b32 v12, 4, v0
v_lshlrev_b32 v12, 2, v12
v_add_u32 v12, s35, v12
v_mul_u32_u24 v12, 32768, v12
v_and_b32 v14, 15, v0
v_lshl_add_u32 v12, v14, 4, v12
v_add_u32 v12, s46, v12
v_lshrrev_b32 v13, 4, v0
v_lshlrev_b32 v13, 2, v13
v_add_u32 v13, s35, v13
v_mul_u32_u24 v13, 32768, v13
v_and_b32 v14, 15, v0
v_lshl_add_u32 v13, v14, 4, v13
v_add_u32 v13, s46, v13
s_mov_b32 s44, 0
s_add_u32 m0, s45, 0
s_nop 0
buffer_load_dwordx4 v11, s[8:11], s44 offen offset:0 lds
s_mov_b32 s44, 8192
s_add_u32 m0, s45, 1056
s_nop 0
buffer_load_dwordx4 v11, s[8:11], s44 offen offset:0 lds
s_mov_b32 s44, 16384
s_add_u32 m0, s45, 2112
s_nop 0
buffer_load_dwordx4 v11, s[8:11], s44 offen offset:0 lds
s_mov_b32 s44, 24576
s_add_u32 m0, s45, 3168
s_nop 0
buffer_load_dwordx4 v11, s[8:11], s44 offen offset:0 lds
s_mov_b32 s44, 524288
s_add_u32 m0, s45, 16896
s_nop 0
buffer_load_dwordx4 v11, s[8:11], s44 offen offset:0 lds
s_mov_b32 s44, 532480
s_add_u32 m0, s45, 17952
s_nop 0
buffer_load_dwordx4 v11, s[8:11], s44 offen offset:0 lds
s_mov_b32 s44, 540672
s_add_u32 m0, s45, 19008
s_nop 0
buffer_load_dwordx4 v11, s[8:11], s44 offen offset:0 lds
s_mov_b32 s44, 548864
s_add_u32 m0, s45, 20064
s_nop 0
buffer_load_dwordx4 v11, s[8:11], s44 offen offset:0 lds
s_mov_b32 s44, 1048576
s_add_u32 m0, s45, 33792
s_nop 0
buffer_load_dwordx4 v11, s[8:11], s44 offen offset:0 lds
s_mov_b32 s44, 1056768
s_add_u32 m0, s45, 34848
s_nop 0
buffer_load_dwordx4 v11, s[8:11], s44 offen offset:0 lds
s_mov_b32 s44, 1064960
s_add_u32 m0, s45, 35904
s_nop 0
buffer_load_dwordx4 v11, s[8:11], s44 offen offset:0 lds
s_mov_b32 s44, 1073152
s_add_u32 m0, s45, 36960
s_nop 0
buffer_load_dwordx4 v11, s[8:11], s44 offen offset:0 lds
s_mov_b32 s44, 1572864
s_add_u32 m0, s45, 50688
s_nop 0
buffer_load_dwordx4 v11, s[8:11], s44 offen offset:0 lds
s_mov_b32 s44, 1581056
s_add_u32 m0, s45, 51744
s_nop 0
buffer_load_dwordx4 v11, s[8:11], s44 offen offset:0 lds
s_mov_b32 s44, 1589248
s_add_u32 m0, s45, 52800
s_nop 0
buffer_load_dwordx4 v11, s[8:11], s44 offen offset:0 lds
s_mov_b32 s44, 1597440
s_add_u32 m0, s45, 53856
s_nop 0
buffer_load_dwordx4 v11, s[8:11], s44 offen offset:0 lds
s_mov_b32 s44, 2097152
s_add_u32 m0, s45, 67584
s_nop 0
buffer_load_dwordx4 v11, s[8:11], s44 offen offset:0 lds
s_mov_b32 s44, 2105344
s_add_u32 m0, s45, 68640
s_nop 0
buffer_load_dwordx4 v11, s[8:11], s44 offen offset:0 lds
s_mov_b32 s44, 2113536
s_add_u32 m0, s45, 69696
s_nop 0
buffer_load_dwordx4 v11, s[8:11], s44 offen offset:0 lds
s_mov_b32 s44, 2121728
s_add_u32 m0, s45, 70752
s_nop 0
buffer_load_dwordx4 v11, s[8:11], s44 offen offset:0 lds
s_mov_b32 s44, 2621440
s_add_u32 m0, s45, 84480
s_nop 0
buffer_load_dwordx4 v11, s[8:11], s44 offen offset:0 lds
s_mov_b32 s44, 2629632
s_add_u32 m0, s45, 85536
s_nop 0
buffer_load_dwordx4 v11, s[8:11], s44 offen offset:0 lds
s_mov_b32 s44, 2637824
s_add_u32 m0, s45, 86592
s_nop 0
buffer_load_dwordx4 v11, s[8:11], s44 offen offset:0 lds
s_mov_b32 s44, 2646016
s_add_u32 m0, s45, 87648
s_nop 0
buffer_load_dwordx4 v11, s[8:11], s44 offen offset:0 lds
s_mov_b32 s44, 3145728
s_add_u32 m0, s45, 101376
s_nop 0
buffer_load_dwordx4 v11, s[8:11], s44 offen offset:0 lds
s_mov_b32 s44, 3153920
s_add_u32 m0, s45, 102432
s_nop 0
buffer_load_dwordx4 v11, s[8:11], s44 offen offset:0 lds
s_mov_b32 s44, 3162112
s_add_u32 m0, s45, 103488
s_nop 0
buffer_load_dwordx4 v11, s[8:11], s44 offen offset:0 lds
s_mov_b32 s44, 3170304
s_add_u32 m0, s45, 104544
s_nop 0
buffer_load_dwordx4 v11, s[8:11], s44 offen offset:0 lds
s_mov_b32 s44, 3670016
s_add_u32 m0, s45, 118272
s_nop 0
buffer_load_dwordx4 v11, s[8:11], s44 offen offset:0 lds
s_mov_b32 s44, 3678208
s_add_u32 m0, s45, 119328
s_nop 0
buffer_load_dwordx4 v11, s[8:11], s44 offen offset:0 lds
s_mov_b32 s44, 3686400
s_add_u32 m0, s45, 120384
s_nop 0
buffer_load_dwordx4 v11, s[8:11], s44 offen offset:0 lds
s_mov_b32 s44, 3694592
s_add_u32 m0, s45, 121440
s_nop 0
buffer_load_dwordx4 v11, s[8:11], s44 offen offset:0 lds
s_mov_b32 s44, 4194304
s_add_u32 m0, s45, 135168
s_nop 0
buffer_load_dwordx4 v11, s[8:11], s44 offen offset:0 lds
s_mov_b32 s44, 4202496
s_add_u32 m0, s45, 136224
s_nop 0
buffer_load_dwordx4 v11, s[8:11], s44 offen offset:0 lds
s_mov_b32 s44, 4210688
s_add_u32 m0, s45, 137280
s_nop 0
buffer_load_dwordx4 v11, s[8:11], s44 offen offset:0 lds
s_mov_b32 s44, 4218880
s_add_u32 m0, s45, 138336
s_nop 0
buffer_load_dwordx4 v11, s[8:11], s44 offen offset:0 lds
s_waitcnt vmcnt(24)
s_barrier
ds_read_b64_tr_b16 a[0:1], v8 offset:0
ds_read_b64_tr_b16 a[2:3], v8 offset:4224
ds_read_b64_tr_b16 a[4:5], v8 offset:32
ds_read_b64_tr_b16 a[6:7], v8 offset:4256
ds_read_b64_tr_b16 a[8:9], v8 offset:512
ds_read_b64_tr_b16 a[10:11], v8 offset:4736
ds_read_b64_tr_b16 a[12:13], v8 offset:544
ds_read_b64_tr_b16 a[14:15], v8 offset:4768
ds_read_b64_tr_b16 a[16:17], v8 offset:16896
ds_read_b64_tr_b16 a[18:19], v8 offset:21120
ds_read_b64_tr_b16 a[20:21], v8 offset:16928
ds_read_b64_tr_b16 a[22:23], v8 offset:21152
ds_read_b64_tr_b16 a[24:25], v8 offset:17408
ds_read_b64_tr_b16 a[26:27], v8 offset:21632
ds_read_b64_tr_b16 a[28:29], v8 offset:17440
ds_read_b64_tr_b16 a[30:31], v8 offset:21664
ds_read_b64_tr_b16 a[32:33], v8 offset:33792
ds_read_b64_tr_b16 a[34:35], v8 offset:38016
ds_read_b64_tr_b16 a[36:37], v8 offset:33824
ds_read_b64_tr_b16 a[38:39], v8 offset:38048
ds_read_b64_tr_b16 a[40:41], v8 offset:34304
ds_read_b64_tr_b16 a[42:43], v8 offset:38528
ds_read_b64_tr_b16 a[44:45], v8 offset:34336
ds_read_b64_tr_b16 a[46:47], v8 offset:38560
s_waitcnt lgkmcnt(0)
s_barrier
s_mov_b32 s44, 0
s_add_u32 m0, s45, 0
s_nop 0
buffer_load_dwordx4 v12, s[12:15], s44 offen offset:0 lds
s_mov_b32 s44, 8192
s_add_u32 m0, s45, 1056
s_nop 0
buffer_load_dwordx4 v12, s[12:15], s44 offen offset:0 lds
s_mov_b32 s44, 16384
s_add_u32 m0, s45, 2112
s_nop 0
buffer_load_dwordx4 v12, s[12:15], s44 offen offset:0 lds
s_mov_b32 s44, 24576
s_add_u32 m0, s45, 3168
s_nop 0
buffer_load_dwordx4 v12, s[12:15], s44 offen offset:0 lds
s_mov_b32 s44, 524288
s_add_u32 m0, s45, 16896
s_nop 0
buffer_load_dwordx4 v12, s[12:15], s44 offen offset:0 lds
s_mov_b32 s44, 532480
s_add_u32 m0, s45, 17952
s_nop 0
buffer_load_dwordx4 v12, s[12:15], s44 offen offset:0 lds
s_mov_b32 s44, 540672
s_add_u32 m0, s45, 19008
s_nop 0
buffer_load_dwordx4 v12, s[12:15], s44 offen offset:0 lds
s_mov_b32 s44, 548864
s_add_u32 m0, s45, 20064
s_nop 0
buffer_load_dwordx4 v12, s[12:15], s44 offen offset:0 lds
s_mov_b32 s44, 1048576
s_add_u32 m0, s45, 33792
s_nop 0
buffer_load_dwordx4 v12, s[12:15], s44 offen offset:0 lds
s_mov_b32 s44, 1056768
s_add_u32 m0, s45, 34848
s_nop 0
buffer_load_dwordx4 v12, s[12:15], s44 offen offset:0 lds
s_mov_b32 s44, 1064960
s_add_u32 m0, s45, 35904
s_nop 0
buffer_load_dwordx4 v12, s[12:15], s44 offen offset:0 lds
s_mov_b32 s44, 1073152
s_add_u32 m0, s45, 36960
s_nop 0
buffer_load_dwordx4 v12, s[12:15], s44 offen offset:0 lds
s_waitcnt vmcnt(24)
s_barrier
ds_read_b64_tr_b16 a[48:49], v9 offset:0
ds_read_b64_tr_b16 a[50:51], v9 offset:4224
ds_read_b64_tr_b16 a[52:53], v9 offset:32
ds_read_b64_tr_b16 a[54:55], v9 offset:4256
ds_read_b64_tr_b16 a[56:57], v9 offset:512
ds_read_b64_tr_b16 a[58:59], v9 offset:4736
ds_read_b64_tr_b16 a[60:61], v9 offset:544
ds_read_b64_tr_b16 a[62:63], v9 offset:4768
ds_read_b64_tr_b16 a[64:65], v9 offset:16896
ds_read_b64_tr_b16 a[66:67], v9 offset:21120
ds_read_b64_tr_b16 a[68:69], v9 offset:16928
ds_read_b64_tr_b16 a[70:71], v9 offset:21152
ds_read_b64_tr_b16 a[72:73], v9 offset:17408
ds_read_b64_tr_b16 a[74:75], v9 offset:21632
ds_read_b64_tr_b16 a[76:77], v9 offset:17440
ds_read_b64_tr_b16 a[78:79], v9 offset:21664
ds_read_b64_tr_b16 a[80:81], v9 offset:33792
ds_read_b64_tr_b16 a[82:83], v9 offset:38016
ds_read_b64_tr_b16 a[84:85], v9 offset:33824
ds_read_b64_tr_b16 a[86:87], v9 offset:38048
ds_read_b64_tr_b16 a[88:89], v9 offset:34304
ds_read_b64_tr_b16 a[90:91], v9 offset:38528
ds_read_b64_tr_b16 a[92:93], v9 offset:34336
ds_read_b64_tr_b16 a[94:95], v9 offset:38560
s_waitcnt lgkmcnt(0)
s_barrier
s_mov_b32 s44, 1572864
s_add_u32 m0, s45, 50688
s_nop 0
buffer_load_dwordx4 v12, s[12:15], s44 offen offset:0 lds
s_mov_b32 s44, 1581056
s_add_u32 m0, s45, 51744
s_nop 0
buffer_load_dwordx4 v12, s[12:15], s44 offen offset:0 lds
s_mov_b32 s44, 1589248
s_add_u32 m0, s45, 52800
s_nop 0
buffer_load_dwordx4 v12, s[12:15], s44 offen offset:0 lds
s_mov_b32 s44, 1597440
s_add_u32 m0, s45, 53856
s_nop 0
buffer_load_dwordx4 v12, s[12:15], s44 offen offset:0 lds
s_mov_b32 s44, 2097152
s_add_u32 m0, s45, 67584
s_nop 0
buffer_load_dwordx4 v12, s[12:15], s44 offen offset:0 lds
s_mov_b32 s44, 2105344
s_add_u32 m0, s45, 68640
s_nop 0
buffer_load_dwordx4 v12, s[12:15], s44 offen offset:0 lds
s_mov_b32 s44, 2113536
s_add_u32 m0, s45, 69696
s_nop 0
buffer_load_dwordx4 v12, s[12:15], s44 offen offset:0 lds
s_mov_b32 s44, 2121728
s_add_u32 m0, s45, 70752
s_nop 0
buffer_load_dwordx4 v12, s[12:15], s44 offen offset:0 lds
s_mov_b32 s44, 2621440
s_add_u32 m0, s45, 84480
s_nop 0
buffer_load_dwordx4 v12, s[12:15], s44 offen offset:0 lds
s_mov_b32 s44, 2629632
s_add_u32 m0, s45, 85536
s_nop 0
buffer_load_dwordx4 v12, s[12:15], s44 offen offset:0 lds
s_mov_b32 s44, 2637824
s_add_u32 m0, s45, 86592
s_nop 0
buffer_load_dwordx4 v12, s[12:15], s44 offen offset:0 lds
s_mov_b32 s44, 2646016
s_add_u32 m0, s45, 87648
s_nop 0
buffer_load_dwordx4 v12, s[12:15], s44 offen offset:0 lds
s_waitcnt vmcnt(24)
s_barrier
ds_read_b64_tr_b16 a[96:97], v10 offset:0
ds_read_b64_tr_b16 a[98:99], v10 offset:4224
ds_read_b64_tr_b16 a[100:101], v10 offset:32
ds_read_b64_tr_b16 a[102:103], v10 offset:4256
ds_read_b64_tr_b16 a[104:105], v10 offset:512
ds_read_b64_tr_b16 a[106:107], v10 offset:4736
ds_read_b64_tr_b16 a[108:109], v10 offset:544
ds_read_b64_tr_b16 a[110:111], v10 offset:4768
ds_read_b64_tr_b16 a[112:113], v10 offset:16896
ds_read_b64_tr_b16 a[114:115], v10 offset:21120
ds_read_b64_tr_b16 a[116:117], v10 offset:16928
ds_read_b64_tr_b16 a[118:119], v10 offset:21152
ds_read_b64_tr_b16 a[120:121], v10 offset:17408
ds_read_b64_tr_b16 a[122:123], v10 offset:21632
ds_read_b64_tr_b16 a[124:125], v10 offset:17440
ds_read_b64_tr_b16 a[126:127], v10 offset:21664
ds_read_b64_tr_b16 a[128:129], v10 offset:33792
ds_read_b64_tr_b16 a[130:131], v10 offset:38016
ds_read_b64_tr_b16 a[132:133], v10 offset:33824
ds_read_b64_tr_b16 a[134:135], v10 offset:38048
ds_read_b64_tr_b16 a[136:137], v10 offset:34304
ds_read_b64_tr_b16 a[138:139], v10 offset:38528
ds_read_b64_tr_b16 a[140:141], v10 offset:34336
ds_read_b64_tr_b16 a[142:143], v10 offset:38560
s_waitcnt lgkmcnt(0)
s_barrier
s_mov_b32 s44, 3145728
s_add_u32 m0, s45, 101376
s_nop 0
buffer_load_dwordx4 v12, s[12:15], s44 offen offset:0 lds
s_mov_b32 s44, 3153920
s_add_u32 m0, s45, 102432
s_nop 0
buffer_load_dwordx4 v12, s[12:15], s44 offen offset:0 lds
s_mov_b32 s44, 3162112
s_add_u32 m0, s45, 103488
s_nop 0
buffer_load_dwordx4 v12, s[12:15], s44 offen offset:0 lds
s_mov_b32 s44, 3170304
s_add_u32 m0, s45, 104544
s_nop 0
buffer_load_dwordx4 v12, s[12:15], s44 offen offset:0 lds
s_mov_b32 s44, 3670016
s_add_u32 m0, s45, 118272
s_nop 0
buffer_load_dwordx4 v12, s[12:15], s44 offen offset:0 lds
s_mov_b32 s44, 3678208
s_add_u32 m0, s45, 119328
s_nop 0
buffer_load_dwordx4 v12, s[12:15], s44 offen offset:0 lds
s_mov_b32 s44, 3686400
s_add_u32 m0, s45, 120384
s_nop 0
buffer_load_dwordx4 v12, s[12:15], s44 offen offset:0 lds
s_mov_b32 s44, 3694592
s_add_u32 m0, s45, 121440
s_nop 0
buffer_load_dwordx4 v12, s[12:15], s44 offen offset:0 lds
s_mov_b32 s44, 4194304
s_add_u32 m0, s45, 135168
s_nop 0
buffer_load_dwordx4 v12, s[12:15], s44 offen offset:0 lds
s_mov_b32 s44, 4202496
s_add_u32 m0, s45, 136224
s_nop 0
buffer_load_dwordx4 v12, s[12:15], s44 offen offset:0 lds
s_mov_b32 s44, 4210688
s_add_u32 m0, s45, 137280
s_nop 0
buffer_load_dwordx4 v12, s[12:15], s44 offen offset:0 lds
s_mov_b32 s44, 4218880
s_add_u32 m0, s45, 138336
s_nop 0
buffer_load_dwordx4 v12, s[12:15], s44 offen offset:0 lds
s_waitcnt vmcnt(24)
s_barrier
ds_read_b64_tr_b16 a[144:145], v8 offset:0
ds_read_b64_tr_b16 a[146:147], v8 offset:4224
ds_read_b64_tr_b16 a[148:149], v8 offset:32
ds_read_b64_tr_b16 a[150:151], v8 offset:4256
ds_read_b64_tr_b16 a[152:153], v8 offset:512
ds_read_b64_tr_b16 a[154:155], v8 offset:4736
ds_read_b64_tr_b16 a[156:157], v8 offset:544
ds_read_b64_tr_b16 a[158:159], v8 offset:4768
ds_read_b64_tr_b16 a[160:161], v8 offset:16896
ds_read_b64_tr_b16 a[162:163], v8 offset:21120
ds_read_b64_tr_b16 a[164:165], v8 offset:16928
ds_read_b64_tr_b16 a[166:167], v8 offset:21152
ds_read_b64_tr_b16 a[168:169], v8 offset:17408
ds_read_b64_tr_b16 a[170:171], v8 offset:21632
ds_read_b64_tr_b16 a[172:173], v8 offset:17440
ds_read_b64_tr_b16 a[174:175], v8 offset:21664
ds_read_b64_tr_b16 a[176:177], v8 offset:33792
ds_read_b64_tr_b16 a[178:179], v8 offset:38016
ds_read_b64_tr_b16 a[180:181], v8 offset:33824
ds_read_b64_tr_b16 a[182:183], v8 offset:38048
ds_read_b64_tr_b16 a[184:185], v8 offset:34304
ds_read_b64_tr_b16 a[186:187], v8 offset:38528
ds_read_b64_tr_b16 a[188:189], v8 offset:34336
ds_read_b64_tr_b16 a[190:191], v8 offset:38560
s_waitcnt lgkmcnt(0)
s_barrier
s_mov_b32 s44, 0
s_add_u32 m0, s45, 0
s_nop 0
buffer_load_dwordx4 v13, s[16:19], s44 offen offset:0 lds
s_mov_b32 s44, 8192
s_add_u32 m0, s45, 1056
s_nop 0
buffer_load_dwordx4 v13, s[16:19], s44 offen offset:0 lds
s_mov_b32 s44, 16384
s_add_u32 m0, s45, 2112
s_nop 0
buffer_load_dwordx4 v13, s[16:19], s44 offen offset:0 lds
s_mov_b32 s44, 24576
s_add_u32 m0, s45, 3168
s_nop 0
buffer_load_dwordx4 v13, s[16:19], s44 offen offset:0 lds
s_mov_b32 s44, 524288
s_add_u32 m0, s45, 16896
s_nop 0
buffer_load_dwordx4 v13, s[16:19], s44 offen offset:0 lds
s_mov_b32 s44, 532480
s_add_u32 m0, s45, 17952
s_nop 0
buffer_load_dwordx4 v13, s[16:19], s44 offen offset:0 lds
s_mov_b32 s44, 540672
s_add_u32 m0, s45, 19008
s_nop 0
buffer_load_dwordx4 v13, s[16:19], s44 offen offset:0 lds
s_mov_b32 s44, 548864
s_add_u32 m0, s45, 20064
s_nop 0
buffer_load_dwordx4 v13, s[16:19], s44 offen offset:0 lds
s_mov_b32 s44, 1048576
s_add_u32 m0, s45, 33792
s_nop 0
buffer_load_dwordx4 v13, s[16:19], s44 offen offset:0 lds
s_mov_b32 s44, 1056768
s_add_u32 m0, s45, 34848
s_nop 0
buffer_load_dwordx4 v13, s[16:19], s44 offen offset:0 lds
s_mov_b32 s44, 1064960
s_add_u32 m0, s45, 35904
s_nop 0
buffer_load_dwordx4 v13, s[16:19], s44 offen offset:0 lds
s_mov_b32 s44, 1073152
s_add_u32 m0, s45, 36960
s_nop 0
buffer_load_dwordx4 v13, s[16:19], s44 offen offset:0 lds
s_waitcnt vmcnt(24)
s_barrier
ds_read_b64_tr_b16 a[192:193], v9 offset:0
ds_read_b64_tr_b16 a[194:195], v9 offset:4224
ds_read_b64_tr_b16 a[196:197], v9 offset:32
ds_read_b64_tr_b16 a[198:199], v9 offset:4256
ds_read_b64_tr_b16 a[200:201], v9 offset:512
ds_read_b64_tr_b16 a[202:203], v9 offset:4736
ds_read_b64_tr_b16 a[204:205], v9 offset:544
ds_read_b64_tr_b16 a[206:207], v9 offset:4768
ds_read_b64_tr_b16 a[208:209], v9 offset:16896
ds_read_b64_tr_b16 a[210:211], v9 offset:21120
ds_read_b64_tr_b16 a[212:213], v9 offset:16928
ds_read_b64_tr_b16 a[214:215], v9 offset:21152
ds_read_b64_tr_b16 a[216:217], v9 offset:17408
ds_read_b64_tr_b16 a[218:219], v9 offset:21632
ds_read_b64_tr_b16 a[220:221], v9 offset:17440
ds_read_b64_tr_b16 a[222:223], v9 offset:21664
ds_read_b64_tr_b16 a[224:225], v9 offset:33792
ds_read_b64_tr_b16 a[226:227], v9 offset:38016
ds_read_b64_tr_b16 a[228:229], v9 offset:33824
ds_read_b64_tr_b16 a[230:231], v9 offset:38048
ds_read_b64_tr_b16 a[232:233], v9 offset:34304
ds_read_b64_tr_b16 a[234:235], v9 offset:38528
ds_read_b64_tr_b16 a[236:237], v9 offset:34336
ds_read_b64_tr_b16 a[238:239], v9 offset:38560
s_waitcnt lgkmcnt(0)
s_barrier
s_mov_b32 s44, 1572864
s_add_u32 m0, s45, 50688
s_nop 0
buffer_load_dwordx4 v13, s[16:19], s44 offen offset:0 lds
s_mov_b32 s44, 1581056
s_add_u32 m0, s45, 51744
s_nop 0
buffer_load_dwordx4 v13, s[16:19], s44 offen offset:0 lds
s_mov_b32 s44, 1589248
s_add_u32 m0, s45, 52800
s_nop 0
buffer_load_dwordx4 v13, s[16:19], s44 offen offset:0 lds
s_mov_b32 s44, 1597440
s_add_u32 m0, s45, 53856
s_nop 0
buffer_load_dwordx4 v13, s[16:19], s44 offen offset:0 lds
s_mov_b32 s44, 2097152
s_add_u32 m0, s45, 67584
s_nop 0
buffer_load_dwordx4 v13, s[16:19], s44 offen offset:0 lds
s_mov_b32 s44, 2105344
s_add_u32 m0, s45, 68640
s_nop 0
buffer_load_dwordx4 v13, s[16:19], s44 offen offset:0 lds
s_mov_b32 s44, 2113536
s_add_u32 m0, s45, 69696
s_nop 0
buffer_load_dwordx4 v13, s[16:19], s44 offen offset:0 lds
s_mov_b32 s44, 2121728
s_add_u32 m0, s45, 70752
s_nop 0
buffer_load_dwordx4 v13, s[16:19], s44 offen offset:0 lds
s_mov_b32 s44, 2621440
s_add_u32 m0, s45, 84480
s_nop 0
buffer_load_dwordx4 v13, s[16:19], s44 offen offset:0 lds
s_mov_b32 s44, 2629632
s_add_u32 m0, s45, 85536
s_nop 0
buffer_load_dwordx4 v13, s[16:19], s44 offen offset:0 lds
s_mov_b32 s44, 2637824
s_add_u32 m0, s45, 86592
s_nop 0
buffer_load_dwordx4 v13, s[16:19], s44 offen offset:0 lds
s_mov_b32 s44, 2646016
s_add_u32 m0, s45, 87648
s_nop 0
buffer_load_dwordx4 v13, s[16:19], s44 offen offset:0 lds
s_waitcnt vmcnt(24)
s_barrier
ds_read_b64_tr_b16 a[240:241], v10 offset:0
ds_read_b64_tr_b16 a[242:243], v10 offset:4224
ds_read_b64_tr_b16 a[244:245], v10 offset:32
ds_read_b64_tr_b16 a[246:247], v10 offset:4256
ds_read_b64_tr_b16 a[248:249], v10 offset:512
ds_read_b64_tr_b16 a[250:251], v10 offset:4736
ds_read_b64_tr_b16 a[252:253], v10 offset:544
ds_read_b64_tr_b16 a[254:255], v10 offset:4768
ds_read_b64_tr_b16 v[80:81], v10 offset:16896
ds_read_b64_tr_b16 v[82:83], v10 offset:21120
ds_read_b64_tr_b16 v[84:85], v10 offset:16928
ds_read_b64_tr_b16 v[86:87], v10 offset:21152
ds_read_b64_tr_b16 v[88:89], v10 offset:17408
ds_read_b64_tr_b16 v[90:91], v10 offset:21632
ds_read_b64_tr_b16 v[92:93], v10 offset:17440
ds_read_b64_tr_b16 v[94:95], v10 offset:21664
ds_read_b64_tr_b16 v[96:97], v10 offset:33792
ds_read_b64_tr_b16 v[98:99], v10 offset:38016
ds_read_b64_tr_b16 v[100:101], v10 offset:33824
ds_read_b64_tr_b16 v[102:103], v10 offset:38048
ds_read_b64_tr_b16 v[104:105], v10 offset:34304
ds_read_b64_tr_b16 v[106:107], v10 offset:38528
ds_read_b64_tr_b16 v[108:109], v10 offset:34336
ds_read_b64_tr_b16 v[110:111], v10 offset:38560
s_waitcnt lgkmcnt(0)
s_barrier
s_mov_b32 s44, 3145728
s_add_u32 m0, s45, 101376
s_nop 0
buffer_load_dwordx4 v13, s[16:19], s44 offen offset:0 lds
s_mov_b32 s44, 3153920
s_add_u32 m0, s45, 102432
s_nop 0
buffer_load_dwordx4 v13, s[16:19], s44 offen offset:0 lds
s_mov_b32 s44, 3162112
s_add_u32 m0, s45, 103488
s_nop 0
buffer_load_dwordx4 v13, s[16:19], s44 offen offset:0 lds
s_mov_b32 s44, 3170304
s_add_u32 m0, s45, 104544
s_nop 0
buffer_load_dwordx4 v13, s[16:19], s44 offen offset:0 lds
s_mov_b32 s44, 3670016
s_add_u32 m0, s45, 118272
s_nop 0
buffer_load_dwordx4 v13, s[16:19], s44 offen offset:0 lds
s_mov_b32 s44, 3678208
s_add_u32 m0, s45, 119328
s_nop 0
buffer_load_dwordx4 v13, s[16:19], s44 offen offset:0 lds
s_mov_b32 s44, 3686400
s_add_u32 m0, s45, 120384
s_nop 0
buffer_load_dwordx4 v13, s[16:19], s44 offen offset:0 lds
s_mov_b32 s44, 3694592
s_add_u32 m0, s45, 121440
s_nop 0
buffer_load_dwordx4 v13, s[16:19], s44 offen offset:0 lds
s_mov_b32 s44, 4194304
s_add_u32 m0, s45, 135168
s_nop 0
buffer_load_dwordx4 v13, s[16:19], s44 offen offset:0 lds
s_mov_b32 s44, 4202496
s_add_u32 m0, s45, 136224
s_nop 0
buffer_load_dwordx4 v13, s[16:19], s44 offen offset:0 lds
s_mov_b32 s44, 4210688
s_add_u32 m0, s45, 137280
s_nop 0
buffer_load_dwordx4 v13, s[16:19], s44 offen offset:0 lds
s_mov_b32 s44, 4218880
s_add_u32 m0, s45, 138336
s_nop 0
buffer_load_dwordx4 v13, s[16:19], s44 offen offset:0 lds
s_waitcnt vmcnt(24)
s_barrier
ds_read_b64_tr_b16 v[112:113], v8 offset:0
ds_read_b64_tr_b16 v[114:115], v8 offset:4224
ds_read_b64_tr_b16 v[116:117], v8 offset:32
ds_read_b64_tr_b16 v[118:119], v8 offset:4256
ds_read_b64_tr_b16 v[120:121], v8 offset:512
ds_read_b64_tr_b16 v[122:123], v8 offset:4736
ds_read_b64_tr_b16 v[124:125], v8 offset:544
ds_read_b64_tr_b16 v[126:127], v8 offset:4768
ds_read_b64_tr_b16 v[128:129], v8 offset:16896
ds_read_b64_tr_b16 v[130:131], v8 offset:21120
ds_read_b64_tr_b16 v[132:133], v8 offset:16928
ds_read_b64_tr_b16 v[134:135], v8 offset:21152
ds_read_b64_tr_b16 v[136:137], v8 offset:17408
ds_read_b64_tr_b16 v[138:139], v8 offset:21632
ds_read_b64_tr_b16 v[140:141], v8 offset:17440
ds_read_b64_tr_b16 v[142:143], v8 offset:21664
ds_read_b64_tr_b16 v[144:145], v8 offset:33792
ds_read_b64_tr_b16 v[146:147], v8 offset:38016
ds_read_b64_tr_b16 v[148:149], v8 offset:33824
ds_read_b64_tr_b16 v[150:151], v8 offset:38048
ds_read_b64_tr_b16 v[152:153], v8 offset:34304
ds_read_b64_tr_b16 v[154:155], v8 offset:38528
ds_read_b64_tr_b16 v[156:157], v8 offset:34336
ds_read_b64_tr_b16 v[158:159], v8 offset:38560
s_waitcnt vmcnt(12)
s_barrier
ds_read_b64_tr_b16 v[160:161], v9 offset:0
ds_read_b64_tr_b16 v[162:163], v9 offset:4224
ds_read_b64_tr_b16 v[164:165], v9 offset:32
ds_read_b64_tr_b16 v[166:167], v9 offset:4256
ds_read_b64_tr_b16 v[168:169], v9 offset:512
ds_read_b64_tr_b16 v[170:171], v9 offset:4736
ds_read_b64_tr_b16 v[172:173], v9 offset:544
ds_read_b64_tr_b16 v[174:175], v9 offset:4768
ds_read_b64_tr_b16 v[176:177], v9 offset:16896
ds_read_b64_tr_b16 v[178:179], v9 offset:21120
ds_read_b64_tr_b16 v[180:181], v9 offset:16928
ds_read_b64_tr_b16 v[182:183], v9 offset:21152
ds_read_b64_tr_b16 v[184:185], v9 offset:17408
ds_read_b64_tr_b16 v[186:187], v9 offset:21632
ds_read_b64_tr_b16 v[188:189], v9 offset:17440
ds_read_b64_tr_b16 v[190:191], v9 offset:21664
ds_read_b64_tr_b16 v[192:193], v9 offset:33792
ds_read_b64_tr_b16 v[194:195], v9 offset:38016
ds_read_b64_tr_b16 v[196:197], v9 offset:33824
ds_read_b64_tr_b16 v[198:199], v9 offset:38048
ds_read_b64_tr_b16 v[200:201], v9 offset:34304
ds_read_b64_tr_b16 v[202:203], v9 offset:38528
ds_read_b64_tr_b16 v[204:205], v9 offset:34336
ds_read_b64_tr_b16 v[206:207], v9 offset:38560
s_waitcnt vmcnt(0)
s_barrier
ds_read_b64_tr_b16 v[208:209], v10 offset:0
ds_read_b64_tr_b16 v[210:211], v10 offset:4224
ds_read_b64_tr_b16 v[212:213], v10 offset:32
ds_read_b64_tr_b16 v[214:215], v10 offset:4256
ds_read_b64_tr_b16 v[216:217], v10 offset:512
ds_read_b64_tr_b16 v[218:219], v10 offset:4736
ds_read_b64_tr_b16 v[220:221], v10 offset:544
ds_read_b64_tr_b16 v[222:223], v10 offset:4768
ds_read_b64_tr_b16 v[224:225], v10 offset:16896
ds_read_b64_tr_b16 v[226:227], v10 offset:21120
ds_read_b64_tr_b16 v[228:229], v10 offset:16928
ds_read_b64_tr_b16 v[230:231], v10 offset:21152
ds_read_b64_tr_b16 v[232:233], v10 offset:17408
ds_read_b64_tr_b16 v[234:235], v10 offset:21632
ds_read_b64_tr_b16 v[236:237], v10 offset:17440
ds_read_b64_tr_b16 v[238:239], v10 offset:21664
ds_read_b64_tr_b16 v[240:241], v10 offset:33792
ds_read_b64_tr_b16 v[242:243], v10 offset:38016
ds_read_b64_tr_b16 v[244:245], v10 offset:33824
ds_read_b64_tr_b16 v[246:247], v10 offset:38048
ds_read_b64_tr_b16 v[248:249], v10 offset:34304
ds_read_b64_tr_b16 v[250:251], v10 offset:38528
ds_read_b64_tr_b16 v[252:253], v10 offset:34336
ds_read_b64_tr_b16 v[254:255], v10 offset:38560
s_waitcnt lgkmcnt(0)
s_barrier
v_lshl_add_u32 v16, s35, 6, v0
v_lshlrev_b32 v16, 20, v16
buffer_load_dword v18, v16, s[4:7], 0 offen
buffer_load_dword v18, v16, s[16:19], 0 offen
v_and_b32 v16, 7, v0
v_lshlrev_b32 v16, 3, v16
L_kv_cen1:
buffer_load_dwordx2 v[18:19], v16, s[24:27], s0 offen sc1
s_waitcnt vmcnt(0)
v_sad_u8 v17, v18, 0, 0
v_sad_u8 v17, v19, 0, v17
v_cmp_ne_u32 vcc, 32, v17
s_nop 0
s_cbranch_vccz L_kv_cend2
s_sleep 16
s_sub_u32 s37, s37, 1
s_cbranch_scc0 L_kv_cen1
s_movk_i32 s39, 33
s_branch L_bail
L_kv_cend2:
v_bcnt_u32_b32 v17, v18, 0
v_bcnt_u32_b32 v17, v19, v17
v_cmp_ne_u32 vcc, 1, v17
v_readlane_b32 s41, v17, s1
s_cbranch_vccz L_kv_cok3
s_cmp_eq_u32 s0, 0
s_cbranch_scc1 L_redo
L_kv_cok3:
s_cmp_eq_u32 s41, 1
s_cselect_b32 s36, 1, 0
v_lshrrev_b32 v16, 3, v0
v_lshl_add_u32 v16, s35, 3, v16
v_bfe_u32 v17, v16, 1, 3
v_xor_b32 v17, v17, v0
v_and_b32 v17, 7, v17
v_mul_u32_u24 v1, 1152, v16
v_lshl_add_u32 v1, v17, 4, v1
v_and_b32 v16, 31, v0
v_bfe_u32 v17, v0, 1, 3
v_lshrrev_b32 v18, 5, v0
v_xor_b32 v17, v17, v18
v_xor_b32 v18, 0, v17
v_lshlrev_b32 v18, 4, v18
v_lshl_add_u32 v2, v16, 7, v18
v_xor_b32 v18, 2, v17
v_lshlrev_b32 v18, 4, v18
v_lshl_add_u32 v3, v16, 7, v18
v_xor_b32 v18, 4, v17
v_lshlrev_b32 v18, 4, v18
v_lshl_add_u32 v4, v16, 7, v18
v_xor_b32 v18, 6, v17
v_lshlrev_b32 v18, 4, v18
v_lshl_add_u32 v5, v16, 7, v18
v_and_b32 v16, 15, v0
v_lshrrev_b32 v17, 4, v0
v_bfe_u32 v18, v0, 1, 3
v_xor_b32 v17, v17, v18
v_xor_b32 v18, 0, v17
v_lshlrev_b32 v18, 4, v18
v_lshl_add_u32 v2, v16, 7, v18
v_xor_b32 v18, 4, v17
v_lshlrev_b32 v18, 4, v18
v_lshl_add_u32 v3, v16, 7, v18
v_lshlrev_b32 v16, 4, v0
v_lshl_add_u32 v6, s35, 10, v16
v_lshl_add_u32 v7, s35, 11, v16
v_add_u32 v7, 8192, v7
v_mov_b32 v9, 0
v_mov_b32 v8, 0
s_lshl_b32 s47, s33, 5
s_add_u32 s47, s47, s34
s_lshl_b32 s48, s47, 7
s_add_u32 s56, s48, 32
s_lshl_b32 s49, s35, 2
s_add_u32 s48, s48, s49
s_mul_i32 s50, s33, 2359296
s_add_u32 s50, s50, 2097152
s_mul_i32 s51, s33, 51118080
s_mul_i32 s49, s34, 1597440
s_add_u32 s51, s51, s49
s_add_u32 s51, s51, 58720256
s_lshl_b32 s52, s35, 10
s_mov_b32 s53, 12288
s_mov_b32 s38, 1
s_mov_b32 s54, 0
s_mov_b32 s55, s33
v_mov_b32 v10, 0
s_add_u32 m0, s52, 0
s_nop 0
buffer_load_dwordx4 v1, s[4:7], s50 offen offset:0 sc1 lds
s_add_u32 m0, s52, 3968
s_nop 0
buffer_load_dwordx4 v1, s[4:7], s50 offen offset:128 sc1 lds
s_add_u32 m0, s52, 7936
s_nop 0
buffer_load_dwordx4 v1, s[4:7], s50 offen offset:256 sc1 lds
s_add_u32 m0, s52, 11904
s_nop 0
buffer_load_dwordx4 v1, s[4:7], s50 offen offset:384 sc1 lds
s_add_u32 m0, s52, 15872
s_nop 0
buffer_load_dwordx4 v1, s[4:7], s50 offen offset:512 sc1 lds
s_add_u32 m0, s52, 19840
s_nop 0
buffer_load_dwordx4 v1, s[4:7], s50 offen offset:640 sc1 lds
s_add_u32 m0, s52, 23808
s_nop 0
buffer_load_dwordx4 v1, s[4:7], s50 offen offset:768 sc1 lds
s_add_u32 m0, s52, 27776
s_nop 0
buffer_load_dwordx4 v1, s[4:7], s50 offen offset:896 sc1 lds
s_add_u32 m0, s52, 31744
s_nop 0
buffer_load_dwordx4 v1, s[4:7], s50 offen offset:1024 sc1 lds
s_waitcnt vmcnt(0)
L_kv_loop:
s_waitcnt vmcnt(6)
v_cmp_gt_u32 vcc, s55, v10
s_nop 0
s_cbranch_vccnz L_slow3
L_ret3:
s_barrier
s_add_u32 s50, s50, 36864
s_xor_b32 s52, s52, 0x10000
s_add_u32 s60, s51, 4096
s_add_u32 s59, s51, 16384
s_add_u32 s61, s51, 20480
s_add_u32 s55, s55, s33
ds_read_b128 v[60:63], v2 offset:0
ds_read_b128 v[64:67], v3 offset:0
ds_read_b128 v[68:71], v2 offset:4096
ds_read_b128 v[72:75], v3 offset:4096
ds_read_b128 v[76:79], v2 offset:8192
s_waitcnt lgkmcnt(4)
v_mfma_f32_16x16x32_bf16 v[28:31], v[60:63], a[144:147], 0
v_mfma_f32_16x16x32_bf16 v[32:35], v[60:63], a[148:151], 0
v_mfma_f32_16x16x32_bf16 v[12:15], a[0:3], v[60:63], 0
v_mfma_f32_16x16x32_bf16 v[16:19], a[4:7], v[60:63], 0
v_mfma_f32_16x16x32_bf16 v[44:47], v[112:115], v[60:63], 0
v_mfma_f32_16x16x32_bf16 v[48:51], v[116:119], v[60:63], 0
ds_read_b128 v[60:63], v3 offset:8192
s_waitcnt lgkmcnt(4)
v_mfma_f32_16x16x32_bf16 v[28:31], v[64:67], a[152:155], v[28:31]
v_mfma_f32_16x16x32_bf16 v[32:35], v[64:67], a[156:159], v[32:35]
v_mfma_f32_16x16x32_bf16 v[12:15], a[8:11], v[64:67], v[12:15]
v_mfma_f32_16x16x32_bf16 v[16:19], a[12:15], v[64:67], v[16:19]
v_mfma_f32_16x16x32_bf16 v[44:47], v[120:123], v[64:67], v[44:47]
v_mfma_f32_16x16x32_bf16 v[48:51], v[124:127], v[64:67], v[48:51]
ds_read_b128 v[64:67], v2 offset:12288
s_waitcnt lgkmcnt(4)
v_mfma_f32_16x16x32_bf16 v[28:31], v[68:71], a[160:163], v[28:31]
v_mfma_f32_16x16x32_bf16 v[32:35], v[68:71], a[164:167], v[32:35]
v_mfma_f32_16x16x32_bf16 v[12:15], a[16:19], v[68:71], v[12:15]
v_mfma_f32_16x16x32_bf16 v[16:19], a[20:23], v[68:71], v[16:19]
v_mfma_f32_16x16x32_bf16 v[44:47], v[128:131], v[68:71], v[44:47]
v_mfma_f32_16x16x32_bf16 v[48:51], v[132:135], v[68:71], v[48:51]
ds_read_b128 v[68:71], v3 offset:12288
s_waitcnt lgkmcnt(4)
v_mfma_f32_16x16x32_bf16 v[28:31], v[72:75], a[168:171], v[28:31]
v_mfma_f32_16x16x32_bf16 v[32:35], v[72:75], a[172:175], v[32:35]
v_mfma_f32_16x16x32_bf16 v[12:15], a[24:27], v[72:75], v[12:15]
v_mfma_f32_16x16x32_bf16 v[16:19], a[28:31], v[72:75], v[16:19]
v_mfma_f32_16x16x32_bf16 v[44:47], v[136:139], v[72:75], v[44:47]
v_mfma_f32_16x16x32_bf16 v[48:51], v[140:143], v[72:75], v[48:51]
ds_read_b128 v[72:75], v2 offset:16384
s_waitcnt lgkmcnt(4)
v_mfma_f32_16x16x32_bf16 v[28:31], v[76:79], a[176:179], v[28:31]
v_mfma_f32_16x16x32_bf16 v[32:35], v[76:79], a[180:183], v[32:35]
v_mfma_f32_16x16x32_bf16 v[12:15], a[32:35], v[76:79], v[12:15]
v_mfma_f32_16x16x32_bf16 v[16:19], a[36:39], v[76:79], v[16:19]
v_mfma_f32_16x16x32_bf16 v[44:47], v[144:147], v[76:79], v[44:47]
v_mfma_f32_16x16x32_bf16 v[48:51], v[148:151], v[76:79], v[48:51]
ds_read_b128 v[76:79], v3 offset:16384
s_waitcnt lgkmcnt(4)
v_mfma_f32_16x16x32_bf16 v[28:31], v[60:63], a[184:187], v[28:31]
v_mfma_f32_16x16x32_bf16 v[32:35], v[60:63], a[188:191], v[32:35]
v_mfma_f32_16x16x32_bf16 v[12:15], a[40:43], v[60:63], v[12:15]
v_mfma_f32_16x16x32_bf16 v[16:19], a[44:47], v[60:63], v[16:19]
v_mfma_f32_16x16x32_bf16 v[44:47], v[152:155], v[60:63], v[44:47]
v_mfma_f32_16x16x32_bf16 v[48:51], v[156:159], v[60:63], v[48:51]
ds_read_b128 v[60:63], v2 offset:20480
s_waitcnt lgkmcnt(4)
v_mfma_f32_16x16x32_bf16 v[28:31], v[64:67], a[192:195], v[28:31]
v_mfma_f32_16x16x32_bf16 v[32:35], v[64:67], a[196:199], v[32:35]
v_mfma_f32_16x16x32_bf16 v[12:15], a[48:51], v[64:67], v[12:15]
v_mfma_f32_16x16x32_bf16 v[16:19], a[52:55], v[64:67], v[16:19]
v_mfma_f32_16x16x32_bf16 v[44:47], v[160:163], v[64:67], v[44:47]
v_mfma_f32_16x16x32_bf16 v[48:51], v[164:167], v[64:67], v[48:51]
ds_read_b128 v[64:67], v3 offset:20480
s_waitcnt lgkmcnt(4)
v_mfma_f32_16x16x32_bf16 v[28:31], v[68:71], a[200:203], v[28:31]
v_mfma_f32_16x16x32_bf16 v[32:35], v[68:71], a[204:207], v[32:35]
v_mfma_f32_16x16x32_bf16 v[12:15], a[56:59], v[68:71], v[12:15]
s_waitcnt vmcnt(0)
s_mov_b32 s58, s54
s_buffer_atomic_umax s58, s[4:7], s48
v_mfma_f32_16x16x32_bf16 v[16:19], a[60:63], v[68:71], v[16:19]
s_add_u32 s54, s54, 1
v_mfma_f32_16x16x32_bf16 v[44:47], v[168:171], v[68:71], v[44:47]
v_mfma_f32_16x16x32_bf16 v[48:51], v[172:175], v[68:71], v[48:51]
ds_read_b128 v[68:71], v2 offset:24576
s_waitcnt lgkmcnt(4)
v_mfma_f32_16x16x32_bf16 v[28:31], v[72:75], a[208:211], v[28:31]
v_mfma_f32_16x16x32_bf16 v[32:35], v[72:75], a[212:215], v[32:35]
v_mfma_f32_16x16x32_bf16 v[12:15], a[64:67], v[72:75], v[12:15]
v_mfma_f32_16x16x32_bf16 v[16:19], a[68:71], v[72:75], v[16:19]
v_mfma_f32_16x16x32_bf16 v[44:47], v[176:179], v[72:75], v[44:47]
v_mfma_f32_16x16x32_bf16 v[48:51], v[180:183], v[72:75], v[48:51]
ds_read_b128 v[72:75], v3 offset:24576
s_waitcnt lgkmcnt(4)
v_mfma_f32_16x16x32_bf16 v[28:31], v[76:79], a[216:219], v[28:31]
v_mfma_f32_16x16x32_bf16 v[32:35], v[76:79], a[220:223], v[32:35]
v_mfma_f32_16x16x32_bf16 v[12:15], a[72:75], v[76:79], v[12:15]
v_mfma_f32_16x16x32_bf16 v[16:19], a[76:79], v[76:79], v[16:19]
v_mfma_f32_16x16x32_bf16 v[44:47], v[184:187], v[76:79], v[44:47]
v_mfma_f32_16x16x32_bf16 v[48:51], v[188:191], v[76:79], v[48:51]
ds_read_b128 v[76:79], v2 offset:28672
s_waitcnt lgkmcnt(4)
v_mfma_f32_16x16x32_bf16 v[28:31], v[60:63], a[224:227], v[28:31]
v_mfma_f32_16x16x32_bf16 v[32:35], v[60:63], a[228:231], v[32:35]
v_mfma_f32_16x16x32_bf16 v[12:15], a[80:83], v[60:63], v[12:15]
v_mfma_f32_16x16x32_bf16 v[16:19], a[84:87], v[60:63], v[16:19]
v_mfma_f32_16x16x32_bf16 v[44:47], v[192:195], v[60:63], v[44:47]
v_mfma_f32_16x16x32_bf16 v[48:51], v[196:199], v[60:63], v[48:51]
ds_read_b128 v[60:63], v3 offset:28672
s_waitcnt lgkmcnt(4)
v_mfma_f32_16x16x32_bf16 v[28:31], v[64:67], a[232:235], v[28:31]
v_mfma_f32_16x16x32_bf16 v[32:35], v[64:67], a[236:239], v[32:35]
v_mfma_f32_16x16x32_bf16 v[12:15], a[88:91], v[64:67], v[12:15]
v_mfma_f32_16x16x32_bf16 v[16:19], a[92:95], v[64:67], v[16:19]
v_mfma_f32_16x16x32_bf16 v[44:47], v[200:203], v[64:67], v[44:47]
v_mfma_f32_16x16x32_bf16 v[48:51], v[204:207], v[64:67], v[48:51]
ds_read_b128 v[64:67], v2 offset:32768
s_waitcnt lgkmcnt(4)
v_mfma_f32_16x16x32_bf16 v[28:31], v[68:71], a[240:243], v[28:31]
v_mfma_f32_16x16x32_bf16 v[32:35], v[68:71], a[244:247], v[32:35]
v_mfma_f32_16x16x32_bf16 v[12:15], a[96:99], v[68:71], v[12:15]
v_mfma_f32_16x16x32_bf16 v[16:19], a[100:103], v[68:71], v[16:19]
v_mfma_f32_16x16x32_bf16 v[44:47], v[208:211], v[68:71], v[44:47]
v_mfma_f32_16x16x32_bf16 v[48:51], v[212:215], v[68:71], v[48:51]
ds_read_b128 v[68:71], v3 offset:32768
s_waitcnt lgkmcnt(4)
v_mfma_f32_16x16x32_bf16 v[28:31], v[72:75], a[248:251], v[28:31]
v_mfma_f32_16x16x32_bf16 v[32:35], v[72:75], a[252:255], v[32:35]
v_mfma_f32_16x16x32_bf16 v[12:15], a[104:107], v[72:75], v[12:15]
v_mfma_f32_16x16x32_bf16 v[16:19], a[108:111], v[72:75], v[16:19]
buffer_load_dword v10, v9, s[4:7], s53 offen sc1
v_mfma_f32_16x16x32_bf16 v[44:47], v[216:219], v[72:75], v[44:47]
v_mfma_f32_16x16x32_bf16 v[48:51], v[220:223], v[72:75], v[48:51]
ds_read_b128 v[72:75], v2 offset:2048
s_waitcnt lgkmcnt(4)
v_mfma_f32_16x16x32_bf16 v[28:31], v[76:79], v[80:83], v[28:31]
v_mfma_f32_16x16x32_bf16 v[32:35], v[76:79], v[84:87], v[32:35]
v_mfma_f32_16x16x32_bf16 v[12:15], a[112:115], v[76:79], v[12:15]
v_mfma_f32_16x16x32_bf16 v[16:19], a[116:119], v[76:79], v[16:19]
v_mfma_f32_16x16x32_bf16 v[44:47], v[224:227], v[76:79], v[44:47]
v_mfma_f32_16x16x32_bf16 v[48:51], v[228:231], v[76:79], v[48:51]
ds_read_b128 v[76:79], v3 offset:2048
s_waitcnt lgkmcnt(4)
v_mfma_f32_16x16x32_bf16 v[28:31], v[60:63], v[88:91], v[28:31]
v_mfma_f32_16x16x32_bf16 v[32:35], v[60:63], v[92:95], v[32:35]
v_mfma_f32_16x16x32_bf16 v[12:15], a[120:123], v[60:63], v[12:15]
v_mfma_f32_16x16x32_bf16 v[16:19], a[124:127], v[60:63], v[16:19]
v_mfma_f32_16x16x32_bf16 v[44:47], v[232:235], v[60:63], v[44:47]
v_mfma_f32_16x16x32_bf16 v[48:51], v[236:239], v[60:63], v[48:51]
ds_read_b128 v[60:63], v2 offset:6144
s_waitcnt lgkmcnt(4)
v_mfma_f32_16x16x32_bf16 v[28:31], v[64:67], v[96:99], v[28:31]
v_mfma_f32_16x16x32_bf16 v[32:35], v[64:67], v[100:103], v[32:35]
v_mfma_f32_16x16x32_bf16 v[12:15], a[128:131], v[64:67], v[12:15]
v_mfma_f32_16x16x32_bf16 v[16:19], a[132:135], v[64:67], v[16:19]
v_mfma_f32_16x16x32_bf16 v[44:47], v[240:243], v[64:67], v[44:47]
v_mfma_f32_16x16x32_bf16 v[48:51], v[244:247], v[64:67], v[48:51]
ds_read_b128 v[64:67], v3 offset:6144
s_waitcnt lgkmcnt(4)
v_mfma_f32_16x16x32_bf16 v[28:31], v[68:71], v[104:107], v[28:31]
v_mfma_f32_16x16x32_bf16 v[32:35], v[68:71], v[108:111], v[32:35]
v_mfma_f32_16x16x32_bf16 v[12:15], a[136:139], v[68:71], v[12:15]
v_cvt_pk_bf16_f32 v28, v28, v29
v_cvt_pk_bf16_f32 v29, v30, v31
v_mfma_f32_16x16x32_bf16 v[16:19], a[140:143], v[68:71], v[16:19]
v_cvt_pk_bf16_f32 v32, v32, v33
v_cvt_pk_bf16_f32 v33, v34, v35
v_mfma_f32_16x16x32_bf16 v[44:47], v[248:251], v[68:71], v[44:47]
s_waitcnt vmcnt(0)
s_add_u32 m0, s52, 0
s_nop 0
buffer_load_dwordx4 v1, s[4:7], s50 offen offset:0 sc1 lds
v_mfma_f32_16x16x32_bf16 v[48:51], v[252:255], v[68:71], v[48:51]
ds_read_b128 v[68:71], v2 offset:10240
v_cvt_pk_bf16_f32 v12, v12, v16
s_waitcnt lgkmcnt(4)
v_mfma_f32_16x16x32_bf16 v[36:39], v[72:75], a[144:147], 0
v_cvt_pk_bf16_f32 v13, v13, v17
v_mfma_f32_16x16x32_bf16 v[40:43], v[72:75], a[148:151], 0
v_cvt_pk_bf16_f32 v14, v14, v18
v_cvt_pk_bf16_f32 v15, v15, v19
v_mfma_f32_16x16x32_bf16 v[20:23], a[0:3], v[72:75], 0
s_add_u32 m0, s52, 3968
s_nop 0
buffer_load_dwordx4 v1, s[4:7], s50 offen offset:128 sc1 lds
v_mfma_f32_16x16x32_bf16 v[24:27], a[4:7], v[72:75], 0
v_cvt_pk_bf16_f32 v44, v44, v48
v_cvt_pk_bf16_f32 v45, v45, v49
v_mfma_f32_16x16x32_bf16 v[52:55], v[112:115], v[72:75], 0
v_cvt_pk_bf16_f32 v46, v46, v50
v_cvt_pk_bf16_f32 v47, v47, v51
v_mfma_f32_16x16x32_bf16 v[56:59], v[116:119], v[72:75], 0
s_add_u32 m0, s52, 7936
s_nop 0
buffer_load_dwordx4 v1, s[4:7], s50 offen offset:256 sc1 lds
s_waitcnt lgkmcnt(3)
v_mfma_f32_16x16x32_bf16 v[36:39], v[76:79], a[152:155], v[36:39]
ds_read_b128 v[72:75], v3 offset:10240
v_mfma_f32_16x16x32_bf16 v[40:43], v[76:79], a[156:159], v[40:43]
v_mfma_f32_16x16x32_bf16 v[20:23], a[8:11], v[76:79], v[20:23]
v_mfma_f32_16x16x32_bf16 v[24:27], a[12:15], v[76:79], v[24:27]
s_add_u32 m0, s52, 11904
s_nop 0
buffer_load_dwordx4 v1, s[4:7], s50 offen offset:384 sc1 lds
v_mfma_f32_16x16x32_bf16 v[52:55], v[120:123], v[76:79], v[52:55]
v_mfma_f32_16x16x32_bf16 v[56:59], v[124:127], v[76:79], v[56:59]
ds_read_b128 v[76:79], v2 offset:14336
s_waitcnt lgkmcnt(4)
v_mfma_f32_16x16x32_bf16 v[36:39], v[60:63], a[160:163], v[36:39]
s_add_u32 m0, s52, 15872
s_nop 0
buffer_load_dwordx4 v1, s[4:7], s50 offen offset:512 sc1 lds
v_mfma_f32_16x16x32_bf16 v[40:43], v[60:63], a[164:167], v[40:43]
v_mfma_f32_16x16x32_bf16 v[20:23], a[16:19], v[60:63], v[20:23]
v_mfma_f32_16x16x32_bf16 v[24:27], a[20:23], v[60:63], v[24:27]
v_mfma_f32_16x16x32_bf16 v[52:55], v[128:131], v[60:63], v[52:55]
s_add_u32 m0, s52, 19840
s_nop 0
buffer_load_dwordx4 v1, s[4:7], s50 offen offset:640 sc1 lds
v_mfma_f32_16x16x32_bf16 v[56:59], v[132:135], v[60:63], v[56:59]
ds_read_b128 v[60:63], v3 offset:14336
s_waitcnt lgkmcnt(4)
v_mfma_f32_16x16x32_bf16 v[36:39], v[64:67], a[168:171], v[36:39]
v_mfma_f32_16x16x32_bf16 v[40:43], v[64:67], a[172:175], v[40:43]
s_add_u32 m0, s52, 23808
s_nop 0
buffer_load_dwordx4 v1, s[4:7], s50 offen offset:768 sc1 lds
v_mfma_f32_16x16x32_bf16 v[20:23], a[24:27], v[64:67], v[20:23]
v_mfma_f32_16x16x32_bf16 v[24:27], a[28:31], v[64:67], v[24:27]
v_mfma_f32_16x16x32_bf16 v[52:55], v[136:139], v[64:67], v[52:55]
v_mfma_f32_16x16x32_bf16 v[56:59], v[140:143], v[64:67], v[56:59]
s_add_u32 m0, s52, 27776
s_nop 0
buffer_load_dwordx4 v1, s[4:7], s50 offen offset:896 sc1 lds
s_waitcnt lgkmcnt(3)
v_mfma_f32_16x16x32_bf16 v[36:39], v[68:71], a[176:179], v[36:39]
ds_read_b128 v[64:67], v2 offset:18432
v_mfma_f32_16x16x32_bf16 v[40:43], v[68:71], a[180:183], v[40:43]
v_mfma_f32_16x16x32_bf16 v[20:23], a[32:35], v[68:71], v[20:23]
s_add_u32 m0, s52, 31744
s_nop 0
buffer_load_dwordx4 v1, s[4:7], s50 offen offset:1024 sc1 lds
v_mfma_f32_16x16x32_bf16 v[24:27], a[36:39], v[68:71], v[24:27]
v_mfma_f32_16x16x32_bf16 v[52:55], v[144:147], v[68:71], v[52:55]
v_mfma_f32_16x16x32_bf16 v[56:59], v[148:151], v[68:71], v[56:59]
ds_read_b128 v[68:71], v3 offset:18432
s_waitcnt lgkmcnt(4)
v_mfma_f32_16x16x32_bf16 v[36:39], v[72:75], a[184:187], v[36:39]
v_mfma_f32_16x16x32_bf16 v[40:43], v[72:75], a[188:191], v[40:43]
v_mfma_f32_16x16x32_bf16 v[20:23], a[40:43], v[72:75], v[20:23]
v_mfma_f32_16x16x32_bf16 v[24:27], a[44:47], v[72:75], v[24:27]
v_mfma_f32_16x16x32_bf16 v[52:55], v[152:155], v[72:75], v[52:55]
v_mfma_f32_16x16x32_bf16 v[56:59], v[156:159], v[72:75], v[56:59]
ds_read_b128 v[72:75], v2 offset:22528
s_waitcnt lgkmcnt(4)
v_mfma_f32_16x16x32_bf16 v[36:39], v[76:79], a[192:195], v[36:39]
v_mfma_f32_16x16x32_bf16 v[40:43], v[76:79], a[196:199], v[40:43]
v_mfma_f32_16x16x32_bf16 v[20:23], a[48:51], v[76:79], v[20:23]
v_mfma_f32_16x16x32_bf16 v[24:27], a[52:55], v[76:79], v[24:27]
v_mfma_f32_16x16x32_bf16 v[52:55], v[160:163], v[76:79], v[52:55]
v_mfma_f32_16x16x32_bf16 v[56:59], v[164:167], v[76:79], v[56:59]
ds_read_b128 v[76:79], v3 offset:22528
s_waitcnt lgkmcnt(4)
v_mfma_f32_16x16x32_bf16 v[36:39], v[60:63], a[200:203], v[36:39]
v_mfma_f32_16x16x32_bf16 v[40:43], v[60:63], a[204:207], v[40:43]
v_mfma_f32_16x16x32_bf16 v[20:23], a[56:59], v[60:63], v[20:23]
v_mfma_f32_16x16x32_bf16 v[24:27], a[60:63], v[60:63], v[24:27]
v_mfma_f32_16x16x32_bf16 v[52:55], v[168:171], v[60:63], v[52:55]
v_mfma_f32_16x16x32_bf16 v[56:59], v[172:175], v[60:63], v[56:59]
ds_read_b128 v[60:63], v2 offset:26624
s_waitcnt lgkmcnt(4)
v_mfma_f32_16x16x32_bf16 v[36:39], v[64:67], a[208:211], v[36:39]
v_mfma_f32_16x16x32_bf16 v[40:43], v[64:67], a[212:215], v[40:43]
v_mfma_f32_16x16x32_bf16 v[20:23], a[64:67], v[64:67], v[20:23]
v_mfma_f32_16x16x32_bf16 v[24:27], a[68:71], v[64:67], v[24:27]
v_mfma_f32_16x16x32_bf16 v[52:55], v[176:179], v[64:67], v[52:55]
v_mfma_f32_16x16x32_bf16 v[56:59], v[180:183], v[64:67], v[56:59]
ds_read_b128 v[64:67], v3 offset:26624
s_waitcnt lgkmcnt(4)
v_mfma_f32_16x16x32_bf16 v[36:39], v[68:71], a[216:219], v[36:39]
v_mfma_f32_16x16x32_bf16 v[40:43], v[68:71], a[220:223], v[40:43]
v_mfma_f32_16x16x32_bf16 v[20:23], a[72:75], v[68:71], v[20:23]
v_mfma_f32_16x16x32_bf16 v[24:27], a[76:79], v[68:71], v[24:27]
v_mfma_f32_16x16x32_bf16 v[52:55], v[184:187], v[68:71], v[52:55]
v_mfma_f32_16x16x32_bf16 v[56:59], v[188:191], v[68:71], v[56:59]
ds_read_b128 v[68:71], v2 offset:30720
s_waitcnt lgkmcnt(4)
v_mfma_f32_16x16x32_bf16 v[36:39], v[72:75], a[224:227], v[36:39]
v_mfma_f32_16x16x32_bf16 v[40:43], v[72:75], a[228:231], v[40:43]
buffer_store_dwordx4 v[12:15], v6, s[4:7], s51 offen sc1
v_mfma_f32_16x16x32_bf16 v[20:23], a[80:83], v[72:75], v[20:23]
v_mfma_f32_16x16x32_bf16 v[24:27], a[84:87], v[72:75], v[24:27]
v_mfma_f32_16x16x32_bf16 v[52:55], v[192:195], v[72:75], v[52:55]
buffer_store_dwordx4 v[44:47], v6, s[4:7], s59 offen sc1
v_mfma_f32_16x16x32_bf16 v[56:59], v[196:199], v[72:75], v[56:59]
ds_read_b128 v[72:75], v3 offset:30720
s_waitcnt lgkmcnt(4)
v_mfma_f32_16x16x32_bf16 v[36:39], v[76:79], a[232:235], v[36:39]
v_mfma_f32_16x16x32_bf16 v[40:43], v[76:79], a[236:239], v[40:43]
v_mfma_f32_16x16x32_bf16 v[20:23], a[88:91], v[76:79], v[20:23]
v_mfma_f32_16x16x32_bf16 v[24:27], a[92:95], v[76:79], v[24:27]
v_mfma_f32_16x16x32_bf16 v[52:55], v[200:203], v[76:79], v[52:55]
v_mfma_f32_16x16x32_bf16 v[56:59], v[204:207], v[76:79], v[56:59]
ds_read_b128 v[76:79], v2 offset:34816
v_xor_b32 v2, 0x10000, v2
s_waitcnt lgkmcnt(4)
v_mfma_f32_16x16x32_bf16 v[36:39], v[60:63], a[240:243], v[36:39]
v_mfma_f32_16x16x32_bf16 v[40:43], v[60:63], a[244:247], v[40:43]
v_mfma_f32_16x16x32_bf16 v[20:23], a[96:99], v[60:63], v[20:23]
v_mfma_f32_16x16x32_bf16 v[24:27], a[100:103], v[60:63], v[24:27]
v_mfma_f32_16x16x32_bf16 v[52:55], v[208:211], v[60:63], v[52:55]
v_mfma_f32_16x16x32_bf16 v[56:59], v[212:215], v[60:63], v[56:59]
ds_read_b128 v[60:63], v3 offset:34816
v_xor_b32 v3, 0x10000, v3
s_waitcnt lgkmcnt(4)
v_mfma_f32_16x16x32_bf16 v[36:39], v[64:67], a[248:251], v[36:39]
s_waitcnt lgkmcnt(3)
v_mfma_f32_16x16x32_bf16 v[36:39], v[68:71], v[80:83], v[36:39]
s_waitcnt lgkmcnt(2)
v_mfma_f32_16x16x32_bf16 v[36:39], v[72:75], v[88:91], v[36:39]
s_waitcnt lgkmcnt(1)
v_mfma_f32_16x16x32_bf16 v[36:39], v[76:79], v[96:99], v[36:39]
v_mfma_f32_16x16x32_bf16 v[40:43], v[64:67], a[252:255], v[40:43]
v_mfma_f32_16x16x32_bf16 v[40:43], v[68:71], v[84:87], v[40:43]
v_mfma_f32_16x16x32_bf16 v[40:43], v[72:75], v[92:95], v[40:43]
v_mfma_f32_16x16x32_bf16 v[20:23], a[104:107], v[64:67], v[20:23]
v_mfma_f32_16x16x32_bf16 v[24:27], a[108:111], v[64:67], v[24:27]
s_waitcnt lgkmcnt(0)
v_mfma_f32_16x16x32_bf16 v[36:39], v[60:63], v[104:107], v[36:39]
v_mfma_f32_16x16x32_bf16 v[52:55], v[216:219], v[64:67], v[52:55]
v_mfma_f32_16x16x32_bf16 v[56:59], v[220:223], v[64:67], v[56:59]
v_cvt_pk_bf16_f32 v30, v36, v37
v_cvt_pk_bf16_f32 v31, v38, v39
v_mfma_f32_16x16x32_bf16 v[40:43], v[76:79], v[100:103], v[40:43]
buffer_store_dwordx4 v[28:31], v7, s[4:7], s51 offen offset:0 sc1
v_mfma_f32_16x16x32_bf16 v[20:23], a[112:115], v[68:71], v[20:23]
v_mfma_f32_16x16x32_bf16 v[24:27], a[116:119], v[68:71], v[24:27]
v_mfma_f32_16x16x32_bf16 v[52:55], v[224:227], v[68:71], v[52:55]
v_mfma_f32_16x16x32_bf16 v[40:43], v[60:63], v[108:111], v[40:43]
v_mfma_f32_16x16x32_bf16 v[20:23], a[120:123], v[72:75], v[20:23]
v_mfma_f32_16x16x32_bf16 v[24:27], a[124:127], v[72:75], v[24:27]
v_cvt_pk_bf16_f32 v34, v40, v41
v_cvt_pk_bf16_f32 v35, v42, v43
v_mfma_f32_16x16x32_bf16 v[20:23], a[128:131], v[76:79], v[20:23]
buffer_store_dwordx4 v[32:35], v7, s[4:7], s51 offen offset:1024 sc1
v_mfma_f32_16x16x32_bf16 v[24:27], a[132:135], v[76:79], v[24:27]
v_mfma_f32_16x16x32_bf16 v[20:23], a[136:139], v[60:63], v[20:23]
v_mfma_f32_16x16x32_bf16 v[24:27], a[140:143], v[60:63], v[24:27]
v_mfma_f32_16x16x32_bf16 v[56:59], v[228:231], v[68:71], v[56:59]
v_mfma_f32_16x16x32_bf16 v[52:55], v[232:235], v[72:75], v[52:55]
v_cvt_pk_bf16_f32 v20, v20, v24
v_cvt_pk_bf16_f32 v21, v21, v25
v_mfma_f32_16x16x32_bf16 v[56:59], v[236:239], v[72:75], v[56:59]
v_cvt_pk_bf16_f32 v22, v22, v26
v_cvt_pk_bf16_f32 v23, v23, v27
v_mfma_f32_16x16x32_bf16 v[52:55], v[240:243], v[76:79], v[52:55]
buffer_store_dwordx4 v[20:23], v6, s[4:7], s60 offen sc1
v_mfma_f32_16x16x32_bf16 v[56:59], v[244:247], v[76:79], v[56:59]
v_mfma_f32_16x16x32_bf16 v[52:55], v[248:251], v[60:63], v[52:55]
v_mfma_f32_16x16x32_bf16 v[56:59], v[252:255], v[60:63], v[56:59]
s_nop 7
v_cvt_pk_bf16_f32 v52, v52, v56
v_cvt_pk_bf16_f32 v53, v53, v57
v_cvt_pk_bf16_f32 v54, v54, v58
v_cvt_pk_bf16_f32 v55, v55, v59
buffer_store_dwordx4 v[52:55], v6, s[4:7], s61 offen sc1
s_add_u32 s51, s51, 24576
s_add_u32 s38, s38, 1
s_cmp_le_u32 s38, 64
s_cbranch_scc1 L_kv_loop
s_waitcnt vmcnt(0)
s_mov_b32 s57, s54
s_buffer_atomic_umax s57, s[4:7], s48
s_endpgm
L_slow3:
s_waitcnt vmcnt(0)
s_mov_b32 s57, s54
s_buffer_atomic_umax s57, s[4:7], s48
L_kvo_poll1:
buffer_load_dword v10, v9, s[4:7], s53 offen sc1
s_waitcnt vmcnt(0)
v_cmp_gt_u32 vcc, s55, v10
s_nop 0
s_cbranch_vccz L_kvo_pd2
s_sleep 1
s_sub_u32 s37, s37, 1
s_cbranch_scc0 L_kvo_poll1
s_movk_i32 s39, 34
s_branch L_bail
L_kvo_pd2:
s_add_u32 m0, s52, 0
s_nop 0
buffer_load_dwordx4 v1, s[4:7], s50 offen offset:0 sc1 lds
s_add_u32 m0, s52, 3968
s_nop 0
buffer_load_dwordx4 v1, s[4:7], s50 offen offset:128 sc1 lds
s_add_u32 m0, s52, 7936
s_nop 0
buffer_load_dwordx4 v1, s[4:7], s50 offen offset:256 sc1 lds
s_add_u32 m0, s52, 11904
s_nop 0
buffer_load_dwordx4 v1, s[4:7], s50 offen offset:384 sc1 lds
s_add_u32 m0, s52, 15872
s_nop 0
buffer_load_dwordx4 v1, s[4:7], s50 offen offset:512 sc1 lds
s_add_u32 m0, s52, 19840
s_nop 0
buffer_load_dwordx4 v1, s[4:7], s50 offen offset:640 sc1 lds
s_add_u32 m0, s52, 23808
s_nop 0
buffer_load_dwordx4 v1, s[4:7], s50 offen offset:768 sc1 lds
s_add_u32 m0, s52, 27776
s_nop 0
buffer_load_dwordx4 v1, s[4:7], s50 offen offset:896 sc1 lds
s_add_u32 m0, s52, 31744
s_nop 0
buffer_load_dwordx4 v1, s[4:7], s50 offen offset:1024 sc1 lds
s_waitcnt vmcnt(0)
s_branch L_ret3
L_KV_end:
.p2align 6
L_AT:
s_getpc_b64 s[40:41]
L_AT_pc:
v_lshl_add_u32 v2, s35, 6, v0
v_lshlrev_b32 v2, 7, v2
v_min_u32 v3, L_AT_end-L_AT_pc-4, v2
global_load_dword a255, v3, s[40:41]
v_add_u32 v2, 0x8000, v2
v_min_u32 v3, L_AT_end-L_AT_pc-4, v2
global_load_dword a255, v3, s[40:41]
s_cmp_ge_u32 s34, 16
s_cbranch_scc1 L_at_wo
s_cmp_ge_u32 s34, 8
s_cbranch_scc1 L_at_red
v_lshl_add_u32 v48, s35, 6, v0
v_lshlrev_b32 v48, 20, v48
buffer_load_dword v50, v48, s[4:7], 0 offen
buffer_load_dword v50, v48, s[16:19], 0 offen
v_and_b32 v48, 7, v0
v_lshlrev_b32 v48, 3, v48
L_att_cen1:
buffer_load_dwordx2 v[50:51], v48, s[24:27], s0 offen sc1
s_waitcnt vmcnt(0)
v_sad_u8 v49, v50, 0, 0
v_sad_u8 v49, v51, 0, v49
v_cmp_ne_u32 vcc, 32, v49
s_nop 0
s_cbranch_vccz L_att_cend2
s_sleep 16
s_sub_u32 s37, s37, 1
s_cbranch_scc0 L_att_cen1
s_movk_i32 s39, 49
s_branch L_bail
L_att_cend2:
v_bcnt_u32_b32 v49, v50, 0
v_bcnt_u32_b32 v49, v51, v49
v_cmp_ne_u32 vcc, 1, v49
v_readlane_b32 s41, v49, s1
s_cbranch_vccz L_att_cok3
s_cmp_eq_u32 s0, 0
s_cbranch_scc1 L_redo
L_att_cok3:
s_cmp_eq_u32 s41, 1
s_cselect_b32 s36, 1, 0
v_lshlrev_b32 v1, 4, v0
v_mov_b32 v5, 0
s_cmp_eq_u32 s36, 0
s_cselect_b32 s45, 0x7ffffff0, 0
v_mov_b32 v6, s45
v_and_b32 v48, 15, v0
v_lshrrev_b32 v50, 4, v0
v_and_b32 v49, 7, v0
v_lshlrev_b32 v2, 4, v49
v_lshl_add_u32 v2, v50, 7, v2
v_lshlrev_b32 v3, 3, v0
v_lshlrev_b32 v4, 4, v48
v_lshl_add_u32 v4, v50, 9, v4
v_lshlrev_b32 v50, 2, v50
v_sub_u32 v49, v48, v50
v_mov_b32 v51, 0xff800000
v_cmp_gt_i32 vcc, 0, v49
s_nop 1
v_cndmask_b32 v8, 0, v51, vcc
v_cmp_gt_i32 vcc, 1, v49
s_nop 1
v_cndmask_b32 v9, 0, v51, vcc
v_cmp_gt_i32 vcc, 2, v49
s_nop 1
v_cndmask_b32 v10, 0, v51, vcc
v_cmp_gt_i32 vcc, 3, v49
s_nop 1
v_cndmask_b32 v11, 0, v51, vcc
v_mov_b32 v12, 0x3f803f80
v_mov_b32 v13, 0x3f803f80
v_mov_b32 v14, 0x3f803f80
v_mov_b32 v15, 0x3f803f80
s_mov_b32 s62, -1
s_mov_b32 s63, 0
s_lshl_b32 s46, s34, 2
s_add_u32 s46, s46, s35
s_mul_i32 s49, s33, 51118080
s_mul_i32 s44, s46, 1597440
s_add_u32 s49, s49, s44
s_add_u32 s49, s49, 58720256
s_mul_i32 s50, s33, 8519680
s_mul_i32 s44, s46, 266240
s_add_u32 s50, s50, s44
s_add_u32 s50, s50, 20971520
s_lshl_b32 s52, s33, 5
s_add_u32 s52, s52, s46
s_lshl_b32 s52, s52, 7
s_add_u32 s99, s52, 32
s_lshr_b32 s48, s46, 1
s_lshl_b32 s45, s33, 4
s_add_u32 s45, s45, s48
s_add_u32 s45, s45, 0
s_mul_i32 s57, s45, 73728
s_add_u32 s57, s57, 167772160
s_lshl_b32 s56, s45, 7
s_add_u32 s56, s56, 24576
s_and_b32 s44, s46, 1
s_lshl_b32 s45, s44, 13
s_add_u32 s57, s57, s45
s_add_u32 s58, s57, 4096
s_lshl_b32 s44, s44, 2
s_add_u32 s56, s56, s44
s_mov_b32 s47, 1040356334
s_mov_b32 s38, 1
s_mov_b32 s12, 0
s_lshl_b32 s59, s33, 9
s_lshl_b32 s44, s48, 4
s_add_u32 s59, s59, s44
s_add_u32 s59, s59, 16384
v_and_b32 v0, 3, v0
v_lshlrev_b32 v0, 2, v0
v_mov_b32 v128, 0
v_mov_b32 v129, 0
v_mov_b32 v138, 0
v_mov_b32 v139, 0
v_mov_b32 v238, 0
v_mov_b32 v244, 0
v_mov_b32 v239, 0
v_mov_b32 v245, 0
L_att_loop:
s_cmp_lt_u32 s12, s38
s_cbranch_scc1 L_slow4
L_ret4:
s_buffer_load_dwordx8 s[12:19], s[4:7], s52 glc
s_add_u32 s49, s49, 24576
s_cmp_lt_u32 s38, 64
s_cselect_b32 s49, s49, 0x7fff0000
v_mfma_f32_16x16x32_bf16 v[140:143], a[0:3], a[64:67], v[8:11]
v_mfma_f32_16x16x32_bf16 v[140:143], a[4:7], a[68:71], v[140:143]
v_mfma_f32_16x16x32_bf16 v[140:143], a[8:11], a[72:75], v[140:143]
v_mfma_f32_16x16x32_bf16 v[140:143], a[12:15], a[76:79], v[140:143]
v_mfma_f32_16x16x32_bf16 v[152:155], a[0:3], a[80:83], 0
v_mfma_f32_16x16x32_bf16 v[152:155], a[4:7], a[84:87], v[152:155]
v_mfma_f32_16x16x32_bf16 v[152:155], a[8:11], a[88:91], v[152:155]
v_mfma_f32_16x16x32_bf16 v[152:155], a[12:15], a[92:95], v[152:155]
v_mfma_f32_16x16x32_bf16 v[156:159], a[16:19], a[80:83], v[8:11]
v_mfma_f32_16x16x32_bf16 v[156:159], a[20:23], a[84:87], v[156:159]
v_mfma_f32_16x16x32_bf16 v[156:159], a[24:27], a[88:91], v[156:159]
v_mfma_f32_16x16x32_bf16 v[156:159], a[28:31], a[92:95], v[156:159]
L_att_m0:
s_waitcnt lgkmcnt(0)
s_min_u32 s16, s16, s17
s_min_u32 s16, s16, s18
s_min_u32 s16, s16, s19
s_cmp_ge_u32 s16, s38
s_cbranch_scc1 L_att_md0
s_buffer_load_dwordx8 s[12:19], s[4:7], s52 glc
s_sub_u32 s37, s37, 1
s_cbranch_scc0 L_att_m0
s_movk_i32 s39, 51
s_branch L_bail
L_att_md0:
buffer_load_dwordx4 v[112:115], v2, s[4:7], s50 offen offset:0 sc1
v_max3_f32 v250, v152, v153, v154
v_max3_f32 v248, v140, v141, v142
v_max_f32 v250, v250, v155
v_max_f32 v248, v248, v143
v_max3_f32 v250, v250, v156, v157
s_sub_i32 s60, s38, 4
v_max3_f32 v250, v250, v158, v159
s_max_i32 s60, s60, 0
buffer_load_dwordx4 v[116:119], v2, s[4:7], s50 offen offset:512 sc1
s_min_u32 s12, s12, s13
s_min_u32 s12, s12, s14
s_and_b32 s61, s38, 3
s_cselect_b32 s61, 1, -3
s_mul_i32 s61, s61, 18432
s_min_u32 s12, s12, s15
buffer_load_dwordx4 v[120:123], v2, s[4:7], s50 offen offset:1024 sc1
buffer_load_dwordx4 v[124:127], v2, s[4:7], s50 offen offset:1536 sc1
buffer_load_dwordx2 v[130:131], v3, s[4:7], s50 offen offset:2048 sc1
buffer_load_dwordx2 v[132:133], v3, s[4:7], s50 offen offset:2560 sc1
buffer_load_dwordx2 v[134:135], v3, s[4:7], s50 offen offset:3072 sc1
buffer_load_dwordx2 v[136:137], v3, s[4:7], s50 offen offset:3584 sc1
s_add_u32 s50, s50, 4096
buffer_load_dword v7, v0, s[4:7], s59 offen sc1
s_add_u32 s44, s49, 0
buffer_load_dwordx4 a[96:99], v1, s[4:7], s44 offen offset:0 sc1 nt
s_add_u32 s44, s49, 0
buffer_load_dwordx4 a[100:103], v1, s[4:7], s44 offen offset:1024 sc1 nt
s_add_u32 s44, s49, 0
buffer_load_dwordx4 a[104:107], v1, s[4:7], s44 offen offset:2048 sc1 nt
s_add_u32 s44, s49, 0
buffer_load_dwordx4 a[108:111], v1, s[4:7], s44 offen offset:3072 sc1 nt
s_add_u32 s44, s49, 16384
buffer_load_dwordx4 a[160:163], v1, s[4:7], s44 offen offset:0 sc1 nt
s_add_u32 s44, s49, 16384
buffer_load_dwordx4 a[164:167], v1, s[4:7], s44 offen offset:1024 sc1 nt
s_add_u32 s44, s49, 16384
buffer_load_dwordx4 a[168:171], v1, s[4:7], s44 offen offset:2048 sc1 nt
s_add_u32 s44, s49, 16384
buffer_load_dwordx4 a[172:175], v1, s[4:7], s44 offen offset:3072 sc1 nt
s_add_u32 s44, s49, 4096
buffer_load_dwordx4 a[112:115], v1, s[4:7], s44 offen offset:0 sc1 nt
s_waitcnt vmcnt(17)
v_mfma_f32_16x16x32_bf16 v[148:151], v[112:115], a[64:67], 0
v_mfma_f32_16x16x32_bf16 v[160:163], v[112:115], a[80:83], 0
s_add_u32 s44, s49, 4096
buffer_load_dwordx4 a[116:119], v1, s[4:7], s44 offen offset:1024 sc1 nt
s_waitcnt vmcnt(17)
v_mfma_f32_16x16x32_bf16 v[148:151], v[116:119], a[68:71], v[148:151]
v_mfma_f32_16x16x32_bf16 v[160:163], v[116:119], a[84:87], v[160:163]
s_waitcnt vmcnt(16)
v_mfma_f32_16x16x32_bf16 v[148:151], v[120:123], a[72:75], v[148:151]
s_add_u32 s44, s49, 4096
buffer_load_dwordx4 a[120:123], v1, s[4:7], s44 offen offset:2048 sc1 nt
v_mfma_f32_16x16x32_bf16 v[160:163], v[120:123], a[88:91], v[160:163]
s_waitcnt vmcnt(16)
v_mfma_f32_16x16x32_bf16 v[148:151], v[124:127], a[76:79], v[148:151]
v_mfma_f32_16x16x32_bf16 v[160:163], v[124:127], a[92:95], v[160:163]
s_add_u32 s44, s49, 4096
buffer_load_dwordx4 a[124:127], v1, s[4:7], s44 offen offset:3072 sc1 nt
s_nop 1
v_max3_f32 v249, v148, v149, v150
s_nop 2
v_max3_f32 v251, v160, v161, v162
v_max3_f32 v248, v248, v249, v151
v_max3_f32 v250, v250, v251, v163
v_mov_b32 v249, v248
v_mov_b32 v251, v250
s_nop 0
v_permlane32_swap_b32 v248, v249
v_permlane32_swap_b32 v250, v251
v_max_f32 v248, v248, v249
s_add_u32 s44, s49, 20480
buffer_load_dwordx4 a[176:179], v1, s[4:7], s44 offen offset:0 sc1 nt
v_max_f32 v250, v250, v251
v_mov_b32 v249, v248
v_mov_b32 v251, v250
s_nop 0
v_permlane16_swap_b32 v248, v249
v_permlane16_swap_b32 v250, v251
v_max_f32 v248, v248, v249
v_max_f32 v250, v250, v251
v_mul_f32 v248, s47, v248
v_mul_f32 v250, s47, v250
s_add_u32 s44, s49, 20480
buffer_load_dwordx4 a[180:183], v1, s[4:7], s44 offen offset:1024 sc1 nt
v_fma_f32 v140, v140, s47, -v248
v_fma_f32 v141, v141, s47, -v248
v_fma_f32 v152, v152, s47, -v250
v_fma_f32 v153, v153, s47, -v250
v_fma_f32 v142, v142, s47, -v248
v_fma_f32 v143, v143, s47, -v248
v_fma_f32 v154, v154, s47, -v250
v_fma_f32 v155, v155, s47, -v250
v_exp_f32 v140, v140
v_exp_f32 v141, v141
s_add_u32 s44, s49, 20480
buffer_load_dwordx4 a[184:187], v1, s[4:7], s44 offen offset:2048 sc1 nt
v_exp_f32 v152, v152
v_exp_f32 v153, v153
v_fma_f32 v156, v156, s47, -v250
v_fma_f32 v157, v157, s47, -v250
v_fma_f32 v158, v158, s47, -v250
v_fma_f32 v159, v159, s47, -v250
v_exp_f32 v142, v142
v_exp_f32 v143, v143
s_add_u32 s44, s49, 20480
buffer_load_dwordx4 a[188:191], v1, s[4:7], s44 offen offset:3072 sc1 nt
v_exp_f32 v154, v154
v_exp_f32 v155, v155
v_fma_f32 v148, v148, s47, -v248
v_fma_f32 v149, v149, s47, -v248
v_exp_f32 v156, v156
v_exp_f32 v157, v157
v_exp_f32 v158, v158
v_exp_f32 v159, v159
v_fma_f32 v160, v160, s47, -v250
v_fma_f32 v161, v161, s47, -v250
v_fma_f32 v150, v150, s47, -v248
v_fma_f32 v151, v151, s47, -v248
v_cvt_pk_bf16_f32 v140, v140, v141
v_fma_f32 v162, v162, s47, -v250
v_fma_f32 v163, v163, s47, -v250
v_cvt_pk_bf16_f32 v152, v152, v153
v_exp_f32 v148, v148
v_exp_f32 v149, v149
v_cvt_pk_bf16_f32 v141, v142, v143
v_cvt_pk_bf16_f32 v153, v154, v155
v_mov_b32 v142, 0
v_mov_b32 v143, 0
v_cvt_pk_bf16_f32 v154, v156, v157
v_cvt_pk_bf16_f32 v155, v158, v159
v_mfma_f32_16x16x32_bf16 v[228:231], v[12:15], v[140:143], 0
v_exp_f32 v160, v160
v_mfma_f32_16x16x32_bf16 v[232:235], v[12:15], v[152:155], 0
v_exp_f32 v161, v161
v_mfma_f32_16x16x32_bf16 v[164:167], a[32:35], v[140:143], 0
v_exp_f32 v150, v150
v_mfma_f32_16x16x32_bf16 v[172:175], a[40:43], v[140:143], 0
v_exp_f32 v151, v151
v_mfma_f32_16x16x32_bf16 v[180:183], a[48:51], v[140:143], 0
v_exp_f32 v162, v162
v_mfma_f32_16x16x32_bf16 v[188:191], a[56:59], v[140:143], 0
v_exp_f32 v163, v163
v_mfma_f32_16x16x32_bf16 v[196:199], a[32:35], v[152:155], 0
v_cvt_pk_bf16_f32 v148, v148, v149
v_cvt_pk_bf16_f32 v160, v160, v161
v_mfma_f32_16x16x32_bf16 v[204:207], a[40:43], v[152:155], 0
v_cvt_pk_bf16_f32 v149, v150, v151
v_cvt_pk_bf16_f32 v161, v162, v163
v_mfma_f32_16x16x32_bf16 v[212:215], a[48:51], v[152:155], 0
v_cndmask_b32 v236, 0, v148, s[62:63]
v_cndmask_b32 v237, 0, v149, s[62:63]
v_mfma_f32_16x16x32_bf16 v[220:223], a[56:59], v[152:155], 0
v_cndmask_b32 v242, 0, v160, s[62:63]
v_cndmask_b32 v243, 0, v161, s[62:63]
v_mfma_f32_16x16x32_bf16 v[228:231], v[12:15], v[236:239], v[228:231]
v_cndmask_b32 v240, v148, 0, s[62:63]
v_cndmask_b32 v241, v149, 0, s[62:63]
v_mfma_f32_16x16x32_bf16 v[232:235], v[12:15], v[242:245], v[232:235]
v_cndmask_b32 v246, v160, 0, s[62:63]
v_cndmask_b32 v247, v161, 0, s[62:63]
v_mfma_f32_16x16x32_bf16 v[168:171], a[36:39], v[140:143], 0
s_waitcnt vmcnt(16)
v_cmp_gt_u32 vcc, s60, v7
s_nop 0
s_cbranch_vccnz L_slow5
L_ret5:
v_mfma_f32_16x16x32_bf16 v[176:179], a[44:47], v[140:143], 0
v_rcp_f32 v228, v228
v_mfma_f32_16x16x32_bf16 v[184:187], a[52:55], v[140:143], 0
v_rcp_f32 v232, v232
v_mfma_f32_16x16x32_bf16 v[192:195], a[60:63], v[140:143], 0
v_mov_b32 v7, s38
v_mfma_f32_16x16x32_bf16 v[200:203], a[36:39], v[152:155], 0
v_mfma_f32_16x16x32_bf16 v[208:211], a[44:47], v[152:155], 0
v_mfma_f32_16x16x32_bf16 v[216:219], a[52:55], v[152:155], 0
v_mfma_f32_16x16x32_bf16 v[224:227], a[60:63], v[152:155], 0
v_mfma_f32_16x16x32_bf16 v[164:167], v[130:133], v[236:239], v[164:167]
v_mfma_f32_16x16x32_bf16 v[172:175], v[132:135], v[236:239], v[172:175]
v_mfma_f32_16x16x32_bf16 v[180:183], v[134:137], v[236:239], v[180:183]
v_mul_f32 v164, v164, v228
v_mul_f32 v165, v165, v228
v_mfma_f32_16x16x32_bf16 v[188:191], v[136:139], v[236:239], v[188:191]
v_mul_f32 v172, v172, v228
v_mul_f32 v173, v173, v228
v_mfma_f32_16x16x32_bf16 v[196:199], v[130:133], v[242:245], v[196:199]
v_mul_f32 v180, v180, v228
v_mul_f32 v181, v181, v228
v_mfma_f32_16x16x32_bf16 v[204:207], v[132:135], v[242:245], v[204:207]
v_mul_f32 v188, v188, v228
v_mul_f32 v189, v189, v228
v_mfma_f32_16x16x32_bf16 v[212:215], v[134:137], v[242:245], v[212:215]
v_mul_f32 v196, v196, v232
v_mul_f32 v197, v197, v232
v_mfma_f32_16x16x32_bf16 v[220:223], v[136:139], v[242:245], v[220:223]
v_mul_f32 v204, v204, v232
v_mul_f32 v205, v205, v232
v_mfma_f32_16x16x32_bf16 v[168:171], v[128:131], v[238:241], v[168:171]
v_mul_f32 v212, v212, v232
v_mul_f32 v213, v213, v232
v_mfma_f32_16x16x32_bf16 v[176:179], v[130:133], v[238:241], v[176:179]
v_mul_f32 v220, v220, v232
v_mul_f32 v221, v221, v232
v_mfma_f32_16x16x32_bf16 v[184:187], v[132:135], v[238:241], v[184:187]
v_mul_f32 v166, v166, v228
v_mul_f32 v167, v167, v228
v_mfma_f32_16x16x32_bf16 v[192:195], v[134:137], v[238:241], v[192:195]
v_mul_f32 v174, v174, v228
v_mul_f32 v175, v175, v228
v_mfma_f32_16x16x32_bf16 v[200:203], v[128:131], v[244:247], v[200:203]
v_mul_f32 v182, v182, v228
v_mul_f32 v183, v183, v228
v_mfma_f32_16x16x32_bf16 v[208:211], v[130:133], v[244:247], v[208:211]
v_cvt_pk_bf16_f32 v164, v164, v165
v_mul_f32 v168, v168, v228
v_mul_f32 v169, v169, v228
v_mul_f32 v170, v170, v228
v_mul_f32 v171, v171, v228
v_cvt_pk_bf16_f32 v165, v166, v167
v_cvt_pk_bf16_f32 v166, v168, v169
v_cvt_pk_bf16_f32 v167, v170, v171
v_mul_f32 v190, v190, v228
buffer_store_dwordx4 v[164:167], v4, s[4:7], s57 offen offset:0
v_mul_f32 v191, v191, v228
v_cvt_pk_bf16_f32 v172, v172, v173
v_mul_f32 v176, v176, v228
v_mul_f32 v177, v177, v228
v_mul_f32 v178, v178, v228
v_mul_f32 v179, v179, v228
v_cvt_pk_bf16_f32 v173, v174, v175
v_cvt_pk_bf16_f32 v174, v176, v177
v_cvt_pk_bf16_f32 v175, v178, v179
v_mfma_f32_16x16x32_bf16 v[216:219], v[132:135], v[244:247], v[216:219]
buffer_store_dwordx4 v[172:175], v4, s[4:7], s57 offen offset:2048
v_cvt_pk_bf16_f32 v180, v180, v181
v_mul_f32 v184, v184, v228
v_mul_f32 v185, v185, v228
v_mul_f32 v186, v186, v228
v_mul_f32 v187, v187, v228
v_cvt_pk_bf16_f32 v181, v182, v183
v_cvt_pk_bf16_f32 v182, v184, v185
v_cvt_pk_bf16_f32 v183, v186, v187
v_mul_f32 v198, v198, v232
v_mul_f32 v199, v199, v232
buffer_store_dwordx4 v[180:183], v4, s[4:7], s58 offen offset:0
v_cvt_pk_bf16_f32 v188, v188, v189
v_mul_f32 v192, v192, v228
v_mul_f32 v193, v193, v228
v_mul_f32 v194, v194, v228
v_mul_f32 v195, v195, v228
v_cvt_pk_bf16_f32 v189, v190, v191
v_cvt_pk_bf16_f32 v190, v192, v193
v_cvt_pk_bf16_f32 v191, v194, v195
v_mfma_f32_16x16x32_bf16 v[224:227], v[134:137], v[244:247], v[224:227]
buffer_store_dwordx4 v[188:191], v4, s[4:7], s58 offen offset:2048
v_cvt_pk_bf16_f32 v196, v196, v197
v_mul_f32 v200, v200, v232
v_mul_f32 v201, v201, v232
v_mul_f32 v202, v202, v232
v_mul_f32 v203, v203, v232
v_cvt_pk_bf16_f32 v197, v198, v199
v_cvt_pk_bf16_f32 v198, v200, v201
v_cvt_pk_bf16_f32 v199, v202, v203
v_mul_f32 v206, v206, v232
v_mul_f32 v207, v207, v232
buffer_store_dwordx4 v[196:199], v4, s[4:7], s57 offen offset:256
v_cvt_pk_bf16_f32 v204, v204, v205
v_mul_f32 v208, v208, v232
v_mul_f32 v209, v209, v232
v_mul_f32 v210, v210, v232
v_mul_f32 v211, v211, v232
v_cvt_pk_bf16_f32 v205, v206, v207
v_cvt_pk_bf16_f32 v206, v208, v209
v_cvt_pk_bf16_f32 v207, v210, v211
v_mul_f32 v214, v214, v232
v_mul_f32 v215, v215, v232
buffer_store_dwordx4 v[204:207], v4, s[4:7], s57 offen offset:2304
v_cvt_pk_bf16_f32 v212, v212, v213
v_mul_f32 v216, v216, v232
v_mul_f32 v217, v217, v232
v_mul_f32 v218, v218, v232
v_mul_f32 v219, v219, v232
v_cvt_pk_bf16_f32 v213, v214, v215
v_cvt_pk_bf16_f32 v214, v216, v217
v_cvt_pk_bf16_f32 v215, v218, v219
v_mul_f32 v222, v222, v232
v_mul_f32 v223, v223, v232
buffer_store_dwordx4 v[212:215], v4, s[4:7], s58 offen offset:256
v_cvt_pk_bf16_f32 v220, v220, v221
v_mul_f32 v224, v224, v232
v_mul_f32 v225, v225, v232
v_mul_f32 v226, v226, v232
v_mul_f32 v227, v227, v232
v_cvt_pk_bf16_f32 v221, v222, v223
v_cvt_pk_bf16_f32 v222, v224, v225
v_cvt_pk_bf16_f32 v223, v226, v227
s_add_u32 s57, s57, s61
buffer_store_dwordx4 v[220:223], v4, s[4:7], s58 offen offset:2304
s_add_u32 s58, s58, s61
s_waitcnt vmcnt(0)
s_cmp_eq_u32 s36, 0
s_cbranch_scc1 L_slow6
L_ret6:
buffer_store_dword v7, v6, s[4:7], s56 offen
s_add_u32 s44, s49, 8192
buffer_load_dwordx4 a[128:131], v1, s[4:7], s44 offen offset:0 sc1 nt
s_add_u32 s44, s49, 8192
buffer_load_dwordx4 a[132:135], v1, s[4:7], s44 offen offset:1024 sc1 nt
s_add_u32 s44, s49, 8192
buffer_load_dwordx4 a[136:139], v1, s[4:7], s44 offen offset:2048 sc1 nt
s_add_u32 s44, s49, 8192
buffer_load_dwordx4 a[140:143], v1, s[4:7], s44 offen offset:3072 sc1 nt
s_add_u32 s44, s49, 12288
buffer_load_dwordx4 a[144:147], v1, s[4:7], s44 offen offset:0 sc1 nt
s_add_u32 s44, s49, 12288
buffer_load_dwordx4 a[148:151], v1, s[4:7], s44 offen offset:1024 sc1 nt
s_add_u32 s44, s49, 12288
buffer_load_dwordx4 a[152:155], v1, s[4:7], s44 offen offset:2048 sc1 nt
s_add_u32 s44, s49, 12288
buffer_load_dwordx4 a[156:159], v1, s[4:7], s44 offen offset:3072 sc1 nt
s_add_u32 s38, s38, 1
s_cmp_lt_u32 s12, s38
s_cbranch_scc1 L_slow7
L_ret7:
s_buffer_load_dwordx8 s[12:19], s[4:7], s52 glc
s_add_u32 s49, s49, 24576
s_cmp_lt_u32 s38, 64
s_cselect_b32 s49, s49, 0x7fff0000
v_mfma_f32_16x16x32_bf16 v[140:143], a[96:99], a[160:163], v[8:11]
v_mfma_f32_16x16x32_bf16 v[140:143], a[100:103], a[164:167], v[140:143]
v_mfma_f32_16x16x32_bf16 v[140:143], a[104:107], a[168:171], v[140:143]
v_mfma_f32_16x16x32_bf16 v[140:143], a[108:111], a[172:175], v[140:143]
v_mfma_f32_16x16x32_bf16 v[152:155], a[96:99], a[176:179], 0
v_mfma_f32_16x16x32_bf16 v[152:155], a[100:103], a[180:183], v[152:155]
v_mfma_f32_16x16x32_bf16 v[152:155], a[104:107], a[184:187], v[152:155]
v_mfma_f32_16x16x32_bf16 v[152:155], a[108:111], a[188:191], v[152:155]
v_mfma_f32_16x16x32_bf16 v[156:159], a[112:115], a[176:179], v[8:11]
v_mfma_f32_16x16x32_bf16 v[156:159], a[116:119], a[180:183], v[156:159]
v_mfma_f32_16x16x32_bf16 v[156:159], a[120:123], a[184:187], v[156:159]
v_mfma_f32_16x16x32_bf16 v[156:159], a[124:127], a[188:191], v[156:159]
L_att_m1:
s_waitcnt lgkmcnt(0)
s_min_u32 s16, s16, s17
s_min_u32 s16, s16, s18
s_min_u32 s16, s16, s19
s_cmp_ge_u32 s16, s38
s_cbranch_scc1 L_att_md1
s_buffer_load_dwordx8 s[12:19], s[4:7], s52 glc
s_sub_u32 s37, s37, 1
s_cbranch_scc0 L_att_m1
s_movk_i32 s39, 51
s_branch L_bail
L_att_md1:
buffer_load_dwordx4 v[112:115], v2, s[4:7], s50 offen offset:0 sc1
v_max3_f32 v250, v152, v153, v154
v_max3_f32 v248, v140, v141, v142
v_max_f32 v250, v250, v155
v_max_f32 v248, v248, v143
v_max3_f32 v250, v250, v156, v157
s_sub_i32 s60, s38, 4
v_max3_f32 v250, v250, v158, v159
s_max_i32 s60, s60, 0
buffer_load_dwordx4 v[116:119], v2, s[4:7], s50 offen offset:512 sc1
s_min_u32 s12, s12, s13
s_min_u32 s12, s12, s14
s_and_b32 s61, s38, 3
s_cselect_b32 s61, 1, -3
s_mul_i32 s61, s61, 18432
s_min_u32 s12, s12, s15
buffer_load_dwordx4 v[120:123], v2, s[4:7], s50 offen offset:1024 sc1
buffer_load_dwordx4 v[124:127], v2, s[4:7], s50 offen offset:1536 sc1
buffer_load_dwordx2 v[130:131], v3, s[4:7], s50 offen offset:2048 sc1
buffer_load_dwordx2 v[132:133], v3, s[4:7], s50 offen offset:2560 sc1
buffer_load_dwordx2 v[134:135], v3, s[4:7], s50 offen offset:3072 sc1
buffer_load_dwordx2 v[136:137], v3, s[4:7], s50 offen offset:3584 sc1
s_add_u32 s50, s50, 4096
buffer_load_dword v7, v0, s[4:7], s59 offen sc1
s_add_u32 s44, s49, 0
buffer_load_dwordx4 a[0:3], v1, s[4:7], s44 offen offset:0 sc1 nt
s_add_u32 s44, s49, 0
buffer_load_dwordx4 a[4:7], v1, s[4:7], s44 offen offset:1024 sc1 nt
s_add_u32 s44, s49, 0
buffer_load_dwordx4 a[8:11], v1, s[4:7], s44 offen offset:2048 sc1 nt
s_add_u32 s44, s49, 0
buffer_load_dwordx4 a[12:15], v1, s[4:7], s44 offen offset:3072 sc1 nt
s_add_u32 s44, s49, 16384
buffer_load_dwordx4 a[64:67], v1, s[4:7], s44 offen offset:0 sc1 nt
s_add_u32 s44, s49, 16384
buffer_load_dwordx4 a[68:71], v1, s[4:7], s44 offen offset:1024 sc1 nt
s_add_u32 s44, s49, 16384
buffer_load_dwordx4 a[72:75], v1, s[4:7], s44 offen offset:2048 sc1 nt
s_add_u32 s44, s49, 16384
buffer_load_dwordx4 a[76:79], v1, s[4:7], s44 offen offset:3072 sc1 nt
s_add_u32 s44, s49, 4096
buffer_load_dwordx4 a[16:19], v1, s[4:7], s44 offen offset:0 sc1 nt
s_waitcnt vmcnt(17)
v_mfma_f32_16x16x32_bf16 v[148:151], v[112:115], a[160:163], 0
v_mfma_f32_16x16x32_bf16 v[160:163], v[112:115], a[176:179], 0
s_add_u32 s44, s49, 4096
buffer_load_dwordx4 a[20:23], v1, s[4:7], s44 offen offset:1024 sc1 nt
s_waitcnt vmcnt(17)
v_mfma_f32_16x16x32_bf16 v[148:151], v[116:119], a[164:167], v[148:151]
v_mfma_f32_16x16x32_bf16 v[160:163], v[116:119], a[180:183], v[160:163]
s_waitcnt vmcnt(16)
v_mfma_f32_16x16x32_bf16 v[148:151], v[120:123], a[168:171], v[148:151]
s_add_u32 s44, s49, 4096
buffer_load_dwordx4 a[24:27], v1, s[4:7], s44 offen offset:2048 sc1 nt
v_mfma_f32_16x16x32_bf16 v[160:163], v[120:123], a[184:187], v[160:163]
s_waitcnt vmcnt(16)
v_mfma_f32_16x16x32_bf16 v[148:151], v[124:127], a[172:175], v[148:151]
v_mfma_f32_16x16x32_bf16 v[160:163], v[124:127], a[188:191], v[160:163]
s_add_u32 s44, s49, 4096
buffer_load_dwordx4 a[28:31], v1, s[4:7], s44 offen offset:3072 sc1 nt
s_nop 1
v_max3_f32 v249, v148, v149, v150
s_nop 2
v_max3_f32 v251, v160, v161, v162
v_max3_f32 v248, v248, v249, v151
v_max3_f32 v250, v250, v251, v163
v_mov_b32 v249, v248
v_mov_b32 v251, v250
s_nop 0
v_permlane32_swap_b32 v248, v249
v_permlane32_swap_b32 v250, v251
v_max_f32 v248, v248, v249
s_add_u32 s44, s49, 20480
buffer_load_dwordx4 a[80:83], v1, s[4:7], s44 offen offset:0 sc1 nt
v_max_f32 v250, v250, v251
v_mov_b32 v249, v248
v_mov_b32 v251, v250
s_nop 0
v_permlane16_swap_b32 v248, v249
v_permlane16_swap_b32 v250, v251
v_max_f32 v248, v248, v249
v_max_f32 v250, v250, v251
v_mul_f32 v248, s47, v248
v_mul_f32 v250, s47, v250
s_add_u32 s44, s49, 20480
buffer_load_dwordx4 a[84:87], v1, s[4:7], s44 offen offset:1024 sc1 nt
v_fma_f32 v140, v140, s47, -v248
v_fma_f32 v141, v141, s47, -v248
v_fma_f32 v152, v152, s47, -v250
v_fma_f32 v153, v153, s47, -v250
v_fma_f32 v142, v142, s47, -v248
v_fma_f32 v143, v143, s47, -v248
v_fma_f32 v154, v154, s47, -v250
v_fma_f32 v155, v155, s47, -v250
v_exp_f32 v140, v140
v_exp_f32 v141, v141
s_add_u32 s44, s49, 20480
buffer_load_dwordx4 a[88:91], v1, s[4:7], s44 offen offset:2048 sc1 nt
v_exp_f32 v152, v152
v_exp_f32 v153, v153
v_fma_f32 v156, v156, s47, -v250
v_fma_f32 v157, v157, s47, -v250
v_fma_f32 v158, v158, s47, -v250
v_fma_f32 v159, v159, s47, -v250
v_exp_f32 v142, v142
v_exp_f32 v143, v143
s_add_u32 s44, s49, 20480
buffer_load_dwordx4 a[92:95], v1, s[4:7], s44 offen offset:3072 sc1 nt
v_exp_f32 v154, v154
v_exp_f32 v155, v155
v_fma_f32 v148, v148, s47, -v248
v_fma_f32 v149, v149, s47, -v248
v_exp_f32 v156, v156
v_exp_f32 v157, v157
v_exp_f32 v158, v158
v_exp_f32 v159, v159
v_fma_f32 v160, v160, s47, -v250
v_fma_f32 v161, v161, s47, -v250
v_fma_f32 v150, v150, s47, -v248
v_fma_f32 v151, v151, s47, -v248
v_cvt_pk_bf16_f32 v140, v140, v141
v_fma_f32 v162, v162, s47, -v250
v_fma_f32 v163, v163, s47, -v250
v_cvt_pk_bf16_f32 v152, v152, v153
v_exp_f32 v148, v148
v_exp_f32 v149, v149
v_cvt_pk_bf16_f32 v141, v142, v143
v_cvt_pk_bf16_f32 v153, v154, v155
v_mov_b32 v142, 0
v_mov_b32 v143, 0
v_cvt_pk_bf16_f32 v154, v156, v157
v_cvt_pk_bf16_f32 v155, v158, v159
v_mfma_f32_16x16x32_bf16 v[228:231], v[12:15], v[140:143], 0
v_exp_f32 v160, v160
v_mfma_f32_16x16x32_bf16 v[232:235], v[12:15], v[152:155], 0
v_exp_f32 v161, v161
v_mfma_f32_16x16x32_bf16 v[164:167], a[128:131], v[140:143], 0
v_exp_f32 v150, v150
v_mfma_f32_16x16x32_bf16 v[172:175], a[136:139], v[140:143], 0
v_exp_f32 v151, v151
v_mfma_f32_16x16x32_bf16 v[180:183], a[144:147], v[140:143], 0
v_exp_f32 v162, v162
v_mfma_f32_16x16x32_bf16 v[188:191], a[152:155], v[140:143], 0
v_exp_f32 v163, v163
v_mfma_f32_16x16x32_bf16 v[196:199], a[128:131], v[152:155], 0
v_cvt_pk_bf16_f32 v148, v148, v149
v_cvt_pk_bf16_f32 v160, v160, v161
v_mfma_f32_16x16x32_bf16 v[204:207], a[136:139], v[152:155], 0
v_cvt_pk_bf16_f32 v149, v150, v151
v_cvt_pk_bf16_f32 v161, v162, v163
v_mfma_f32_16x16x32_bf16 v[212:215], a[144:147], v[152:155], 0
v_cndmask_b32 v236, 0, v148, s[62:63]
v_cndmask_b32 v237, 0, v149, s[62:63]
v_mfma_f32_16x16x32_bf16 v[220:223], a[152:155], v[152:155], 0
v_cndmask_b32 v242, 0, v160, s[62:63]
v_cndmask_b32 v243, 0, v161, s[62:63]
v_mfma_f32_16x16x32_bf16 v[228:231], v[12:15], v[236:239], v[228:231]
v_cndmask_b32 v240, v148, 0, s[62:63]
v_cndmask_b32 v241, v149, 0, s[62:63]
v_mfma_f32_16x16x32_bf16 v[232:235], v[12:15], v[242:245], v[232:235]
v_cndmask_b32 v246, v160, 0, s[62:63]
v_cndmask_b32 v247, v161, 0, s[62:63]
v_mfma_f32_16x16x32_bf16 v[168:171], a[132:135], v[140:143], 0
s_waitcnt vmcnt(16)
v_cmp_gt_u32 vcc, s60, v7
s_nop 0
s_cbranch_vccnz L_slow8
L_ret8:
v_mfma_f32_16x16x32_bf16 v[176:179], a[140:143], v[140:143], 0
v_rcp_f32 v228, v228
v_mfma_f32_16x16x32_bf16 v[184:187], a[148:151], v[140:143], 0
v_rcp_f32 v232, v232
v_mfma_f32_16x16x32_bf16 v[192:195], a[156:159], v[140:143], 0
v_mov_b32 v7, s38
v_mfma_f32_16x16x32_bf16 v[200:203], a[132:135], v[152:155], 0
v_mfma_f32_16x16x32_bf16 v[208:211], a[140:143], v[152:155], 0
v_mfma_f32_16x16x32_bf16 v[216:219], a[148:151], v[152:155], 0
v_mfma_f32_16x16x32_bf16 v[224:227], a[156:159], v[152:155], 0
v_mfma_f32_16x16x32_bf16 v[164:167], v[130:133], v[236:239], v[164:167]
v_mfma_f32_16x16x32_bf16 v[172:175], v[132:135], v[236:239], v[172:175]
v_mfma_f32_16x16x32_bf16 v[180:183], v[134:137], v[236:239], v[180:183]
v_mul_f32 v164, v164, v228
v_mul_f32 v165, v165, v228
v_mfma_f32_16x16x32_bf16 v[188:191], v[136:139], v[236:239], v[188:191]
v_mul_f32 v172, v172, v228
v_mul_f32 v173, v173, v228
v_mfma_f32_16x16x32_bf16 v[196:199], v[130:133], v[242:245], v[196:199]
v_mul_f32 v180, v180, v228
v_mul_f32 v181, v181, v228
v_mfma_f32_16x16x32_bf16 v[204:207], v[132:135], v[242:245], v[204:207]
v_mul_f32 v188, v188, v228
v_mul_f32 v189, v189, v228
v_mfma_f32_16x16x32_bf16 v[212:215], v[134:137], v[242:245], v[212:215]
v_mul_f32 v196, v196, v232
v_mul_f32 v197, v197, v232
v_mfma_f32_16x16x32_bf16 v[220:223], v[136:139], v[242:245], v[220:223]
v_mul_f32 v204, v204, v232
v_mul_f32 v205, v205, v232
v_mfma_f32_16x16x32_bf16 v[168:171], v[128:131], v[238:241], v[168:171]
v_mul_f32 v212, v212, v232
v_mul_f32 v213, v213, v232
v_mfma_f32_16x16x32_bf16 v[176:179], v[130:133], v[238:241], v[176:179]
v_mul_f32 v220, v220, v232
v_mul_f32 v221, v221, v232
v_mfma_f32_16x16x32_bf16 v[184:187], v[132:135], v[238:241], v[184:187]
v_mul_f32 v166, v166, v228
v_mul_f32 v167, v167, v228
v_mfma_f32_16x16x32_bf16 v[192:195], v[134:137], v[238:241], v[192:195]
v_mul_f32 v174, v174, v228
v_mul_f32 v175, v175, v228
v_mfma_f32_16x16x32_bf16 v[200:203], v[128:131], v[244:247], v[200:203]
v_mul_f32 v182, v182, v228
v_mul_f32 v183, v183, v228
v_mfma_f32_16x16x32_bf16 v[208:211], v[130:133], v[244:247], v[208:211]
v_cvt_pk_bf16_f32 v164, v164, v165
v_mul_f32 v168, v168, v228
v_mul_f32 v169, v169, v228
v_mul_f32 v170, v170, v228
v_mul_f32 v171, v171, v228
v_cvt_pk_bf16_f32 v165, v166, v167
v_cvt_pk_bf16_f32 v166, v168, v169
v_cvt_pk_bf16_f32 v167, v170, v171
v_mul_f32 v190, v190, v228
buffer_store_dwordx4 v[164:167], v4, s[4:7], s57 offen offset:0
v_mul_f32 v191, v191, v228
v_cvt_pk_bf16_f32 v172, v172, v173
v_mul_f32 v176, v176, v228
v_mul_f32 v177, v177, v228
v_mul_f32 v178, v178, v228
v_mul_f32 v179, v179, v228
v_cvt_pk_bf16_f32 v173, v174, v175
v_cvt_pk_bf16_f32 v174, v176, v177
v_cvt_pk_bf16_f32 v175, v178, v179
v_mfma_f32_16x16x32_bf16 v[216:219], v[132:135], v[244:247], v[216:219]
buffer_store_dwordx4 v[172:175], v4, s[4:7], s57 offen offset:2048
v_cvt_pk_bf16_f32 v180, v180, v181
v_mul_f32 v184, v184, v228
v_mul_f32 v185, v185, v228
v_mul_f32 v186, v186, v228
v_mul_f32 v187, v187, v228
v_cvt_pk_bf16_f32 v181, v182, v183
v_cvt_pk_bf16_f32 v182, v184, v185
v_cvt_pk_bf16_f32 v183, v186, v187
v_mul_f32 v198, v198, v232
v_mul_f32 v199, v199, v232
buffer_store_dwordx4 v[180:183], v4, s[4:7], s58 offen offset:0
v_cvt_pk_bf16_f32 v188, v188, v189
v_mul_f32 v192, v192, v228
v_mul_f32 v193, v193, v228
v_mul_f32 v194, v194, v228
v_mul_f32 v195, v195, v228
v_cvt_pk_bf16_f32 v189, v190, v191
v_cvt_pk_bf16_f32 v190, v192, v193
v_cvt_pk_bf16_f32 v191, v194, v195
v_mfma_f32_16x16x32_bf16 v[224:227], v[134:137], v[244:247], v[224:227]
buffer_store_dwordx4 v[188:191], v4, s[4:7], s58 offen offset:2048
v_cvt_pk_bf16_f32 v196, v196, v197
v_mul_f32 v200, v200, v232
v_mul_f32 v201, v201, v232
v_mul_f32 v202, v202, v232
v_mul_f32 v203, v203, v232
v_cvt_pk_bf16_f32 v197, v198, v199
v_cvt_pk_bf16_f32 v198, v200, v201
v_cvt_pk_bf16_f32 v199, v202, v203
v_mul_f32 v206, v206, v232
v_mul_f32 v207, v207, v232
buffer_store_dwordx4 v[196:199], v4, s[4:7], s57 offen offset:256
v_cvt_pk_bf16_f32 v204, v204, v205
v_mul_f32 v208, v208, v232
v_mul_f32 v209, v209, v232
v_mul_f32 v210, v210, v232
v_mul_f32 v211, v211, v232
v_cvt_pk_bf16_f32 v205, v206, v207
v_cvt_pk_bf16_f32 v206, v208, v209
v_cvt_pk_bf16_f32 v207, v210, v211
v_mul_f32 v214, v214, v232
v_mul_f32 v215, v215, v232
buffer_store_dwordx4 v[204:207], v4, s[4:7], s57 offen offset:2304
v_cvt_pk_bf16_f32 v212, v212, v213
v_mul_f32 v216, v216, v232
v_mul_f32 v217, v217, v232
v_mul_f32 v218, v218, v232
v_mul_f32 v219, v219, v232
v_cvt_pk_bf16_f32 v213, v214, v215
v_cvt_pk_bf16_f32 v214, v216, v217
v_cvt_pk_bf16_f32 v215, v218, v219
v_mul_f32 v222, v222, v232
v_mul_f32 v223, v223, v232
buffer_store_dwordx4 v[212:215], v4, s[4:7], s58 offen offset:256
v_cvt_pk_bf16_f32 v220, v220, v221
v_mul_f32 v224, v224, v232
v_mul_f32 v225, v225, v232
v_mul_f32 v226, v226, v232
v_mul_f32 v227, v227, v232
v_cvt_pk_bf16_f32 v221, v222, v223
v_cvt_pk_bf16_f32 v222, v224, v225
v_cvt_pk_bf16_f32 v223, v226, v227
s_add_u32 s57, s57, s61
buffer_store_dwordx4 v[220:223], v4, s[4:7], s58 offen offset:2304
s_add_u32 s58, s58, s61
s_waitcnt vmcnt(0)
s_cmp_eq_u32 s36, 0
s_cbranch_scc1 L_slow9
L_ret9:
buffer_store_dword v7, v6, s[4:7], s56 offen
s_add_u32 s44, s49, 8192
buffer_load_dwordx4 a[32:35], v1, s[4:7], s44 offen offset:0 sc1 nt
s_add_u32 s44, s49, 8192
buffer_load_dwordx4 a[36:39], v1, s[4:7], s44 offen offset:1024 sc1 nt
s_add_u32 s44, s49, 8192
buffer_load_dwordx4 a[40:43], v1, s[4:7], s44 offen offset:2048 sc1 nt
s_add_u32 s44, s49, 8192
buffer_load_dwordx4 a[44:47], v1, s[4:7], s44 offen offset:3072 sc1 nt
s_add_u32 s44, s49, 12288
buffer_load_dwordx4 a[48:51], v1, s[4:7], s44 offen offset:0 sc1 nt
s_add_u32 s44, s49, 12288
buffer_load_dwordx4 a[52:55], v1, s[4:7], s44 offen offset:1024 sc1 nt
s_add_u32 s44, s49, 12288
buffer_load_dwordx4 a[56:59], v1, s[4:7], s44 offen offset:2048 sc1 nt
s_add_u32 s44, s49, 12288
buffer_load_dwordx4 a[60:63], v1, s[4:7], s44 offen offset:3072 sc1 nt
s_add_u32 s38, s38, 1
s_cmp_le_u32 s38, 64
s_cbranch_scc1 L_att_loop
s_endpgm
L_slow4:
L_atto_sp1:
s_buffer_load_dwordx4 s[12:15], s[4:7], s52 glc
s_waitcnt lgkmcnt(0)
s_min_u32 s12, s12, s13
s_min_u32 s12, s12, s14
s_min_u32 s12, s12, s15
s_cmp_ge_u32 s12, s38
s_cbranch_scc1 L_atto_sd2
s_sleep 1
s_sub_u32 s37, s37, 1
s_cbranch_scc0 L_atto_sp1
s_movk_i32 s39, 53
s_branch L_bail
L_atto_sd2:
s_add_u32 s44, s49, 0
buffer_load_dwordx4 a[0:3], v1, s[4:7], s44 offen offset:0 sc1 nt
s_add_u32 s44, s49, 0
buffer_load_dwordx4 a[4:7], v1, s[4:7], s44 offen offset:1024 sc1 nt
s_add_u32 s44, s49, 0
buffer_load_dwordx4 a[8:11], v1, s[4:7], s44 offen offset:2048 sc1 nt
s_add_u32 s44, s49, 0
buffer_load_dwordx4 a[12:15], v1, s[4:7], s44 offen offset:3072 sc1 nt
s_add_u32 s44, s49, 16384
buffer_load_dwordx4 a[64:67], v1, s[4:7], s44 offen offset:0 sc1 nt
s_add_u32 s44, s49, 16384
buffer_load_dwordx4 a[68:71], v1, s[4:7], s44 offen offset:1024 sc1 nt
s_add_u32 s44, s49, 16384
buffer_load_dwordx4 a[72:75], v1, s[4:7], s44 offen offset:2048 sc1 nt
s_add_u32 s44, s49, 16384
buffer_load_dwordx4 a[76:79], v1, s[4:7], s44 offen offset:3072 sc1 nt
s_add_u32 s44, s49, 4096
buffer_load_dwordx4 a[16:19], v1, s[4:7], s44 offen offset:0 sc1 nt
s_add_u32 s44, s49, 4096
buffer_load_dwordx4 a[20:23], v1, s[4:7], s44 offen offset:1024 sc1 nt
s_add_u32 s44, s49, 4096
buffer_load_dwordx4 a[24:27], v1, s[4:7], s44 offen offset:2048 sc1 nt
s_add_u32 s44, s49, 4096
buffer_load_dwordx4 a[28:31], v1, s[4:7], s44 offen offset:3072 sc1 nt
s_add_u32 s44, s49, 20480
buffer_load_dwordx4 a[80:83], v1, s[4:7], s44 offen offset:0 sc1 nt
s_add_u32 s44, s49, 20480
buffer_load_dwordx4 a[84:87], v1, s[4:7], s44 offen offset:1024 sc1 nt
s_add_u32 s44, s49, 20480
buffer_load_dwordx4 a[88:91], v1, s[4:7], s44 offen offset:2048 sc1 nt
s_add_u32 s44, s49, 20480
buffer_load_dwordx4 a[92:95], v1, s[4:7], s44 offen offset:3072 sc1 nt
s_add_u32 s44, s49, 8192
buffer_load_dwordx4 a[32:35], v1, s[4:7], s44 offen offset:0 sc1 nt
s_add_u32 s44, s49, 8192
buffer_load_dwordx4 a[36:39], v1, s[4:7], s44 offen offset:1024 sc1 nt
s_add_u32 s44, s49, 8192
buffer_load_dwordx4 a[40:43], v1, s[4:7], s44 offen offset:2048 sc1 nt
s_add_u32 s44, s49, 8192
buffer_load_dwordx4 a[44:47], v1, s[4:7], s44 offen offset:3072 sc1 nt
s_add_u32 s44, s49, 12288
buffer_load_dwordx4 a[48:51], v1, s[4:7], s44 offen offset:0 sc1 nt
s_add_u32 s44, s49, 12288
buffer_load_dwordx4 a[52:55], v1, s[4:7], s44 offen offset:1024 sc1 nt
s_add_u32 s44, s49, 12288
buffer_load_dwordx4 a[56:59], v1, s[4:7], s44 offen offset:2048 sc1 nt
s_add_u32 s44, s49, 12288
buffer_load_dwordx4 a[60:63], v1, s[4:7], s44 offen offset:3072 sc1 nt
s_waitcnt vmcnt(0)
s_branch L_ret4
L_slow5:
L_atto_poll3:
buffer_load_dword v7, v0, s[4:7], s59 offen sc1
s_waitcnt vmcnt(0)
v_cmp_gt_u32 vcc, s60, v7
s_nop 0
s_cbranch_vccz L_atto_pd4
s_sleep 1
s_sub_u32 s37, s37, 1
s_cbranch_scc0 L_atto_poll3
s_movk_i32 s39, 55
s_branch L_bail
L_atto_pd4:
s_branch L_ret5
L_slow6:
s_waitcnt vmcnt(0)
buffer_wbl2 sc1
s_waitcnt vmcnt(0)
buffer_store_dword v7, v5, s[4:7], s56 offen sc1
s_branch L_ret6
L_slow7:
L_atto_sp5:
s_buffer_load_dwordx4 s[12:15], s[4:7], s52 glc
s_waitcnt lgkmcnt(0)
s_min_u32 s12, s12, s13
s_min_u32 s12, s12, s14
s_min_u32 s12, s12, s15
s_cmp_ge_u32 s12, s38
s_cbranch_scc1 L_atto_sd6
s_sleep 1
s_sub_u32 s37, s37, 1
s_cbranch_scc0 L_atto_sp5
s_movk_i32 s39, 53
s_branch L_bail
L_atto_sd6:
s_add_u32 s44, s49, 0
buffer_load_dwordx4 a[96:99], v1, s[4:7], s44 offen offset:0 sc1 nt
s_add_u32 s44, s49, 0
buffer_load_dwordx4 a[100:103], v1, s[4:7], s44 offen offset:1024 sc1 nt
s_add_u32 s44, s49, 0
buffer_load_dwordx4 a[104:107], v1, s[4:7], s44 offen offset:2048 sc1 nt
s_add_u32 s44, s49, 0
buffer_load_dwordx4 a[108:111], v1, s[4:7], s44 offen offset:3072 sc1 nt
s_add_u32 s44, s49, 16384
buffer_load_dwordx4 a[160:163], v1, s[4:7], s44 offen offset:0 sc1 nt
s_add_u32 s44, s49, 16384
buffer_load_dwordx4 a[164:167], v1, s[4:7], s44 offen offset:1024 sc1 nt
s_add_u32 s44, s49, 16384
buffer_load_dwordx4 a[168:171], v1, s[4:7], s44 offen offset:2048 sc1 nt
s_add_u32 s44, s49, 16384
buffer_load_dwordx4 a[172:175], v1, s[4:7], s44 offen offset:3072 sc1 nt
s_add_u32 s44, s49, 4096
buffer_load_dwordx4 a[112:115], v1, s[4:7], s44 offen offset:0 sc1 nt
s_add_u32 s44, s49, 4096
buffer_load_dwordx4 a[116:119], v1, s[4:7], s44 offen offset:1024 sc1 nt
s_add_u32 s44, s49, 4096
buffer_load_dwordx4 a[120:123], v1, s[4:7], s44 offen offset:2048 sc1 nt
s_add_u32 s44, s49, 4096
buffer_load_dwordx4 a[124:127], v1, s[4:7], s44 offen offset:3072 sc1 nt
s_add_u32 s44, s49, 20480
buffer_load_dwordx4 a[176:179], v1, s[4:7], s44 offen offset:0 sc1 nt
s_add_u32 s44, s49, 20480
buffer_load_dwordx4 a[180:183], v1, s[4:7], s44 offen offset:1024 sc1 nt
s_add_u32 s44, s49, 20480
buffer_load_dwordx4 a[184:187], v1, s[4:7], s44 offen offset:2048 sc1 nt
s_add_u32 s44, s49, 20480
buffer_load_dwordx4 a[188:191], v1, s[4:7], s44 offen offset:3072 sc1 nt
s_add_u32 s44, s49, 8192
buffer_load_dwordx4 a[128:131], v1, s[4:7], s44 offen offset:0 sc1 nt
s_add_u32 s44, s49, 8192
buffer_load_dwordx4 a[132:135], v1, s[4:7], s44 offen offset:1024 sc1 nt
s_add_u32 s44, s49, 8192
buffer_load_dwordx4 a[136:139], v1, s[4:7], s44 offen offset:2048 sc1 nt
s_add_u32 s44, s49, 8192
buffer_load_dwordx4 a[140:143], v1, s[4:7], s44 offen offset:3072 sc1 nt
s_add_u32 s44, s49, 12288
buffer_load_dwordx4 a[144:147], v1, s[4:7], s44 offen offset:0 sc1 nt
s_add_u32 s44, s49, 12288
buffer_load_dwordx4 a[148:151], v1, s[4:7], s44 offen offset:1024 sc1 nt
s_add_u32 s44, s49, 12288
buffer_load_dwordx4 a[152:155], v1, s[4:7], s44 offen offset:2048 sc1 nt
s_add_u32 s44, s49, 12288
buffer_load_dwordx4 a[156:159], v1, s[4:7], s44 offen offset:3072 sc1 nt
s_waitcnt vmcnt(0)
s_branch L_ret7
L_slow8:
L_atto_poll7:
buffer_load_dword v7, v0, s[4:7], s59 offen sc1
s_waitcnt vmcnt(0)
v_cmp_gt_u32 vcc, s60, v7
s_nop 0
s_cbranch_vccz L_atto_pd8
s_sleep 1
s_sub_u32 s37, s37, 1
s_cbranch_scc0 L_atto_poll7
s_movk_i32 s39, 55
s_branch L_bail
L_atto_pd8:
s_branch L_ret8
L_slow9:
s_waitcnt vmcnt(0)
buffer_wbl2 sc1
s_waitcnt vmcnt(0)
buffer_store_dword v7, v5, s[4:7], s56 offen sc1
s_branch L_ret9
L_at_red:
s_cmp_eq_u32 s33, 0
s_cselect_b32 s16, s64, s92
s_cselect_b32 s17, s65, s93
s_mov_b32 s44, 268435456
s_cselect_b32 s18, 2359296, s44
s_and_b32 s17, s17, 0xffff
s_mov_b32 s19, 0x20000
v_lshl_add_u32 v48, s35, 6, v0
v_lshlrev_b32 v48, 20, v48
buffer_load_dword v50, v48, s[4:7], 0 offen
buffer_load_dword v50, v48, s[16:19], 0 offen
v_and_b32 v48, 7, v0
v_lshlrev_b32 v48, 3, v48
L_red_cen1:
buffer_load_dwordx2 v[50:51], v48, s[24:27], s0 offen sc1
s_waitcnt vmcnt(0)
v_sad_u8 v49, v50, 0, 0
v_sad_u8 v49, v51, 0, v49
v_cmp_ne_u32 vcc, 32, v49
s_nop 0
s_cbranch_vccz L_red_cend2
s_sleep 16
s_sub_u32 s37, s37, 1
s_cbranch_scc0 L_red_cen1
s_movk_i32 s39, 57
s_branch L_bail
L_red_cend2:
v_bcnt_u32_b32 v49, v50, 0
v_bcnt_u32_b32 v49, v51, v49
v_cmp_ne_u32 vcc, 1, v49
v_readlane_b32 s41, v49, s1
s_cbranch_vccz L_red_cok3
s_cmp_eq_u32 s0, 0
s_cbranch_scc1 L_redo
L_red_cok3:
s_cmp_eq_u32 s41, 1
s_cselect_b32 s36, 1, 0
v_lshlrev_b32 v1, 4, v0
v_mov_b32 v7, 0
s_cmp_eq_u32 s36, 0
s_cselect_b32 s45, 0x7ffffff0, 0
v_mov_b32 v8, s45
v_lshrrev_b32 v49, 5, v0
v_and_b32 v50, 15, v0
v_lshrrev_b32 v51, 4, v0
v_mul_u32_u24 v2, 36864, v51
v_lshl_add_u32 v2, v50, 4, v2
v_lshrrev_b32 v52, 3, v0
v_mul_u32_u24 v3, 36864, v52
v_and_b32 v52, 7, v0
v_lshl_add_u32 v3, v52, 4, v3
s_lshl_b32 s47, s35, 13
v_and_b32 v4, 60, v0
v_lshl_add_u32 v4, v4, 2, s47
v_and_b32 v52, 1, v0
v_lshl_add_u32 v4, v52, 3, v4
v_bfe_u32 v53, v0, 1, 1
v_lshl_add_u32 v4, v53, 2, v4
v_bfe_u32 v53, v0, 1, 2
v_lshl_add_u32 v5, v53, 5, s47
v_lshl_add_u32 v5, v52, 3, v5
v_lshl_add_u32 v5, v49, 4, v5
v_bfe_u32 v53, v0, 4, 1
v_lshl_add_u32 v5, v53, 2, v5
v_add_u32 v5, 1024, v5
v_add_u32 v13, s47, v1
v_add_u32 v52, 1024, v1
v_mov_b32 v53, 0x7ffffff0
v_cmp_gt_u32 vcc, 8, v0
s_nop 1
v_cndmask_b32 v6, v53, v52, vcc
v_bfe_u32 v52, v0, 2, 2
v_and_b32 v53, 3, v0
v_lshl_add_u32 v52, v53, 2, v52
v_and_b32 v53, 1, v52
v_lshlrev_b32 v53, 4, v53
v_mov_b32 v54, 0x3f80
v_lshlrev_b32 v53, v53, v54
v_lshrrev_b32 v52, 1, v52
v_cmp_eq_u32 vcc, 0, v52
s_nop 1
v_cndmask_b32 v16, 0, v53, vcc
v_cmp_eq_u32 vcc, 1, v52
s_nop 1
v_cndmask_b32 v17, 0, v53, vcc
v_cmp_eq_u32 vcc, 2, v52
s_nop 1
v_cndmask_b32 v18, 0, v53, vcc
v_cmp_eq_u32 vcc, 3, v52
s_nop 1
v_cndmask_b32 v19, 0, v53, vcc
v_lshlrev_b32 v9, 2, v0
v_and_b32 v10, 124, v9
s_mov_b32 s8, 0xaaaaaaaa
s_mov_b32 s9, 0xaaaaaaaa
s_lshl_b32 s46, s34, 2
s_add_u32 s46, s46, s35
s_sub_u32 s46, s46, 32
s_lshl_b32 s45, s33, 9
s_add_u32 s54, s45, 16384
s_add_u32 s56, s45, 8192
s_add_u32 s41, s54, 2048
s_lshl_b32 s55, s46, 2
s_add_u32 s55, s55, s54
s_mul_i32 s44, s46, 1152
s_lshl_b32 s45, s33, 22
s_add_u32 s45, s45, 46137344
s_add_u32 s10, s44, s45
s_add_u32 s11, s10, 147456
s_add_u32 s12, s10, 294912
s_add_u32 s13, s10, 442368
s_mul_i32 s45, s33, 2359296
s_add_u32 s45, s45, s44
s_add_u32 s95, s45, 11534336
s_add_u32 s96, s45, 6815744
s_mul_i32 s94, s33, 16252928
s_add_u32 s94, s94, s44
s_mov_b32 s53, 12288
s_mov_b32 s64, s33
s_mov_b32 s38, 1
s_and_b32 s44, s46, 3
s_lshl_b32 s44, s44, 7
s_add_u32 s56, s56, s44
s_and_b32 s44, s46, 28
s_add_u32 s56, s56, s44
v_mov_b32 v14, 0
s_mov_b32 m0, s47
s_nop 0
buffer_load_dwordx4 v1, s[16:19], s94 offen sc1 lds
s_add_u32 m0, s47, 1024
s_nop 0
buffer_load_dwordx4 v6, s[16:19], s94 offen sc1 lds
L_red_loop:
s_waitcnt vmcnt(0)
v_cmp_gt_u32 vcc, s64, v14
s_nop 0
s_cbranch_vccnz L_slow10
L_ret10:
buffer_load_dword v14, v7, s[4:7], s53 offen sc1
L_red_poll4:
buffer_load_dword v11, v9, s[4:7], s54 offen sc1
s_waitcnt vmcnt(0)
v_cmp_gt_u32 vcc, s38, v11
s_nop 0
s_cbranch_vccz L_red_pd5
s_sleep 1
s_sub_u32 s37, s37, 1
s_cbranch_scc0 L_red_poll4
s_movk_i32 s39, 52
s_branch L_bail
L_red_pd5:
v_mov_b32 v12, s38
s_add_u32 s64, s64, s33
s_add_u32 s94, s94, 36864
buffer_load_dwordx4 v[24:27], v2, s[4:7], s10 offen offset:0 sc1
buffer_load_dwordx4 v[28:31], v2, s[4:7], s11 offen offset:0 sc1
buffer_load_dwordx4 v[32:35], v2, s[4:7], s12 offen offset:0 sc1
buffer_load_dwordx4 v[36:39], v2, s[4:7], s13 offen offset:0 sc1
buffer_load_dwordx4 v[40:43], v2, s[4:7], s10 offen offset:256 sc1
buffer_load_dwordx4 v[44:47], v2, s[4:7], s11 offen offset:256 sc1
ds_read_b32 v126, v4 offset:0
ds_read_b32 v128, v4 offset:512
ds_read_b32 v127, v4 offset:256
ds_read_b32 v129, v4 offset:768
ds_read_b32 v130, v5 offset:0
buffer_load_dwordx4 v[48:51], v2, s[4:7], s12 offen offset:256 sc1
buffer_load_dwordx4 v[52:55], v2, s[4:7], s13 offen offset:256 sc1
s_waitcnt vmcnt(7)
v_mfma_f32_16x16x32_bf16 v[96:99], v[16:19], v[24:27], 0
s_waitcnt lgkmcnt(4)
v_lshlrev_b32 v116, 16, v126
v_and_b32 v117, 0xffff0000, v126
s_waitcnt lgkmcnt(3)
v_lshlrev_b32 v120, 16, v128
s_waitcnt lgkmcnt(2)
v_and_b32 v119, 0xffff0000, v127
buffer_load_dwordx4 v[56:59], v2, s[4:7], s10 offen offset:512 sc1
s_waitcnt vmcnt(7)
v_mfma_f32_16x16x32_bf16 v[96:99], v[16:19], v[28:31], v[96:99]
s_waitcnt lgkmcnt(0)
v_lshlrev_b32 v124, 16, v130
v_and_b32 v123, 0xffff0000, v129
v_lshlrev_b32 v118, 16, v127
v_and_b32 v121, 0xffff0000, v128
v_lshlrev_b32 v122, 16, v129
v_and_b32 v125, 0xffff0000, v130
buffer_load_dwordx4 v[60:63], v2, s[4:7], s11 offen offset:512 sc1
s_waitcnt vmcnt(7)
v_mfma_f32_16x16x32_bf16 v[96:99], v[16:19], v[32:35], v[96:99]
buffer_load_dwordx4 v[64:67], v2, s[4:7], s12 offen offset:512 sc1
s_waitcnt vmcnt(7)
v_mfma_f32_16x16x32_bf16 v[96:99], v[16:19], v[36:39], v[96:99]
s_nop 7
v_mov_b32_dpp v98, v96 quad_perm:[1,0,3,2] row_mask:0xf bank_mask:0xf
v_mov_b32_dpp v99, v97 quad_perm:[1,0,3,2] row_mask:0xf bank_mask:0xf
v_cndmask_b32 v97, v98, v97, s[8:9]
v_cndmask_b32 v96, v96, v99, s[8:9]
v_add_f32 v117, v117, v97
buffer_load_dwordx4 v[68:71], v2, s[4:7], s13 offen offset:512 sc1
s_waitcnt vmcnt(7)
v_mfma_f32_16x16x32_bf16 v[100:103], v[16:19], v[40:43], 0
v_add_f32 v116, v116, v96
v_cvt_pk_bf16_f32 v98, v116, v117
v_and_b32 v117, 0xffff0000, v98
v_lshlrev_b32 v116, 16, v98
ds_write_b32 v4, v98 offset:4096
v_mul_f32 v133, v116, v116
v_add_f32 v132, v116, v117
v_fmac_f32 v133, v117, v117
buffer_load_dwordx4 v[72:75], v2, s[4:7], s10 offen offset:768 sc1
s_waitcnt vmcnt(7)
v_mfma_f32_16x16x32_bf16 v[100:103], v[16:19], v[44:47], v[100:103]
buffer_load_dwordx4 v[76:79], v2, s[4:7], s11 offen offset:768 sc1
s_waitcnt vmcnt(7)
v_mfma_f32_16x16x32_bf16 v[100:103], v[16:19], v[48:51], v[100:103]
buffer_load_dwordx4 v[80:83], v2, s[4:7], s12 offen offset:768 sc1
s_waitcnt vmcnt(7)
v_mfma_f32_16x16x32_bf16 v[100:103], v[16:19], v[52:55], v[100:103]
s_nop 7
v_mov_b32_dpp v103, v101 quad_perm:[1,0,3,2] row_mask:0xf bank_mask:0xf
v_mov_b32_dpp v102, v100 quad_perm:[1,0,3,2] row_mask:0xf bank_mask:0xf
v_cndmask_b32 v100, v100, v103, s[8:9]
v_cndmask_b32 v101, v102, v101, s[8:9]
v_add_f32 v118, v118, v100
buffer_load_dwordx4 v[84:87], v2, s[4:7], s13 offen offset:768 sc1
s_waitcnt vmcnt(7)
v_mfma_f32_16x16x32_bf16 v[104:107], v[16:19], v[56:59], 0
v_add_f32 v119, v119, v101
v_add_u32 v2, 1048576, v2
v_cvt_pk_bf16_f32 v102, v118, v119
v_and_b32 v2, 2097151, v2
v_lshlrev_b32 v118, 16, v102
v_and_b32 v119, 0xffff0000, v102
v_fmac_f32 v133, v118, v118
v_add_f32 v132, v132, v118
v_fmac_f32 v133, v119, v119
v_add_f32 v132, v132, v119
ds_write_b32 v4, v102 offset:4352
buffer_load_dwordx4 v[88:91], v3, s[4:7], s10 offen offset:1024 sc1
s_waitcnt vmcnt(7)
v_mfma_f32_16x16x32_bf16 v[104:107], v[16:19], v[60:63], v[104:107]
buffer_load_dwordx4 v[92:95], v3, s[4:7], s12 offen offset:1024 sc1
s_waitcnt vmcnt(7)
v_mfma_f32_16x16x32_bf16 v[104:107], v[16:19], v[64:67], v[104:107]
v_add_u32 v3, 1048576, v3
v_and_b32 v3, 2097151, v3
s_waitcnt vmcnt(6)
v_mfma_f32_16x16x32_bf16 v[104:107], v[16:19], v[68:71], v[104:107]
s_nop 7
v_mov_b32_dpp v106, v104 quad_perm:[1,0,3,2] row_mask:0xf bank_mask:0xf
v_mov_b32_dpp v107, v105 quad_perm:[1,0,3,2] row_mask:0xf bank_mask:0xf
v_cndmask_b32 v105, v106, v105, s[8:9]
v_cndmask_b32 v104, v104, v107, s[8:9]
v_add_f32 v121, v121, v105
v_add_f32 v120, v120, v104
v_cvt_pk_bf16_f32 v106, v120, v121
s_waitcnt vmcnt(5)
v_mfma_f32_16x16x32_bf16 v[108:111], v[16:19], v[72:75], 0
v_and_b32 v121, 0xffff0000, v106
v_lshlrev_b32 v120, 16, v106
ds_write_b32 v4, v106 offset:4608
v_fmac_f32 v133, v120, v120
v_add_f32 v132, v132, v120
v_fmac_f32 v133, v121, v121
v_add_f32 v132, v132, v121
s_waitcnt vmcnt(4)
v_mfma_f32_16x16x32_bf16 v[108:111], v[16:19], v[76:79], v[108:111]
s_waitcnt vmcnt(3)
v_mfma_f32_16x16x32_bf16 v[108:111], v[16:19], v[80:83], v[108:111]
s_waitcnt vmcnt(2)
v_mfma_f32_16x16x32_bf16 v[108:111], v[16:19], v[84:87], v[108:111]
s_nop 7
v_mov_b32_dpp v111, v109 quad_perm:[1,0,3,2] row_mask:0xf bank_mask:0xf
v_mov_b32_dpp v110, v108 quad_perm:[1,0,3,2] row_mask:0xf bank_mask:0xf
v_cndmask_b32 v108, v108, v111, s[8:9]
v_cndmask_b32 v109, v110, v109, s[8:9]
v_add_f32 v122, v122, v108
v_add_f32 v123, v123, v109
v_cvt_pk_bf16_f32 v110, v122, v123
s_waitcnt vmcnt(1)
v_mfma_f32_16x16x32_bf16 v[112:115], v[16:19], v[88:91], 0
v_lshlrev_b32 v122, 16, v110
v_and_b32 v123, 0xffff0000, v110
v_add_f32 v132, v132, v122
v_fmac_f32 v133, v122, v122
v_add_f32 v132, v132, v123
v_fmac_f32 v133, v123, v123
ds_write_b32 v4, v110 offset:4864
s_waitcnt vmcnt(0)
v_mfma_f32_16x16x32_bf16 v[112:115], v[16:19], v[92:95], v[112:115]
s_cmp_eq_u32 s36, 0
s_cbranch_scc1 L_slow11
L_ret11:
buffer_store_dword v12, v8, s[4:7], s55 offen offset:2048
s_barrier
s_nop 3
v_add_f32_dpp v112, v112, v112 row_ror:8 row_mask:0xf bank_mask:0xf
v_add_f32_dpp v113, v113, v113 row_ror:8 row_mask:0xf bank_mask:0xf
v_add_f32 v124, v124, v112
v_add_f32 v125, v125, v113
v_cvt_pk_bf16_f32 v114, v124, v125
v_lshlrev_b32 v124, 16, v114
v_and_b32 v125, 0xffff0000, v114
v_mul_f32 v113, v124, v124
v_add_f32 v112, v124, v125
v_fmac_f32 v113, v125, v125
v_fmac_f32 v132, 0.5, v112
v_fmac_f32 v133, 0.5, v113
ds_write_b32 v5, v114 offset:4096
v_add_f32_dpp v132, v132, v132 row_ror:8 row_mask:0xf bank_mask:0xf
v_add_f32_dpp v133, v133, v133 row_ror:8 row_mask:0xf bank_mask:0xf
s_nop 0
v_add_f32_dpp v132, v132, v132 row_ror:4 row_mask:0xf bank_mask:0xf
v_add_f32_dpp v133, v133, v133 row_ror:4 row_mask:0xf bank_mask:0xf
ds_read_b128 v[24:27], v13 offset:4096
v_add_f32_dpp v132, v132, v132 row_ror:2 row_mask:0xf bank_mask:0xf
v_add_f32_dpp v133, v133, v133 row_ror:2 row_mask:0xf bank_mask:0xf
s_nop 0
v_add_f32_dpp v132, v132, v132 row_ror:1 row_mask:0xf bank_mask:0xf
v_add_f32_dpp v133, v133, v133 row_ror:1 row_mask:0xf bank_mask:0xf
v_mov_b32 v134, v132
v_mov_b32 v135, v133
ds_read_b128 v[28:31], v13 offset:5120
v_permlane16_swap_b32 v132, v134
v_add_f32 v132, v132, v134
v_permlane16_swap_b32 v133, v135
v_add_f32 v133, v133, v135
v_mov_b32 v134, v132
v_mov_b32 v135, v133
s_nop 0
v_permlane32_swap_b32 v132, v134
v_add_f32 v132, v132, v134
v_permlane32_swap_b32 v133, v135
v_add_f32 v133, v133, v135
v_mul_f32 v132, 0x3ae38e39, v132
v_mul_f32 v133, 0x3ae38e39, v133
v_fma_f32 v133, -v132, v132, v133
v_max_f32 v133, 0, v133
v_cvt_pk_bf16_f32 v132, v132, v133
v_and_b32 v133, 0xffff0000, v132
v_lshlrev_b32 v132, 16, v132
v_add_f32 v133, 0x3727c5ac, v133
v_sub_f32 v116, v116, v132
v_sub_f32 v119, v119, v132
v_sub_f32 v117, v117, v132
v_cvt_pk_bf16_f32 v133, v133, v133
v_sub_f32 v121, v121, v132
v_and_b32 v133, 0xffff0000, v133
v_sub_f32 v118, v118, v132
v_sqrt_f32 v133, v133
v_sub_f32 v120, v120, v132
v_cvt_pk_bf16_f32 v133, v133, v133
v_sub_f32 v124, v124, v132
v_sub_f32 v122, v122, v132
v_sub_f32 v123, v123, v132
v_and_b32 v133, 0xffff0000, v133
v_sub_f32 v125, v125, v132
v_cvt_pk_bf16_f32 v117, v116, v117
v_cvt_pk_bf16_f32 v119, v118, v119
v_cvt_pk_bf16_f32 v121, v120, v121
v_cvt_pk_bf16_f32 v123, v122, v123
v_lshlrev_b32 v120, 16, v121
v_lshlrev_b32 v122, 16, v123
v_lshlrev_b32 v118, 16, v119
v_rcp_f32 v133, v133
v_lshlrev_b32 v116, 16, v117
v_and_b32 v117, 0xffff0000, v117
v_mul_f32 v116, v116, v133
v_cvt_pk_bf16_f32 v125, v124, v125
v_mul_f32 v117, v117, v133
v_lshlrev_b32 v124, 16, v125
v_and_b32 v119, 0xffff0000, v119
v_and_b32 v121, 0xffff0000, v121
v_mul_f32 v119, v119, v133
v_mul_f32 v118, v118, v133
v_cvt_pk_bf16_f32 v96, v116, v117
v_cvt_pk_bf16_f32 v100, v118, v119
ds_write_b32 v4, v96 offset:2048
v_mul_f32 v120, v120, v133
v_mul_f32 v121, v121, v133
v_mul_f32 v122, v122, v133
ds_write_b32 v4, v100 offset:2304
v_cvt_pk_bf16_f32 v104, v120, v121
v_and_b32 v123, 0xffff0000, v123
v_and_b32 v125, 0xffff0000, v125
ds_write_b32 v4, v104 offset:2560
v_mul_f32 v123, v123, v133
v_mul_f32 v125, v125, v133
v_cvt_pk_bf16_f32 v108, v122, v123
v_mul_f32 v124, v124, v133
ds_write_b32 v4, v108 offset:2816
v_cvt_pk_bf16_f32 v112, v124, v125
s_waitcnt lgkmcnt(5)
buffer_store_dwordx4 v[24:27], v1, s[4:7], s95 offen sc1
ds_write_b32 v5, v112 offset:2048
ds_read_b128 v[32:35], v13 offset:2048
ds_read_b128 v[36:39], v13 offset:3072
s_waitcnt lgkmcnt(7)
buffer_store_dwordx4 v[28:31], v6, s[4:7], s95 offen sc1
s_add_u32 s95, s95, 36864
s_waitcnt lgkmcnt(1)
buffer_store_dwordx4 v[32:35], v1, s[4:7], s96 offen sc1
s_waitcnt lgkmcnt(0)
buffer_store_dwordx4 v[36:39], v6, s[4:7], s96 offen sc1
s_add_u32 s96, s96, 36864
s_mov_b32 m0, s47
s_nop 0
buffer_load_dwordx4 v1, s[16:19], s94 offen sc1 lds
s_add_u32 m0, s47, 1024
s_nop 0
buffer_load_dwordx4 v6, s[16:19], s94 offen sc1 lds
s_waitcnt vmcnt(2)
s_mov_b32 s42, s38
s_buffer_atomic_umax s42, s[4:7], s56
s_add_u32 s38, s38, 1
s_cmp_le_u32 s38, 64
s_cbranch_scc1 L_red_loop
s_endpgm
L_slow10:
L_redo_poll1:
buffer_load_dword v14, v7, s[4:7], s53 offen sc1
s_waitcnt vmcnt(0)
v_cmp_gt_u32 vcc, s64, v14
s_nop 0
s_cbranch_vccz L_redo_pd2
s_sleep 1
s_sub_u32 s37, s37, 1
s_cbranch_scc0 L_redo_poll1
s_movk_i32 s39, 58
s_branch L_bail
L_redo_pd2:
s_mov_b32 m0, s47
s_nop 0
buffer_load_dwordx4 v1, s[16:19], s94 offen sc1 lds
s_add_u32 m0, s47, 1024
s_nop 0
buffer_load_dwordx4 v6, s[16:19], s94 offen sc1 lds
s_waitcnt vmcnt(0)
s_branch L_ret10
L_slow11:
buffer_store_dword v12, v7, s[4:7], s55 offen offset:2048 sc1
s_branch L_ret11
L_at_wo:
s_mov_b32 s12, s74
s_and_b32 s13, s75, 0xffff
s_mov_b32 s14, 4718592
s_mov_b32 s15, 0x20000
s_sub_u32 s34, s34, 16
s_mul_i32 s46, s34, 294912
v_lshlrev_b32 v8, 4, v0
v_lshrrev_b32 v9, 5, v0
v_lshlrev_b32 v9, 2, v9
v_bfe_u32 v10, v0, 2, 2
v_add_u32 v9, v9, v10
v_mul_u32_u24 v9, 1152, v9
v_bfe_u32 v11, v0, 4, 1
v_and_b32 v12, 3, v0
v_lshl_add_u32 v10, v11, 5, v9
v_lshl_add_u32 v10, v12, 3, v10
v_lshl_add_u32 v9, v11, 3, v9
v_lshl_add_u32 v9, v12, 4, v9
s_and_b32 s45, s35, 1
s_lshl_b32 s45, s45, 6
s_add_u32 s45, s45, 1024
v_add_u32 v10, s45, v10
v_lshl_add_u32 v9, s35, 8, v9
s_lshl_b32 s45, s35, 10
s_add_u32 s43, s45, 0
s_mov_b32 m0, s43
s_add_u32 s44, s43, s46
s_add_u32 s44, s44, 0
buffer_load_dwordx4 v8, s[12:15], s44 offen lds
s_add_u32 s43, s45, 4096
s_mov_b32 m0, s43
s_add_u32 s44, s43, s46
s_add_u32 s44, s44, 0
buffer_load_dwordx4 v8, s[12:15], s44 offen lds
s_add_u32 s43, s45, 8192
s_mov_b32 m0, s43
s_add_u32 s44, s43, s46
s_add_u32 s44, s44, 0
buffer_load_dwordx4 v8, s[12:15], s44 offen lds
s_add_u32 s43, s45, 12288
s_mov_b32 m0, s43
s_add_u32 s44, s43, s46
s_add_u32 s44, s44, 0
buffer_load_dwordx4 v8, s[12:15], s44 offen lds
s_add_u32 s43, s45, 16384
s_mov_b32 m0, s43
s_add_u32 s44, s43, s46
s_add_u32 s44, s44, 0
buffer_load_dwordx4 v8, s[12:15], s44 offen lds
s_add_u32 s43, s45, 20480
s_mov_b32 m0, s43
s_add_u32 s44, s43, s46
s_add_u32 s44, s44, 0
buffer_load_dwordx4 v8, s[12:15], s44 offen lds
s_add_u32 s43, s45, 24576
s_mov_b32 m0, s43
s_add_u32 s44, s43, s46
s_add_u32 s44, s44, 0
buffer_load_dwordx4 v8, s[12:15], s44 offen lds
s_add_u32 s43, s45, 28672
s_mov_b32 m0, s43
s_add_u32 s44, s43, s46
s_add_u32 s44, s44, 0
buffer_load_dwordx4 v8, s[12:15], s44 offen lds
s_add_u32 s43, s45, 32768
s_mov_b32 m0, s43
s_add_u32 s44, s43, s46
s_add_u32 s44, s44, 0
buffer_load_dwordx4 v8, s[12:15], s44 offen lds
s_add_u32 s43, s45, 36864
s_mov_b32 m0, s43
s_add_u32 s44, s43, s46
s_add_u32 s44, s44, 0
buffer_load_dwordx4 v8, s[12:15], s44 offen lds
s_add_u32 s43, s45, 40960
s_mov_b32 m0, s43
s_add_u32 s44, s43, s46
s_add_u32 s44, s44, 0
buffer_load_dwordx4 v8, s[12:15], s44 offen lds
s_add_u32 s43, s45, 45056
s_mov_b32 m0, s43
s_add_u32 s44, s43, s46
s_add_u32 s44, s44, 0
buffer_load_dwordx4 v8, s[12:15], s44 offen lds
s_add_u32 s43, s45, 49152
s_mov_b32 m0, s43
s_add_u32 s44, s43, s46
s_add_u32 s44, s44, 0
buffer_load_dwordx4 v8, s[12:15], s44 offen lds
s_add_u32 s43, s45, 53248
s_mov_b32 m0, s43
s_add_u32 s44, s43, s46
s_add_u32 s44, s44, 0
buffer_load_dwordx4 v8, s[12:15], s44 offen lds
s_add_u32 s43, s45, 57344
s_mov_b32 m0, s43
s_add_u32 s44, s43, s46
s_add_u32 s44, s44, 0
buffer_load_dwordx4 v8, s[12:15], s44 offen lds
s_add_u32 s43, s45, 61440
s_mov_b32 m0, s43
s_add_u32 s44, s43, s46
s_add_u32 s44, s44, 0
buffer_load_dwordx4 v8, s[12:15], s44 offen lds
s_add_u32 s43, s45, 65536
s_mov_b32 m0, s43
s_add_u32 s44, s43, s46
s_add_u32 s44, s44, 0
buffer_load_dwordx4 v8, s[12:15], s44 offen lds
s_add_u32 s43, s45, 69632
s_mov_b32 m0, s43
s_add_u32 s44, s43, s46
s_add_u32 s44, s44, 0
buffer_load_dwordx4 v8, s[12:15], s44 offen lds
s_add_u32 s43, s45, 73728
s_mov_b32 m0, s43
s_add_u32 s44, s43, s46
s_add_u32 s44, s44, 0
buffer_load_dwordx4 v8, s[12:15], s44 offen lds
s_add_u32 s43, s45, 77824
s_mov_b32 m0, s43
s_add_u32 s44, s43, s46
s_add_u32 s44, s44, 0
buffer_load_dwordx4 v8, s[12:15], s44 offen lds
s_add_u32 s43, s45, 81920
s_mov_b32 m0, s43
s_add_u32 s44, s43, s46
s_add_u32 s44, s44, 0
buffer_load_dwordx4 v8, s[12:15], s44 offen lds
s_add_u32 s43, s45, 86016
s_mov_b32 m0, s43
s_add_u32 s44, s43, s46
s_add_u32 s44, s44, 0
buffer_load_dwordx4 v8, s[12:15], s44 offen lds
s_add_u32 s43, s45, 90112
s_mov_b32 m0, s43
s_add_u32 s44, s43, s46
s_add_u32 s44, s44, 0
buffer_load_dwordx4 v8, s[12:15], s44 offen lds
s_add_u32 s43, s45, 94208
s_mov_b32 m0, s43
s_add_u32 s44, s43, s46
s_add_u32 s44, s44, 0
buffer_load_dwordx4 v8, s[12:15], s44 offen lds
s_add_u32 s43, s45, 98304
s_mov_b32 m0, s43
s_add_u32 s44, s43, s46
s_add_u32 s44, s44, 0
buffer_load_dwordx4 v8, s[12:15], s44 offen lds
s_add_u32 s43, s45, 102400
s_mov_b32 m0, s43
s_add_u32 s44, s43, s46
s_add_u32 s44, s44, 0
buffer_load_dwordx4 v8, s[12:15], s44 offen lds
s_add_u32 s43, s45, 106496
s_mov_b32 m0, s43
s_add_u32 s44, s43, s46
s_add_u32 s44, s44, 0
buffer_load_dwordx4 v8, s[12:15], s44 offen lds
s_add_u32 s43, s45, 110592
s_mov_b32 m0, s43
s_add_u32 s44, s43, s46
s_add_u32 s44, s44, 0
buffer_load_dwordx4 v8, s[12:15], s44 offen lds
s_add_u32 s43, s45, 114688
s_mov_b32 m0, s43
s_add_u32 s44, s43, s46
s_add_u32 s44, s44, 0
buffer_load_dwordx4 v8, s[12:15], s44 offen lds
s_add_u32 s43, s45, 118784
s_mov_b32 m0, s43
s_add_u32 s44, s43, s46
s_add_u32 s44, s44, 0
buffer_load_dwordx4 v8, s[12:15], s44 offen lds
s_add_u32 s43, s45, 122880
s_mov_b32 m0, s43
s_add_u32 s44, s43, s46
s_add_u32 s44, s44, 0
buffer_load_dwordx4 v8, s[12:15], s44 offen lds
s_add_u32 s43, s45, 126976
s_mov_b32 m0, s43
s_add_u32 s44, s43, s46
s_add_u32 s44, s44, 0
buffer_load_dwordx4 v8, s[12:15], s44 offen lds
s_add_u32 s43, s45, 131072
s_mov_b32 m0, s43
s_add_u32 s44, s43, s46
s_add_u32 s44, s44, 0
buffer_load_dwordx4 v8, s[12:15], s44 offen lds
s_add_u32 s43, s45, 135168
s_mov_b32 m0, s43
s_add_u32 s44, s43, s46
s_add_u32 s44, s44, 0
buffer_load_dwordx4 v8, s[12:15], s44 offen lds
s_add_u32 s43, s45, 139264
s_mov_b32 m0, s43
s_add_u32 s44, s43, s46
s_add_u32 s44, s44, 0
buffer_load_dwordx4 v8, s[12:15], s44 offen lds
s_add_u32 s43, s45, 143360
s_mov_b32 m0, s43
s_add_u32 s44, s43, s46
s_add_u32 s44, s44, 0
buffer_load_dwordx4 v8, s[12:15], s44 offen lds
s_waitcnt vmcnt(0)
s_barrier
v_add_u32 v11, 0, v9
v_add_u32 v12, 0, v10
ds_read_b64_tr_b16 a[0:1], v11 offset:0
ds_read_b64_tr_b16 a[64:65], v11 offset:64
ds_read_b64_tr_b16 a[128:129], v11 offset:128
ds_read_b64_tr_b16 a[192:193], v11 offset:192
ds_read_b64_tr_b16 v[192:193], v12 offset:0
ds_read_b64_tr_b16 a[2:3], v11 offset:18432
ds_read_b64_tr_b16 a[66:67], v11 offset:18496
ds_read_b64_tr_b16 a[130:131], v11 offset:18560
ds_read_b64_tr_b16 a[194:195], v11 offset:18624
ds_read_b64_tr_b16 v[194:195], v12 offset:18432
ds_read_b64_tr_b16 a[4:5], v11 offset:9216
ds_read_b64_tr_b16 a[68:69], v11 offset:9280
ds_read_b64_tr_b16 a[132:133], v11 offset:9344
ds_read_b64_tr_b16 a[196:197], v11 offset:9408
ds_read_b64_tr_b16 v[196:197], v12 offset:9216
ds_read_b64_tr_b16 a[6:7], v11 offset:27648
ds_read_b64_tr_b16 a[70:71], v11 offset:27712
ds_read_b64_tr_b16 a[134:135], v11 offset:27776
ds_read_b64_tr_b16 a[198:199], v11 offset:27840
ds_read_b64_tr_b16 v[198:199], v12 offset:27648
ds_read_b64_tr_b16 a[8:9], v11 offset:36864
ds_read_b64_tr_b16 a[72:73], v11 offset:36928
ds_read_b64_tr_b16 a[136:137], v11 offset:36992
ds_read_b64_tr_b16 a[200:201], v11 offset:37056
ds_read_b64_tr_b16 v[200:201], v12 offset:36864
ds_read_b64_tr_b16 a[10:11], v11 offset:55296
ds_read_b64_tr_b16 a[74:75], v11 offset:55360
ds_read_b64_tr_b16 a[138:139], v11 offset:55424
ds_read_b64_tr_b16 a[202:203], v11 offset:55488
ds_read_b64_tr_b16 v[202:203], v12 offset:55296
ds_read_b64_tr_b16 a[12:13], v11 offset:46080
ds_read_b64_tr_b16 a[76:77], v11 offset:46144
ds_read_b64_tr_b16 a[140:141], v11 offset:46208
ds_read_b64_tr_b16 a[204:205], v11 offset:46272
ds_read_b64_tr_b16 v[204:205], v12 offset:46080
v_add_u32 v11, 57600, v9
v_add_u32 v12, 57600, v10
ds_read_b64_tr_b16 a[14:15], v11 offset:6912
ds_read_b64_tr_b16 a[78:79], v11 offset:6976
ds_read_b64_tr_b16 a[142:143], v11 offset:7040
ds_read_b64_tr_b16 a[206:207], v11 offset:7104
ds_read_b64_tr_b16 v[206:207], v12 offset:6912
ds_read_b64_tr_b16 a[16:17], v11 offset:16128
ds_read_b64_tr_b16 a[80:81], v11 offset:16192
ds_read_b64_tr_b16 a[144:145], v11 offset:16256
ds_read_b64_tr_b16 a[208:209], v11 offset:16320
ds_read_b64_tr_b16 v[208:209], v12 offset:16128
ds_read_b64_tr_b16 a[18:19], v11 offset:34560
ds_read_b64_tr_b16 a[82:83], v11 offset:34624
ds_read_b64_tr_b16 a[146:147], v11 offset:34688
ds_read_b64_tr_b16 a[210:211], v11 offset:34752
ds_read_b64_tr_b16 v[210:211], v12 offset:34560
ds_read_b64_tr_b16 a[20:21], v11 offset:25344
ds_read_b64_tr_b16 a[84:85], v11 offset:25408
ds_read_b64_tr_b16 a[148:149], v11 offset:25472
ds_read_b64_tr_b16 a[212:213], v11 offset:25536
ds_read_b64_tr_b16 v[212:213], v12 offset:25344
ds_read_b64_tr_b16 a[22:23], v11 offset:43776
ds_read_b64_tr_b16 a[86:87], v11 offset:43840
ds_read_b64_tr_b16 a[150:151], v11 offset:43904
ds_read_b64_tr_b16 a[214:215], v11 offset:43968
ds_read_b64_tr_b16 v[214:215], v12 offset:43776
ds_read_b64_tr_b16 a[24:25], v11 offset:52992
ds_read_b64_tr_b16 a[88:89], v11 offset:53056
ds_read_b64_tr_b16 a[152:153], v11 offset:53120
ds_read_b64_tr_b16 a[216:217], v11 offset:53184
ds_read_b64_tr_b16 v[216:217], v12 offset:52992
v_add_u32 v11, 115200, v9
v_add_u32 v12, 115200, v10
ds_read_b64_tr_b16 a[26:27], v11 offset:13824
ds_read_b64_tr_b16 a[90:91], v11 offset:13888
ds_read_b64_tr_b16 a[154:155], v11 offset:13952
ds_read_b64_tr_b16 a[218:219], v11 offset:14016
ds_read_b64_tr_b16 v[218:219], v12 offset:13824
ds_read_b64_tr_b16 a[28:29], v11 offset:4608
ds_read_b64_tr_b16 a[92:93], v11 offset:4672
ds_read_b64_tr_b16 a[156:157], v11 offset:4736
ds_read_b64_tr_b16 a[220:221], v11 offset:4800
ds_read_b64_tr_b16 v[220:221], v12 offset:4608
ds_read_b64_tr_b16 a[30:31], v11 offset:23040
ds_read_b64_tr_b16 a[94:95], v11 offset:23104
ds_read_b64_tr_b16 a[158:159], v11 offset:23168
ds_read_b64_tr_b16 a[222:223], v11 offset:23232
ds_read_b64_tr_b16 v[222:223], v12 offset:23040
s_waitcnt lgkmcnt(0)
s_barrier
s_add_u32 s43, s45, 0
s_mov_b32 m0, s43
s_add_u32 s44, s43, s46
s_add_u32 s44, s44, 147456
buffer_load_dwordx4 v8, s[12:15], s44 offen lds
s_add_u32 s43, s45, 4096
s_mov_b32 m0, s43
s_add_u32 s44, s43, s46
s_add_u32 s44, s44, 147456
buffer_load_dwordx4 v8, s[12:15], s44 offen lds
s_add_u32 s43, s45, 8192
s_mov_b32 m0, s43
s_add_u32 s44, s43, s46
s_add_u32 s44, s44, 147456
buffer_load_dwordx4 v8, s[12:15], s44 offen lds
s_add_u32 s43, s45, 12288
s_mov_b32 m0, s43
s_add_u32 s44, s43, s46
s_add_u32 s44, s44, 147456
buffer_load_dwordx4 v8, s[12:15], s44 offen lds
s_add_u32 s43, s45, 16384
s_mov_b32 m0, s43
s_add_u32 s44, s43, s46
s_add_u32 s44, s44, 147456
buffer_load_dwordx4 v8, s[12:15], s44 offen lds
s_add_u32 s43, s45, 20480
s_mov_b32 m0, s43
s_add_u32 s44, s43, s46
s_add_u32 s44, s44, 147456
buffer_load_dwordx4 v8, s[12:15], s44 offen lds
s_add_u32 s43, s45, 24576
s_mov_b32 m0, s43
s_add_u32 s44, s43, s46
s_add_u32 s44, s44, 147456
buffer_load_dwordx4 v8, s[12:15], s44 offen lds
s_add_u32 s43, s45, 28672
s_mov_b32 m0, s43
s_add_u32 s44, s43, s46
s_add_u32 s44, s44, 147456
buffer_load_dwordx4 v8, s[12:15], s44 offen lds
s_add_u32 s43, s45, 32768
s_mov_b32 m0, s43
s_add_u32 s44, s43, s46
s_add_u32 s44, s44, 147456
buffer_load_dwordx4 v8, s[12:15], s44 offen lds
s_add_u32 s43, s45, 36864
s_mov_b32 m0, s43
s_add_u32 s44, s43, s46
s_add_u32 s44, s44, 147456
buffer_load_dwordx4 v8, s[12:15], s44 offen lds
s_add_u32 s43, s45, 40960
s_mov_b32 m0, s43
s_add_u32 s44, s43, s46
s_add_u32 s44, s44, 147456
buffer_load_dwordx4 v8, s[12:15], s44 offen lds
s_add_u32 s43, s45, 45056
s_mov_b32 m0, s43
s_add_u32 s44, s43, s46
s_add_u32 s44, s44, 147456
buffer_load_dwordx4 v8, s[12:15], s44 offen lds
s_add_u32 s43, s45, 49152
s_mov_b32 m0, s43
s_add_u32 s44, s43, s46
s_add_u32 s44, s44, 147456
buffer_load_dwordx4 v8, s[12:15], s44 offen lds
s_add_u32 s43, s45, 53248
s_mov_b32 m0, s43
s_add_u32 s44, s43, s46
s_add_u32 s44, s44, 147456
buffer_load_dwordx4 v8, s[12:15], s44 offen lds
s_add_u32 s43, s45, 57344
s_mov_b32 m0, s43
s_add_u32 s44, s43, s46
s_add_u32 s44, s44, 147456
buffer_load_dwordx4 v8, s[12:15], s44 offen lds
s_add_u32 s43, s45, 61440
s_mov_b32 m0, s43
s_add_u32 s44, s43, s46
s_add_u32 s44, s44, 147456
buffer_load_dwordx4 v8, s[12:15], s44 offen lds
s_add_u32 s43, s45, 65536
s_mov_b32 m0, s43
s_add_u32 s44, s43, s46
s_add_u32 s44, s44, 147456
buffer_load_dwordx4 v8, s[12:15], s44 offen lds
s_add_u32 s43, s45, 69632
s_mov_b32 m0, s43
s_add_u32 s44, s43, s46
s_add_u32 s44, s44, 147456
buffer_load_dwordx4 v8, s[12:15], s44 offen lds
s_add_u32 s43, s45, 73728
s_mov_b32 m0, s43
s_add_u32 s44, s43, s46
s_add_u32 s44, s44, 147456
buffer_load_dwordx4 v8, s[12:15], s44 offen lds
s_add_u32 s43, s45, 77824
s_mov_b32 m0, s43
s_add_u32 s44, s43, s46
s_add_u32 s44, s44, 147456
buffer_load_dwordx4 v8, s[12:15], s44 offen lds
s_add_u32 s43, s45, 81920
s_mov_b32 m0, s43
s_add_u32 s44, s43, s46
s_add_u32 s44, s44, 147456
buffer_load_dwordx4 v8, s[12:15], s44 offen lds
s_add_u32 s43, s45, 86016
s_mov_b32 m0, s43
s_add_u32 s44, s43, s46
s_add_u32 s44, s44, 147456
buffer_load_dwordx4 v8, s[12:15], s44 offen lds
s_add_u32 s43, s45, 90112
s_mov_b32 m0, s43
s_add_u32 s44, s43, s46
s_add_u32 s44, s44, 147456
buffer_load_dwordx4 v8, s[12:15], s44 offen lds
s_add_u32 s43, s45, 94208
s_mov_b32 m0, s43
s_add_u32 s44, s43, s46
s_add_u32 s44, s44, 147456
buffer_load_dwordx4 v8, s[12:15], s44 offen lds
s_add_u32 s43, s45, 98304
s_mov_b32 m0, s43
s_add_u32 s44, s43, s46
s_add_u32 s44, s44, 147456
buffer_load_dwordx4 v8, s[12:15], s44 offen lds
s_add_u32 s43, s45, 102400
s_mov_b32 m0, s43
s_add_u32 s44, s43, s46
s_add_u32 s44, s44, 147456
buffer_load_dwordx4 v8, s[12:15], s44 offen lds
s_add_u32 s43, s45, 106496
s_mov_b32 m0, s43
s_add_u32 s44, s43, s46
s_add_u32 s44, s44, 147456
buffer_load_dwordx4 v8, s[12:15], s44 offen lds
s_add_u32 s43, s45, 110592
s_mov_b32 m0, s43
s_add_u32 s44, s43, s46
s_add_u32 s44, s44, 147456
buffer_load_dwordx4 v8, s[12:15], s44 offen lds
s_add_u32 s43, s45, 114688
s_mov_b32 m0, s43
s_add_u32 s44, s43, s46
s_add_u32 s44, s44, 147456
buffer_load_dwordx4 v8, s[12:15], s44 offen lds
s_add_u32 s43, s45, 118784
s_mov_b32 m0, s43
s_add_u32 s44, s43, s46
s_add_u32 s44, s44, 147456
buffer_load_dwordx4 v8, s[12:15], s44 offen lds
s_add_u32 s43, s45, 122880
s_mov_b32 m0, s43
s_add_u32 s44, s43, s46
s_add_u32 s44, s44, 147456
buffer_load_dwordx4 v8, s[12:15], s44 offen lds
s_add_u32 s43, s45, 126976
s_mov_b32 m0, s43
s_add_u32 s44, s43, s46
s_add_u32 s44, s44, 147456
buffer_load_dwordx4 v8, s[12:15], s44 offen lds
s_add_u32 s43, s45, 131072
s_mov_b32 m0, s43
s_add_u32 s44, s43, s46
s_add_u32 s44, s44, 147456
buffer_load_dwordx4 v8, s[12:15], s44 offen lds
s_add_u32 s43, s45, 135168
s_mov_b32 m0, s43
s_add_u32 s44, s43, s46
s_add_u32 s44, s44, 147456
buffer_load_dwordx4 v8, s[12:15], s44 offen lds
s_add_u32 s43, s45, 139264
s_mov_b32 m0, s43
s_add_u32 s44, s43, s46
s_add_u32 s44, s44, 147456
buffer_load_dwordx4 v8, s[12:15], s44 offen lds
s_add_u32 s43, s45, 143360
s_mov_b32 m0, s43
s_add_u32 s44, s43, s46
s_add_u32 s44, s44, 147456
buffer_load_dwordx4 v8, s[12:15], s44 offen lds
s_waitcnt vmcnt(0)
s_barrier
v_add_u32 v11, 0, v9
v_add_u32 v12, 0, v10
ds_read_b64_tr_b16 a[32:33], v11 offset:0
ds_read_b64_tr_b16 a[96:97], v11 offset:64
ds_read_b64_tr_b16 a[160:161], v11 offset:128
ds_read_b64_tr_b16 a[224:225], v11 offset:192
ds_read_b64_tr_b16 v[224:225], v12 offset:0
ds_read_b64_tr_b16 a[34:35], v11 offset:18432
ds_read_b64_tr_b16 a[98:99], v11 offset:18496
ds_read_b64_tr_b16 a[162:163], v11 offset:18560
ds_read_b64_tr_b16 a[226:227], v11 offset:18624
ds_read_b64_tr_b16 v[226:227], v12 offset:18432
ds_read_b64_tr_b16 a[36:37], v11 offset:9216
ds_read_b64_tr_b16 a[100:101], v11 offset:9280
ds_read_b64_tr_b16 a[164:165], v11 offset:9344
ds_read_b64_tr_b16 a[228:229], v11 offset:9408
ds_read_b64_tr_b16 v[228:229], v12 offset:9216
ds_read_b64_tr_b16 a[38:39], v11 offset:27648
ds_read_b64_tr_b16 a[102:103], v11 offset:27712
ds_read_b64_tr_b16 a[166:167], v11 offset:27776
ds_read_b64_tr_b16 a[230:231], v11 offset:27840
ds_read_b64_tr_b16 v[230:231], v12 offset:27648
ds_read_b64_tr_b16 a[40:41], v11 offset:36864
ds_read_b64_tr_b16 a[104:105], v11 offset:36928
ds_read_b64_tr_b16 a[168:169], v11 offset:36992
ds_read_b64_tr_b16 a[232:233], v11 offset:37056
ds_read_b64_tr_b16 v[232:233], v12 offset:36864
ds_read_b64_tr_b16 a[42:43], v11 offset:55296
ds_read_b64_tr_b16 a[106:107], v11 offset:55360
ds_read_b64_tr_b16 a[170:171], v11 offset:55424
ds_read_b64_tr_b16 a[234:235], v11 offset:55488
ds_read_b64_tr_b16 v[234:235], v12 offset:55296
ds_read_b64_tr_b16 a[44:45], v11 offset:46080
ds_read_b64_tr_b16 a[108:109], v11 offset:46144
ds_read_b64_tr_b16 a[172:173], v11 offset:46208
ds_read_b64_tr_b16 a[236:237], v11 offset:46272
ds_read_b64_tr_b16 v[236:237], v12 offset:46080
v_add_u32 v11, 57600, v9
v_add_u32 v12, 57600, v10
ds_read_b64_tr_b16 a[46:47], v11 offset:6912
ds_read_b64_tr_b16 a[110:111], v11 offset:6976
ds_read_b64_tr_b16 a[174:175], v11 offset:7040
ds_read_b64_tr_b16 a[238:239], v11 offset:7104
ds_read_b64_tr_b16 v[238:239], v12 offset:6912
ds_read_b64_tr_b16 a[48:49], v11 offset:16128
ds_read_b64_tr_b16 a[112:113], v11 offset:16192
ds_read_b64_tr_b16 a[176:177], v11 offset:16256
ds_read_b64_tr_b16 a[240:241], v11 offset:16320
ds_read_b64_tr_b16 v[240:241], v12 offset:16128
ds_read_b64_tr_b16 a[50:51], v11 offset:34560
ds_read_b64_tr_b16 a[114:115], v11 offset:34624
ds_read_b64_tr_b16 a[178:179], v11 offset:34688
ds_read_b64_tr_b16 a[242:243], v11 offset:34752
ds_read_b64_tr_b16 v[242:243], v12 offset:34560
ds_read_b64_tr_b16 a[52:53], v11 offset:25344
ds_read_b64_tr_b16 a[116:117], v11 offset:25408
ds_read_b64_tr_b16 a[180:181], v11 offset:25472
ds_read_b64_tr_b16 a[244:245], v11 offset:25536
ds_read_b64_tr_b16 v[244:245], v12 offset:25344
ds_read_b64_tr_b16 a[54:55], v11 offset:43776
ds_read_b64_tr_b16 a[118:119], v11 offset:43840
ds_read_b64_tr_b16 a[182:183], v11 offset:43904
ds_read_b64_tr_b16 a[246:247], v11 offset:43968
ds_read_b64_tr_b16 v[246:247], v12 offset:43776
ds_read_b64_tr_b16 a[56:57], v11 offset:52992
ds_read_b64_tr_b16 a[120:121], v11 offset:53056
ds_read_b64_tr_b16 a[184:185], v11 offset:53120
ds_read_b64_tr_b16 a[248:249], v11 offset:53184
ds_read_b64_tr_b16 v[248:249], v12 offset:52992
v_add_u32 v11, 115200, v9
v_add_u32 v12, 115200, v10
ds_read_b64_tr_b16 a[58:59], v11 offset:13824
ds_read_b64_tr_b16 a[122:123], v11 offset:13888
ds_read_b64_tr_b16 a[186:187], v11 offset:13952
ds_read_b64_tr_b16 a[250:251], v11 offset:14016
ds_read_b64_tr_b16 v[250:251], v12 offset:13824
ds_read_b64_tr_b16 a[60:61], v11 offset:4608
ds_read_b64_tr_b16 a[124:125], v11 offset:4672
ds_read_b64_tr_b16 a[188:189], v11 offset:4736
ds_read_b64_tr_b16 a[252:253], v11 offset:4800
ds_read_b64_tr_b16 v[252:253], v12 offset:4608
ds_read_b64_tr_b16 a[62:63], v11 offset:23040
ds_read_b64_tr_b16 a[126:127], v11 offset:23104
ds_read_b64_tr_b16 a[190:191], v11 offset:23168
ds_read_b64_tr_b16 a[254:255], v11 offset:23232
ds_read_b64_tr_b16 v[254:255], v12 offset:23040
s_waitcnt lgkmcnt(0)
s_barrier
v_lshl_add_u32 v48, s35, 6, v0
v_lshlrev_b32 v48, 20, v48
buffer_load_dword v50, v48, s[4:7], 0 offen
buffer_load_dword v50, v48, s[16:19], 0 offen
v_and_b32 v48, 7, v0
v_lshlrev_b32 v48, 3, v48
L_wo_cen1:
buffer_load_dwordx2 v[50:51], v48, s[24:27], s0 offen sc1
s_waitcnt vmcnt(0)
v_sad_u8 v49, v50, 0, 0
v_sad_u8 v49, v51, 0, v49
v_cmp_ne_u32 vcc, 32, v49
s_nop 0
s_cbranch_vccz L_wo_cend2
s_sleep 16
s_sub_u32 s37, s37, 1
s_cbranch_scc0 L_wo_cen1
s_movk_i32 s39, 81
s_branch L_bail
L_wo_cend2:
v_bcnt_u32_b32 v49, v50, 0
v_bcnt_u32_b32 v49, v51, v49
v_cmp_ne_u32 vcc, 1, v49
v_readlane_b32 s41, v49, s1
s_cbranch_vccz L_wo_cok3
s_cmp_eq_u32 s0, 0
s_cbranch_scc1 L_redo
L_wo_cok3:
s_cmp_eq_u32 s41, 1
s_cselect_b32 s36, 1, 0
v_lshlrev_b32 v1, 4, v0
v_mov_b32 v2, v1
v_and_b32 v48, 31, v0
v_lshrrev_b32 v49, 5, v0
v_and_b32 v50, 15, v0
v_lshrrev_b32 v51, 4, v0
v_mul_u32_u24 v3, 2304, v51
v_lshl_add_u32 v3, v50, 4, v3
v_lshl_add_u32 v3, s35, 8, v3
v_mul_u32_u24 v4, 1152, v48
v_lshl_add_u32 v4, v49, 4, v4
v_lshl_add_u32 v4, s35, 6, v4
v_lshlrev_b32 v5, 2, v48
v_mov_b32 v6, 0
v_mov_b32 v9, 0
v_and_b32 v8, 1, v0
v_lshlrev_b32 v8, 2, v8
s_cmp_eq_u32 s36, 0
s_cselect_b32 s45, 0x7ffffff0, 0
v_mov_b32 v7, s45
s_lshl_b32 s45, s33, 9
s_add_u32 s54, s45, 16384
s_add_u32 s41, s54, 2048
s_lshl_b32 s55, s34, 2
s_add_u32 s55, s55, s35
s_lshl_b32 s55, s55, 2
s_add_u32 s55, s55, s54
s_lshl_b32 s45, s33, 22
s_add_u32 s45, s45, 46137344
s_mul_i32 s57, s34, 36864
s_add_u32 s57, s57, s45
s_add_u32 s58, s57, 9216
s_add_u32 s59, s57, 18432
s_add_u32 s60, s57, 27648
s_lshl_b32 s45, s33, 4
s_add_u32 s45, s45, s34
s_add_u32 s45, s45, 0
s_mul_i32 s48, s45, 73728
s_add_u32 s48, s48, 167772160
s_lshl_b32 s53, s45, 7
s_add_u32 s53, s53, 24576
s_lshl_b32 s51, s35, 12
s_add_u32 s48, s48, s51
s_mov_b32 s38, 1
s_mov_b32 s66, -1
v_lshl_add_u32 v56, s35, 6, v0
v_lshlrev_b32 v56, 7, v56
v_add_u32 v57, 4096, v56
s_add_u32 s44, s57, 0
buffer_load_dword v58, v56, s[4:7], s44 offen sc1
buffer_load_dword v58, v57, s[4:7], s44 offen sc1
s_add_u32 s44, s57, 1048576
buffer_load_dword v58, v56, s[4:7], s44 offen sc1
buffer_load_dword v58, v57, s[4:7], s44 offen sc1
s_sub_u32 s44, s48, s51
buffer_load_dword v58, v56, s[4:7], s44 offen sc1
s_add_u32 s44, s44, 32768
buffer_load_dword v58, v56, s[4:7], s44 offen sc1
s_add_u32 s44, s44, 32768
buffer_load_dword v58, v56, s[4:7], s44 offen sc1
s_add_u32 s44, s44, 32768
s_waitcnt vmcnt(0)
v_lshlrev_b32 v12, 7, v0
s_lshl_b32 s46, s34, 1
s_lshr_b32 s44, s35, 1
s_add_u32 s46, s46, s44
s_mul_i32 s49, s33, 51118080
s_mul_i32 s44, s46, 1597440
s_add_u32 s49, s49, s44
s_and_b32 s44, s35, 1
s_mul_i32 s44, s44, 12288
s_add_u32 s49, s49, s44
s_add_u32 s49, s49, 58769408
s_cmp_ge_u32 s35, 2
s_cbranch_scc1 L_wo_hi
L_wo_looplo:
v_cmp_gt_u32 vcc, s38, v9
s_nop 0
s_cbranch_vccnz L_slow12
L_ret12:
s_barrier
s_max_i32 s42, s66, 0
s_xor_b32 s51, s51, 0x8000
s_and_b32 s61, s38, 3
s_cselect_b32 s61, 1, -3
s_mul_i32 s61, s61, 18432
s_add_u32 s48, s48, s61
v_mov_b32 v11, s38
ds_read_b128 v[136:139], v2 offset:0
ds_read_b128 v[140:143], v2 offset:1024
ds_read_b128 v[144:147], v2 offset:2048
ds_read_b128 v[148:151], v2 offset:3072
ds_read_b128 v[152:155], v2 offset:0
ds_read_b128 v[156:159], v2 offset:1024
ds_read_b128 v[164:167], v2 offset:3072
ds_read_b128 v[160:163], v2 offset:2048
ds_read_b128 v[168:171], v2 offset:4096
ds_read_b128 v[176:179], v2 offset:6144
s_waitcnt lgkmcnt(9)
v_mfma_f32_32x32x16_bf16 v[16:31], v[136:139], a[0:3], 0
ds_read_b128 v[172:175], v2 offset:5120
ds_read_b128 v[180:183], v2 offset:7168
v_mfma_f32_32x32x16_bf16 v[32:47], v[136:139], a[64:67], 0
v_mfma_f32_32x32x16_bf16 v[48:63], v[136:139], a[128:131], 0
v_mfma_f32_32x32x16_bf16 v[64:79], v[136:139], a[192:195], 0
ds_read_b128 v[136:139], v2 offset:4096
s_waitcnt lgkmcnt(11)
v_mfma_f32_32x32x16_bf16 v[32:47], v[140:143], a[68:71], v[32:47]
v_mfma_f32_32x32x16_bf16 v[16:31], v[140:143], a[4:7], v[16:31]
v_mfma_f32_32x32x16_bf16 v[48:63], v[140:143], a[132:135], v[48:63]
v_mfma_f32_32x32x16_bf16 v[64:79], v[140:143], a[196:199], v[64:79]
ds_read_b128 v[140:143], v2 offset:5120
s_waitcnt lgkmcnt(11)
v_mfma_f32_32x32x16_bf16 v[16:31], v[144:147], a[8:11], v[16:31]
v_mfma_f32_32x32x16_bf16 v[32:47], v[144:147], a[72:75], v[32:47]
v_mfma_f32_32x32x16_bf16 v[48:63], v[144:147], a[136:139], v[48:63]
v_mfma_f32_32x32x16_bf16 v[64:79], v[144:147], a[200:203], v[64:79]
ds_read_b128 v[144:147], v2 offset:6144
s_waitcnt lgkmcnt(11)
v_mfma_f32_32x32x16_bf16 v[16:31], v[148:151], a[12:15], v[16:31]
v_mfma_f32_32x32x16_bf16 v[32:47], v[148:151], a[76:79], v[32:47]
v_mfma_f32_32x32x16_bf16 v[48:63], v[148:151], a[140:143], v[48:63]
v_mfma_f32_32x32x16_bf16 v[64:79], v[148:151], a[204:207], v[64:79]
ds_read_b128 v[148:151], v2 offset:7168
s_waitcnt lgkmcnt(3)
v_mfma_f32_32x32x16_bf16 v[32:47], v[136:139], a[80:83], v[32:47]
v_mfma_f32_32x32x16_bf16 v[16:31], v[136:139], a[16:19], v[16:31]
v_mfma_f32_32x32x16_bf16 v[48:63], v[136:139], a[144:147], v[48:63]
v_mfma_f32_32x32x16_bf16 v[64:79], v[136:139], a[208:211], v[64:79]
ds_read_b128 v[136:139], v2 offset:8192
s_waitcnt lgkmcnt(3)
v_mfma_f32_32x32x16_bf16 v[16:31], v[140:143], a[20:23], v[16:31]
v_mfma_f32_32x32x16_bf16 v[32:47], v[140:143], a[84:87], v[32:47]
v_mfma_f32_32x32x16_bf16 v[48:63], v[140:143], a[148:151], v[48:63]
v_mfma_f32_32x32x16_bf16 v[64:79], v[140:143], a[212:215], v[64:79]
ds_read_b128 v[140:143], v2 offset:9216
s_waitcnt lgkmcnt(3)
v_mfma_f32_32x32x16_bf16 v[16:31], v[144:147], a[24:27], v[16:31]
v_mfma_f32_32x32x16_bf16 v[32:47], v[144:147], a[88:91], v[32:47]
v_mfma_f32_32x32x16_bf16 v[48:63], v[144:147], a[152:155], v[48:63]
s_waitcnt lgkmcnt(2)
v_mfma_f32_32x32x16_bf16 v[16:31], v[148:151], a[28:31], v[16:31]
v_mfma_f32_32x32x16_bf16 v[64:79], v[144:147], a[216:219], v[64:79]
ds_read_b128 v[144:147], v2 offset:10240
v_mfma_f32_32x32x16_bf16 v[32:47], v[148:151], a[92:95], v[32:47]
v_mfma_f32_32x32x16_bf16 v[48:63], v[148:151], a[156:159], v[48:63]
v_mfma_f32_32x32x16_bf16 v[64:79], v[148:151], a[220:223], v[64:79]
ds_read_b128 v[148:151], v2 offset:11264
s_waitcnt lgkmcnt(3)
v_mfma_f32_32x32x16_bf16 v[16:31], v[136:139], a[32:35], v[16:31]
v_mfma_f32_32x32x16_bf16 v[48:63], v[136:139], a[160:163], v[48:63]
v_mfma_f32_32x32x16_bf16 v[32:47], v[136:139], a[96:99], v[32:47]
v_mfma_f32_32x32x16_bf16 v[64:79], v[136:139], a[224:227], v[64:79]
ds_read_b128 v[136:139], v2 offset:12288
s_waitcnt lgkmcnt(3)
v_mfma_f32_32x32x16_bf16 v[32:47], v[140:143], a[100:103], v[32:47]
v_mfma_f32_32x32x16_bf16 v[16:31], v[140:143], a[36:39], v[16:31]
v_mfma_f32_32x32x16_bf16 v[48:63], v[140:143], a[164:167], v[48:63]
v_mfma_f32_32x32x16_bf16 v[64:79], v[140:143], a[228:231], v[64:79]
ds_read_b128 v[140:143], v2 offset:13312
s_waitcnt lgkmcnt(3)
v_mfma_f32_32x32x16_bf16 v[16:31], v[144:147], a[40:43], v[16:31]
buffer_load_dword v9, v8, s[4:7], s53 offen sc1
v_mfma_f32_32x32x16_bf16 v[32:47], v[144:147], a[104:107], v[32:47]
v_mfma_f32_32x32x16_bf16 v[64:79], v[144:147], a[232:235], v[64:79]
v_mfma_f32_32x32x16_bf16 v[48:63], v[144:147], a[168:171], v[48:63]
ds_read_b128 v[144:147], v2 offset:14336
s_waitcnt lgkmcnt(3)
v_mfma_f32_32x32x16_bf16 v[16:31], v[148:151], a[44:47], v[16:31]
v_mfma_f32_32x32x16_bf16 v[32:47], v[148:151], a[108:111], v[32:47]
v_mfma_f32_32x32x16_bf16 v[64:79], v[148:151], a[236:239], v[64:79]
v_mfma_f32_32x32x16_bf16 v[48:63], v[148:151], a[172:175], v[48:63]
buffer_load_dword v10, v5, s[4:7], s41 offen sc1
ds_read_b128 v[148:151], v2 offset:15360
s_waitcnt lgkmcnt(3)
v_mfma_f32_32x32x16_bf16 v[16:31], v[136:139], a[48:51], v[16:31]
v_mfma_f32_32x32x16_bf16 v[48:63], v[136:139], a[176:179], v[48:63]
v_mfma_f32_32x32x16_bf16 v[32:47], v[136:139], a[112:115], v[32:47]
s_waitcnt vmcnt(1)
s_mov_b32 m0, s51
s_nop 0
buffer_load_dwordx4 v1, s[4:7], s48 offen offset:0 sc1 lds
v_mfma_f32_32x32x16_bf16 v[64:79], v[136:139], a[240:243], v[64:79]
s_mov_b32 m0, s51
s_nop 0
buffer_load_dwordx4 v1, s[4:7], s48 offen offset:1024 sc1 lds
s_waitcnt lgkmcnt(2)
v_mfma_f32_32x32x16_bf16 v[16:31], v[140:143], a[52:55], v[16:31]
s_mov_b32 m0, s51
s_nop 0
buffer_load_dwordx4 v1, s[4:7], s48 offen offset:2048 sc1 lds
v_mfma_f32_32x32x16_bf16 v[32:47], v[140:143], a[116:119], v[32:47]
s_mov_b32 m0, s51
s_nop 0
buffer_load_dwordx4 v1, s[4:7], s48 offen offset:3072 sc1 lds
v_mfma_f32_32x32x16_bf16 v[48:63], v[140:143], a[180:183], v[48:63]
v_mfma_f32_32x32x16_bf16 v[64:79], v[140:143], a[244:247], v[64:79]
s_waitcnt lgkmcnt(1)
v_mfma_f32_32x32x16_bf16 v[32:47], v[144:147], a[120:123], v[32:47]
s_waitcnt vmcnt(4)
v_cmp_gt_u32 vcc, s42, v10
s_nop 0
s_cbranch_vccnz L_slow13
L_ret13:
v_mfma_f32_32x32x16_bf16 v[16:31], v[144:147], a[56:59], v[16:31]
v_mfma_f32_32x32x16_bf16 v[64:79], v[144:147], a[248:251], v[64:79]
v_mfma_f32_32x32x16_bf16 v[48:63], v[144:147], a[184:187], v[48:63]
s_waitcnt lgkmcnt(0)
v_mfma_f32_32x32x16_bf16 v[16:31], v[148:151], a[60:63], v[16:31]
v_mfma_f32_32x32x16_bf16 v[32:47], v[148:151], a[124:127], v[32:47]
v_mfma_f32_32x32x16_bf16 v[48:63], v[148:151], a[188:191], v[48:63]
s_nop 3
v_cvt_pk_bf16_f32 v80, v16, v32
v_cvt_pk_bf16_f32 v82, v18, v34
v_cvt_pk_bf16_f32 v86, v19, v35
v_mfma_f32_32x32x16_bf16 v[64:79], v[148:151], a[252:255], v[64:79]
v_permlane16_swap_b32 v80, v82
v_cvt_pk_bf16_f32 v84, v17, v33
v_cvt_pk_bf16_f32 v90, v22, v38
v_cvt_pk_bf16_f32 v88, v20, v36
v_permlane16_swap_b32 v84, v86
v_mfma_f32_32x32x16_bf16 v[112:127], v[192:195], v[152:155], 0
ds_read_b128 v[152:155], v2 offset:8192
v_permlane16_swap_b32 v88, v90
s_nop 1
v_cvt_pk_bf16_f32 v83, v50, v66
v_cvt_pk_bf16_f32 v81, v48, v64
v_cvt_pk_bf16_f32 v85, v49, v65
v_mfma_f32_32x32x16_bf16 v[112:127], v[196:199], v[156:159], v[112:127]
v_permlane16_swap_b32 v81, v83
buffer_store_dwordx4 v[80:83], v3, s[4:7], s57 offen offset:0
v_cvt_pk_bf16_f32 v87, v51, v67
v_cvt_pk_bf16_f32 v91, v54, v70
v_mfma_f32_32x32x16_bf16 v[112:127], v[200:203], v[160:163], v[112:127]
v_permlane16_swap_b32 v85, v87
v_cvt_pk_bf16_f32 v89, v52, v68
ds_read_b128 v[160:163], v2 offset:10240
v_cvt_pk_bf16_f32 v95, v55, v71
v_permlane16_swap_b32 v89, v91
v_mfma_f32_32x32x16_bf16 v[112:127], v[204:207], v[164:167], v[112:127]
ds_read_b128 v[156:159], v2 offset:9216
buffer_store_dwordx4 v[84:87], v3, s[4:7], s57 offen offset:1152
v_cvt_pk_bf16_f32 v92, v21, v37
v_cvt_pk_bf16_f32 v94, v23, v39
v_cvt_pk_bf16_f32 v93, v53, v69
v_mfma_f32_32x32x16_bf16 v[112:127], v[208:211], v[168:171], v[112:127]
s_nop 0
v_permlane16_swap_b32 v93, v95
v_permlane16_swap_b32 v92, v94
ds_read_b128 v[168:171], v2 offset:12288
v_cvt_pk_bf16_f32 v96, v24, v40
v_mfma_f32_32x32x16_bf16 v[112:127], v[212:215], v[172:175], v[112:127]
ds_read_b128 v[164:167], v2 offset:11264
buffer_store_dwordx4 v[88:91], v3, s[4:7], s58 offen offset:0
v_cvt_pk_bf16_f32 v98, v26, v42
v_cvt_pk_bf16_f32 v99, v58, v74
ds_read_b128 v[172:175], v2 offset:13312
v_mfma_f32_32x32x16_bf16 v[112:127], v[216:219], v[176:179], v[112:127]
v_cvt_pk_bf16_f32 v97, v56, v72
v_permlane16_swap_b32 v96, v98
s_nop 0
v_permlane16_swap_b32 v97, v99
v_cvt_pk_bf16_f32 v102, v27, v43
v_mfma_f32_32x32x16_bf16 v[112:127], v[220:223], v[180:183], v[112:127]
v_cvt_pk_bf16_f32 v100, v25, v41
buffer_store_dwordx4 v[92:95], v3, s[4:7], s58 offen offset:1152
ds_read_b128 v[176:179], v2 offset:14336
v_cvt_pk_bf16_f32 v101, v57, v73
v_cvt_pk_bf16_f32 v103, v59, v75
s_waitcnt lgkmcnt(6)
v_mfma_f32_32x32x16_bf16 v[112:127], v[224:227], v[152:155], v[112:127]
v_permlane16_swap_b32 v100, v102
v_permlane16_swap_b32 v101, v103
v_cvt_pk_bf16_f32 v105, v60, v76
s_waitcnt lgkmcnt(4)
v_mfma_f32_32x32x16_bf16 v[112:127], v[228:231], v[156:159], v[112:127]
buffer_store_dwordx4 v[96:99], v3, s[4:7], s59 offen offset:0
ds_read_b128 v[180:183], v2 offset:15360
v_cvt_pk_bf16_f32 v107, v62, v78
v_cvt_pk_bf16_f32 v104, v28, v44
v_mfma_f32_32x32x16_bf16 v[112:127], v[232:235], v[160:163], v[112:127]
v_cvt_pk_bf16_f32 v106, v30, v46
v_permlane16_swap_b32 v105, v107
s_nop 0
v_permlane16_swap_b32 v104, v106
v_cvt_pk_bf16_f32 v109, v61, v77
s_waitcnt lgkmcnt(3)
v_mfma_f32_32x32x16_bf16 v[112:127], v[236:239], v[164:167], v[112:127]
buffer_store_dwordx4 v[100:103], v3, s[4:7], s59 offen offset:1152
v_cvt_pk_bf16_f32 v108, v29, v45
v_cvt_pk_bf16_f32 v110, v31, v47
v_cvt_pk_bf16_f32 v111, v63, v79
v_mfma_f32_32x32x16_bf16 v[112:127], v[240:243], v[168:171], v[112:127]
v_permlane16_swap_b32 v108, v110
v_permlane16_swap_b32 v109, v111
v_xor_b32 v2, 0x8000, v2
s_waitcnt lgkmcnt(2)
v_mfma_f32_32x32x16_bf16 v[112:127], v[244:247], v[172:175], v[112:127]
buffer_store_dwordx4 v[104:107], v3, s[4:7], s60 offen offset:0
s_waitcnt lgkmcnt(1)
v_mfma_f32_32x32x16_bf16 v[112:127], v[248:251], v[176:179], v[112:127]
s_waitcnt lgkmcnt(0)
v_mfma_f32_32x32x16_bf16 v[112:127], v[252:255], v[180:183], v[112:127]
buffer_store_dwordx4 v[108:111], v3, s[4:7], s60 offen offset:1152
v_add_u32 v3, 1048576, v3
v_and_b32 v3, 2097151, v3
s_nop 8
v_cvt_pk_bf16_f32 v128, v112, v114
v_cvt_pk_bf16_f32 v131, v117, v119
v_cvt_pk_bf16_f32 v129, v116, v118
v_cvt_pk_bf16_f32 v130, v113, v115
v_cvt_pk_bf16_f32 v133, v124, v126
v_cvt_pk_bf16_f32 v132, v120, v122
buffer_store_dwordx4 v[128:131], v4, s[4:7], s57 offen offset:1024
v_cvt_pk_bf16_f32 v134, v121, v123
v_cvt_pk_bf16_f32 v135, v125, v127
buffer_store_dwordx4 v[132:135], v4, s[4:7], s57 offen offset:1056
v_add_u32 v4, 1048576, v4
v_and_b32 v4, 2097151, v4
s_waitcnt vmcnt(0)
s_cmp_eq_u32 s36, 0
s_cbranch_scc1 L_slow14
L_ret14:
buffer_store_dword v11, v7, s[4:7], s55 offen
s_add_u32 s38, s38, 1
s_add_u32 s66, s66, 1
s_cmp_le_u32 s38, 64
s_cbranch_scc1 L_wo_looplo
s_endpgm
L_wo_hi:
L_wo_loophi:
v_cmp_gt_u32 vcc, s38, v9
s_nop 0
s_cbranch_vccnz L_slow15
L_ret15:
s_barrier
s_max_i32 s42, s66, 0
s_and_b32 s61, s38, 3
s_cselect_b32 s61, 1, -3
s_mul_i32 s61, s61, 18432
s_add_u32 s48, s48, s61
s_xor_b32 s51, s51, 0x8000
v_add_u32 v4, 1048576, v4
ds_read_b128 v[136:139], v2 offset:0
v_mov_b32 v11, s38
v_and_b32 v4, 2097151, v4
ds_read_b128 v[140:143], v2 offset:1024
ds_read_b128 v[144:147], v2 offset:2048
ds_read_b128 v[148:151], v2 offset:3072
s_waitcnt lgkmcnt(3)
v_mfma_f32_32x32x16_bf16 v[16:31], v[136:139], a[0:3], 0
v_mfma_f32_32x32x16_bf16 v[32:47], v[136:139], a[64:67], 0
v_mfma_f32_32x32x16_bf16 v[48:63], v[136:139], a[128:131], 0
v_mfma_f32_32x32x16_bf16 v[64:79], v[136:139], a[192:195], 0
ds_read_b128 v[136:139], v2 offset:4096
s_waitcnt lgkmcnt(3)
v_mfma_f32_32x32x16_bf16 v[16:31], v[140:143], a[4:7], v[16:31]
v_mfma_f32_32x32x16_bf16 v[32:47], v[140:143], a[68:71], v[32:47]
v_mfma_f32_32x32x16_bf16 v[48:63], v[140:143], a[132:135], v[48:63]
v_mfma_f32_32x32x16_bf16 v[64:79], v[140:143], a[196:199], v[64:79]
ds_read_b128 v[140:143], v2 offset:5120
s_waitcnt lgkmcnt(3)
v_mfma_f32_32x32x16_bf16 v[16:31], v[144:147], a[8:11], v[16:31]
v_mfma_f32_32x32x16_bf16 v[32:47], v[144:147], a[72:75], v[32:47]
v_mfma_f32_32x32x16_bf16 v[48:63], v[144:147], a[136:139], v[48:63]
v_mfma_f32_32x32x16_bf16 v[64:79], v[144:147], a[200:203], v[64:79]
ds_read_b128 v[144:147], v2 offset:6144
s_waitcnt lgkmcnt(3)
v_mfma_f32_32x32x16_bf16 v[16:31], v[148:151], a[12:15], v[16:31]
v_mfma_f32_32x32x16_bf16 v[32:47], v[148:151], a[76:79], v[32:47]
v_mfma_f32_32x32x16_bf16 v[48:63], v[148:151], a[140:143], v[48:63]
v_mfma_f32_32x32x16_bf16 v[64:79], v[148:151], a[204:207], v[64:79]
ds_read_b128 v[148:151], v2 offset:7168
s_waitcnt lgkmcnt(3)
v_mfma_f32_32x32x16_bf16 v[16:31], v[136:139], a[16:19], v[16:31]
v_mfma_f32_32x32x16_bf16 v[32:47], v[136:139], a[80:83], v[32:47]
v_mfma_f32_32x32x16_bf16 v[48:63], v[136:139], a[144:147], v[48:63]
v_mfma_f32_32x32x16_bf16 v[64:79], v[136:139], a[208:211], v[64:79]
ds_read_b128 v[136:139], v2 offset:8192
s_waitcnt lgkmcnt(3)
v_mfma_f32_32x32x16_bf16 v[16:31], v[140:143], a[20:23], v[16:31]
v_mfma_f32_32x32x16_bf16 v[32:47], v[140:143], a[84:87], v[32:47]
v_mfma_f32_32x32x16_bf16 v[48:63], v[140:143], a[148:151], v[48:63]
v_mfma_f32_32x32x16_bf16 v[64:79], v[140:143], a[212:215], v[64:79]
ds_read_b128 v[140:143], v2 offset:9216
s_waitcnt lgkmcnt(3)
v_mfma_f32_32x32x16_bf16 v[16:31], v[144:147], a[24:27], v[16:31]
v_mfma_f32_32x32x16_bf16 v[32:47], v[144:147], a[88:91], v[32:47]
v_mfma_f32_32x32x16_bf16 v[48:63], v[144:147], a[152:155], v[48:63]
v_mfma_f32_32x32x16_bf16 v[64:79], v[144:147], a[216:219], v[64:79]
ds_read_b128 v[144:147], v2 offset:10240
s_waitcnt lgkmcnt(3)
v_mfma_f32_32x32x16_bf16 v[16:31], v[148:151], a[28:31], v[16:31]
v_mfma_f32_32x32x16_bf16 v[32:47], v[148:151], a[92:95], v[32:47]
v_mfma_f32_32x32x16_bf16 v[48:63], v[148:151], a[156:159], v[48:63]
v_mfma_f32_32x32x16_bf16 v[64:79], v[148:151], a[220:223], v[64:79]
ds_read_b128 v[148:151], v2 offset:11264
s_waitcnt lgkmcnt(3)
v_mfma_f32_32x32x16_bf16 v[16:31], v[136:139], a[32:35], v[16:31]
v_mfma_f32_32x32x16_bf16 v[32:47], v[136:139], a[96:99], v[32:47]
v_mfma_f32_32x32x16_bf16 v[48:63], v[136:139], a[160:163], v[48:63]
v_mfma_f32_32x32x16_bf16 v[64:79], v[136:139], a[224:227], v[64:79]
ds_read_b128 v[136:139], v2 offset:12288
s_waitcnt lgkmcnt(3)
v_mfma_f32_32x32x16_bf16 v[16:31], v[140:143], a[36:39], v[16:31]
v_mfma_f32_32x32x16_bf16 v[32:47], v[140:143], a[100:103], v[32:47]
v_mfma_f32_32x32x16_bf16 v[48:63], v[140:143], a[164:167], v[48:63]
v_mfma_f32_32x32x16_bf16 v[64:79], v[140:143], a[228:231], v[64:79]
ds_read_b128 v[140:143], v2 offset:13312
s_waitcnt lgkmcnt(3)
v_mfma_f32_32x32x16_bf16 v[16:31], v[144:147], a[40:43], v[16:31]
buffer_load_dword v9, v8, s[4:7], s53 offen sc1
v_mfma_f32_32x32x16_bf16 v[32:47], v[144:147], a[104:107], v[32:47]
v_mfma_f32_32x32x16_bf16 v[48:63], v[144:147], a[168:171], v[48:63]
v_mfma_f32_32x32x16_bf16 v[64:79], v[144:147], a[232:235], v[64:79]
ds_read_b128 v[144:147], v2 offset:14336
s_waitcnt lgkmcnt(3)
v_mfma_f32_32x32x16_bf16 v[16:31], v[148:151], a[44:47], v[16:31]
v_mfma_f32_32x32x16_bf16 v[32:47], v[148:151], a[108:111], v[32:47]
v_mfma_f32_32x32x16_bf16 v[48:63], v[148:151], a[172:175], v[48:63]
v_mfma_f32_32x32x16_bf16 v[64:79], v[148:151], a[236:239], v[64:79]
buffer_load_dword v10, v5, s[4:7], s41 offen sc1
ds_read_b128 v[148:151], v2 offset:15360
v_xor_b32 v2, 0x8000, v2
s_waitcnt lgkmcnt(3)
v_mfma_f32_32x32x16_bf16 v[16:31], v[136:139], a[48:51], v[16:31]
v_mfma_f32_32x32x16_bf16 v[32:47], v[136:139], a[112:115], v[32:47]
v_mfma_f32_32x32x16_bf16 v[48:63], v[136:139], a[176:179], v[48:63]
s_waitcnt vmcnt(1)
s_mov_b32 m0, s51
s_nop 0
buffer_load_dwordx4 v1, s[4:7], s48 offen offset:0 sc1 lds
v_mfma_f32_32x32x16_bf16 v[64:79], v[136:139], a[240:243], v[64:79]
s_mov_b32 m0, s51
s_nop 0
buffer_load_dwordx4 v1, s[4:7], s48 offen offset:1024 sc1 lds
s_waitcnt lgkmcnt(2)
v_mfma_f32_32x32x16_bf16 v[16:31], v[140:143], a[52:55], v[16:31]
s_mov_b32 m0, s51
s_nop 0
buffer_load_dwordx4 v1, s[4:7], s48 offen offset:2048 sc1 lds
v_mfma_f32_32x32x16_bf16 v[32:47], v[140:143], a[116:119], v[32:47]
s_mov_b32 m0, s51
s_nop 0
buffer_load_dwordx4 v1, s[4:7], s48 offen offset:3072 sc1 lds
v_mfma_f32_32x32x16_bf16 v[48:63], v[140:143], a[180:183], v[48:63]
v_mfma_f32_32x32x16_bf16 v[64:79], v[140:143], a[244:247], v[64:79]
s_waitcnt lgkmcnt(1)
v_mfma_f32_32x32x16_bf16 v[16:31], v[144:147], a[56:59], v[16:31]
s_waitcnt vmcnt(4)
v_cmp_gt_u32 vcc, s42, v10
s_nop 0
s_cbranch_vccnz L_slow16
L_ret16:
v_mfma_f32_32x32x16_bf16 v[32:47], v[144:147], a[120:123], v[32:47]
v_mfma_f32_32x32x16_bf16 v[48:63], v[144:147], a[184:187], v[48:63]
v_mfma_f32_32x32x16_bf16 v[64:79], v[144:147], a[248:251], v[64:79]
s_waitcnt lgkmcnt(0)
v_mfma_f32_32x32x16_bf16 v[16:31], v[148:151], a[60:63], v[16:31]
v_mfma_f32_32x32x16_bf16 v[32:47], v[148:151], a[124:127], v[32:47]
v_mfma_f32_32x32x16_bf16 v[48:63], v[148:151], a[188:191], v[48:63]
s_nop 3
v_cvt_pk_bf16_f32 v80, v16, v32
v_cvt_pk_bf16_f32 v82, v18, v34
v_cvt_pk_bf16_f32 v84, v17, v33
v_mfma_f32_32x32x16_bf16 v[64:79], v[148:151], a[252:255], v[64:79]
v_permlane16_swap_b32 v80, v82
v_cvt_pk_bf16_f32 v86, v19, v35
v_cvt_pk_bf16_f32 v88, v20, v36
v_cvt_pk_bf16_f32 v90, v22, v38
v_permlane16_swap_b32 v84, v86
s_nop 0
v_permlane16_swap_b32 v88, v90
v_cvt_pk_bf16_f32 v92, v21, v37
v_cvt_pk_bf16_f32 v94, v23, v39
s_nop 2
v_cvt_pk_bf16_f32 v81, v48, v64
v_cvt_pk_bf16_f32 v83, v50, v66
v_cvt_pk_bf16_f32 v85, v49, v65
v_cvt_pk_bf16_f32 v87, v51, v67
v_permlane16_swap_b32 v81, v83
buffer_store_dwordx4 v[80:83], v3, s[4:7], s57 offen offset:0
v_permlane16_swap_b32 v85, v87
v_cvt_pk_bf16_f32 v89, v52, v68
v_cvt_pk_bf16_f32 v91, v54, v70
v_cvt_pk_bf16_f32 v93, v53, v69
v_cvt_pk_bf16_f32 v95, v55, v71
v_permlane16_swap_b32 v89, v91
v_permlane16_swap_b32 v92, v94
v_permlane16_swap_b32 v93, v95
v_cvt_pk_bf16_f32 v96, v24, v40
v_cvt_pk_bf16_f32 v98, v26, v42
buffer_store_dwordx4 v[84:87], v3, s[4:7], s57 offen offset:1152
v_cvt_pk_bf16_f32 v97, v56, v72
v_cvt_pk_bf16_f32 v99, v58, v74
v_permlane16_swap_b32 v96, v98
s_nop 0
v_permlane16_swap_b32 v97, v99
v_cvt_pk_bf16_f32 v100, v25, v41
v_cvt_pk_bf16_f32 v102, v27, v43
v_cvt_pk_bf16_f32 v101, v57, v73
v_cvt_pk_bf16_f32 v103, v59, v75
v_permlane16_swap_b32 v100, v102
s_nop 0
v_permlane16_swap_b32 v101, v103
buffer_store_dwordx4 v[88:91], v3, s[4:7], s58 offen offset:0
v_cvt_pk_bf16_f32 v104, v28, v44
v_cvt_pk_bf16_f32 v106, v30, v46
v_cvt_pk_bf16_f32 v105, v60, v76
v_cvt_pk_bf16_f32 v107, v62, v78
v_permlane16_swap_b32 v104, v106
s_nop 0
v_permlane16_swap_b32 v105, v107
v_cvt_pk_bf16_f32 v108, v29, v45
v_cvt_pk_bf16_f32 v110, v31, v47
v_cvt_pk_bf16_f32 v109, v61, v77
v_cvt_pk_bf16_f32 v111, v63, v79
v_permlane16_swap_b32 v108, v110
buffer_store_dwordx4 v[92:95], v3, s[4:7], s58 offen offset:1152
v_permlane16_swap_b32 v109, v111
buffer_store_dwordx4 v[96:99], v3, s[4:7], s59 offen offset:0
buffer_store_dwordx4 v[100:103], v3, s[4:7], s59 offen offset:1152
buffer_store_dwordx4 v[104:107], v3, s[4:7], s60 offen offset:0
buffer_store_dwordx4 v[108:111], v3, s[4:7], s60 offen offset:1152
v_add_u32 v3, 1048576, v3
v_and_b32 v3, 2097151, v3
s_waitcnt vmcnt(0)
s_cmp_eq_u32 s36, 0
s_cbranch_scc1 L_slow17
L_ret17:
buffer_store_dword v11, v7, s[4:7], s55 offen
s_add_u32 s38, s38, 1
s_add_u32 s66, s66, 1
s_cmp_le_u32 s38, 64
s_cbranch_scc1 L_wo_loophi
s_endpgm
L_slow12:
L_woo_poll1:
buffer_load_dword v9, v8, s[4:7], s53 offen sc1
s_waitcnt vmcnt(0)
v_cmp_gt_u32 vcc, s38, v9
s_nop 0
s_cbranch_vccz L_woo_pd2
s_sleep 1
s_sub_u32 s37, s37, 1
s_cbranch_scc0 L_woo_poll1
s_movk_i32 s39, 82
s_branch L_bail
L_woo_pd2:
s_mov_b32 m0, s51
s_nop 0
buffer_load_dwordx4 v1, s[4:7], s48 offen offset:0 sc1 lds
s_mov_b32 m0, s51
s_nop 0
buffer_load_dwordx4 v1, s[4:7], s48 offen offset:1024 sc1 lds
s_mov_b32 m0, s51
s_nop 0
buffer_load_dwordx4 v1, s[4:7], s48 offen offset:2048 sc1 lds
s_mov_b32 m0, s51
s_nop 0
buffer_load_dwordx4 v1, s[4:7], s48 offen offset:3072 sc1 lds
s_waitcnt vmcnt(0)
s_branch L_ret12
L_slow13:
L_woo_poll3:
buffer_load_dword v10, v5, s[4:7], s41 offen sc1
s_waitcnt vmcnt(0)
v_cmp_gt_u32 vcc, s42, v10
s_nop 0
s_cbranch_vccz L_woo_pd4
s_sleep 1
s_sub_u32 s37, s37, 1
s_cbranch_scc0 L_woo_poll3
s_movk_i32 s39, 55
s_branch L_bail
L_woo_pd4:
s_branch L_ret13
L_slow14:
s_waitcnt vmcnt(0)
buffer_wbl2 sc1
s_waitcnt vmcnt(0)
buffer_store_dword v11, v6, s[4:7], s55 offen sc1
s_branch L_ret14
L_slow15:
L_woo_poll5:
buffer_load_dword v9, v8, s[4:7], s53 offen sc1
s_waitcnt vmcnt(0)
v_cmp_gt_u32 vcc, s38, v9
s_nop 0
s_cbranch_vccz L_woo_pd6
s_sleep 1
s_sub_u32 s37, s37, 1
s_cbranch_scc0 L_woo_poll5
s_movk_i32 s39, 82
s_branch L_bail
L_woo_pd6:
s_mov_b32 m0, s51
s_nop 0
buffer_load_dwordx4 v1, s[4:7], s48 offen offset:0 sc1 lds
s_mov_b32 m0, s51
s_nop 0
buffer_load_dwordx4 v1, s[4:7], s48 offen offset:1024 sc1 lds
s_mov_b32 m0, s51
s_nop 0
buffer_load_dwordx4 v1, s[4:7], s48 offen offset:2048 sc1 lds
s_mov_b32 m0, s51
s_nop 0
buffer_load_dwordx4 v1, s[4:7], s48 offen offset:3072 sc1 lds
s_waitcnt vmcnt(0)
s_branch L_ret15
L_slow16:
L_woo_poll7:
buffer_load_dword v10, v5, s[4:7], s41 offen sc1
s_waitcnt vmcnt(0)
v_cmp_gt_u32 vcc, s42, v10
s_nop 0
s_cbranch_vccz L_woo_pd8
s_sleep 1
s_sub_u32 s37, s37, 1
s_cbranch_scc0 L_woo_poll7
s_movk_i32 s39, 55
s_branch L_bail
L_woo_pd8:
s_branch L_ret16
L_slow17:
s_waitcnt vmcnt(0)
buffer_wbl2 sc1
s_waitcnt vmcnt(0)
buffer_store_dword v11, v6, s[4:7], s55 offen sc1
s_branch L_ret17
L_AT_end:
.p2align 6
L_ML:
s_getpc_b64 s[40:41]
L_ML_pc:
v_lshl_add_u32 v2, s35, 6, v0
v_lshlrev_b32 v2, 7, v2
v_min_u32 v3, L_ML_end-L_ML_pc-4, v2
global_load_dword a255, v3, s[40:41]
v_add_u32 v2, 0x8000, v2
v_min_u32 v3, L_ML_end-L_ML_pc-4, v2
global_load_dword a255, v3, s[40:41]
s_cmp_ge_u32 s34, 16
s_cbranch_scc1 L_backm
s_mov_b32 s8, s80
s_and_b32 s9, s81, 0xffff
s_mov_b32 s10, 5308416
s_mov_b32 s11, 0x20000
s_mov_b32 s20, s82
s_and_b32 s21, s83, 0xffff
s_mov_b32 s22, 9216
s_mov_b32 s23, 0x20000
s_mul_i32 s46, s34, 576
s_add_u32 s47, s46, 256
v_lshrrev_b32 v8, 5, v0
v_lshlrev_b32 v8, 3, v8
v_bfe_u32 v9, v0, 2, 2
v_add_u32 v8, v8, v9
v_mul_u32_u24 v8, 1088, v8
v_bfe_u32 v9, v0, 4, 1
v_lshl_add_u32 v8, v9, 5, v8
v_and_b32 v9, 3, v0
v_lshl_add_u32 v8, v9, 3, v8
v_lshl_add_u32 v8, s35, 6, v8
v_add_u32 v9, 52224, v8
v_add_u32 v10, 104448, v8
s_xor_b32 s48, s35, 0
s_lshl_b32 s48, s48, 8
s_xor_b32 s49, s35, 1
s_lshl_b32 s49, s49, 8
s_xor_b32 s50, s35, 2
s_lshl_b32 s50, s50, 8
s_xor_b32 s51, s35, 3
s_lshl_b32 s51, s51, 8
s_mul_i32 s45, s35, 4352
v_lshrrev_b32 v11, 4, v0
v_lshlrev_b32 v11, 2, v11
v_add_u32 v11, s35, v11
v_mul_u32_u24 v11, 36864, v11
v_and_b32 v13, 15, v0
v_lshl_add_u32 v11, v13, 4, v11
v_add_u32 v11, s46, v11
v_lshrrev_b32 v12, 4, v0
v_lshlrev_b32 v12, 2, v12
v_add_u32 v12, s35, v12
v_mul_u32_u24 v12, 36864, v12
v_and_b32 v13, 15, v0
v_lshl_add_u32 v12, v13, 4, v12
v_add_u32 v12, s47, v12
s_mov_b32 s44, 0
s_add_u32 m0, s45, 0
s_nop 0
buffer_load_dwordx4 v11, s[8:11], s44 offen offset:0 lds
s_mov_b32 s44, 9216
s_add_u32 m0, s45, 1088
s_nop 0
buffer_load_dwordx4 v11, s[8:11], s44 offen offset:0 lds
s_mov_b32 s44, 18432
s_add_u32 m0, s45, 2176
s_nop 0
buffer_load_dwordx4 v11, s[8:11], s44 offen offset:0 lds
s_mov_b32 s44, 27648
s_add_u32 m0, s45, 3264
s_nop 0
buffer_load_dwordx4 v11, s[8:11], s44 offen offset:0 lds
s_mov_b32 s44, 589824
s_add_u32 m0, s45, 17408
s_nop 0
buffer_load_dwordx4 v11, s[8:11], s44 offen offset:0 lds
s_mov_b32 s44, 599040
s_add_u32 m0, s45, 18496
s_nop 0
buffer_load_dwordx4 v11, s[8:11], s44 offen offset:0 lds
s_mov_b32 s44, 608256
s_add_u32 m0, s45, 19584
s_nop 0
buffer_load_dwordx4 v11, s[8:11], s44 offen offset:0 lds
s_mov_b32 s44, 617472
s_add_u32 m0, s45, 20672
s_nop 0
buffer_load_dwordx4 v11, s[8:11], s44 offen offset:0 lds
s_mov_b32 s44, 1179648
s_add_u32 m0, s45, 34816
s_nop 0
buffer_load_dwordx4 v11, s[8:11], s44 offen offset:0 lds
s_mov_b32 s44, 1188864
s_add_u32 m0, s45, 35904
s_nop 0
buffer_load_dwordx4 v11, s[8:11], s44 offen offset:0 lds
s_mov_b32 s44, 1198080
s_add_u32 m0, s45, 36992
s_nop 0
buffer_load_dwordx4 v11, s[8:11], s44 offen offset:0 lds
s_mov_b32 s44, 1207296
s_add_u32 m0, s45, 38080
s_nop 0
buffer_load_dwordx4 v11, s[8:11], s44 offen offset:0 lds
s_mov_b32 s44, 1769472
s_add_u32 m0, s45, 52224
s_nop 0
buffer_load_dwordx4 v11, s[8:11], s44 offen offset:0 lds
s_mov_b32 s44, 1778688
s_add_u32 m0, s45, 53312
s_nop 0
buffer_load_dwordx4 v11, s[8:11], s44 offen offset:0 lds
s_mov_b32 s44, 1787904
s_add_u32 m0, s45, 54400
s_nop 0
buffer_load_dwordx4 v11, s[8:11], s44 offen offset:0 lds
s_mov_b32 s44, 1797120
s_add_u32 m0, s45, 55488
s_nop 0
buffer_load_dwordx4 v11, s[8:11], s44 offen offset:0 lds
s_mov_b32 s44, 2359296
s_add_u32 m0, s45, 69632
s_nop 0
buffer_load_dwordx4 v11, s[8:11], s44 offen offset:0 lds
s_mov_b32 s44, 2368512
s_add_u32 m0, s45, 70720
s_nop 0
buffer_load_dwordx4 v11, s[8:11], s44 offen offset:0 lds
s_mov_b32 s44, 2377728
s_add_u32 m0, s45, 71808
s_nop 0
buffer_load_dwordx4 v11, s[8:11], s44 offen offset:0 lds
s_mov_b32 s44, 2386944
s_add_u32 m0, s45, 72896
s_nop 0
buffer_load_dwordx4 v11, s[8:11], s44 offen offset:0 lds
s_mov_b32 s44, 2949120
s_add_u32 m0, s45, 87040
s_nop 0
buffer_load_dwordx4 v11, s[8:11], s44 offen offset:0 lds
s_mov_b32 s44, 2958336
s_add_u32 m0, s45, 88128
s_nop 0
buffer_load_dwordx4 v11, s[8:11], s44 offen offset:0 lds
s_mov_b32 s44, 2967552
s_add_u32 m0, s45, 89216
s_nop 0
buffer_load_dwordx4 v11, s[8:11], s44 offen offset:0 lds
s_mov_b32 s44, 2976768
s_add_u32 m0, s45, 90304
s_nop 0
buffer_load_dwordx4 v11, s[8:11], s44 offen offset:0 lds
s_mov_b32 s44, 3538944
s_add_u32 m0, s45, 104448
s_nop 0
buffer_load_dwordx4 v11, s[8:11], s44 offen offset:0 lds
s_mov_b32 s44, 3548160
s_add_u32 m0, s45, 105536
s_nop 0
buffer_load_dwordx4 v11, s[8:11], s44 offen offset:0 lds
s_mov_b32 s44, 3557376
s_add_u32 m0, s45, 106624
s_nop 0
buffer_load_dwordx4 v11, s[8:11], s44 offen offset:0 lds
s_mov_b32 s44, 3566592
s_add_u32 m0, s45, 107712
s_nop 0
buffer_load_dwordx4 v11, s[8:11], s44 offen offset:0 lds
s_mov_b32 s44, 4128768
s_add_u32 m0, s45, 121856
s_nop 0
buffer_load_dwordx4 v11, s[8:11], s44 offen offset:0 lds
s_mov_b32 s44, 4137984
s_add_u32 m0, s45, 122944
s_nop 0
buffer_load_dwordx4 v11, s[8:11], s44 offen offset:0 lds
s_mov_b32 s44, 4147200
s_add_u32 m0, s45, 124032
s_nop 0
buffer_load_dwordx4 v11, s[8:11], s44 offen offset:0 lds
s_mov_b32 s44, 4156416
s_add_u32 m0, s45, 125120
s_nop 0
buffer_load_dwordx4 v11, s[8:11], s44 offen offset:0 lds
s_mov_b32 s44, 4718592
s_add_u32 m0, s45, 139264
s_nop 0
buffer_load_dwordx4 v11, s[8:11], s44 offen offset:0 lds
s_mov_b32 s44, 4727808
s_add_u32 m0, s45, 140352
s_nop 0
buffer_load_dwordx4 v11, s[8:11], s44 offen offset:0 lds
s_mov_b32 s44, 4737024
s_add_u32 m0, s45, 141440
s_nop 0
buffer_load_dwordx4 v11, s[8:11], s44 offen offset:0 lds
s_mov_b32 s44, 4746240
s_add_u32 m0, s45, 142528
s_nop 0
buffer_load_dwordx4 v11, s[8:11], s44 offen offset:0 lds
s_waitcnt vmcnt(24)
s_barrier
v_add_u32 v20, s48, v8
ds_read_b64_tr_b16 a[0:1], v20 offset:0
ds_read_b64_tr_b16 a[2:3], v20 offset:4352
v_add_u32 v21, s49, v8
ds_read_b64_tr_b16 a[4:5], v21 offset:0
ds_read_b64_tr_b16 a[6:7], v21 offset:4352
v_add_u32 v22, s50, v8
ds_read_b64_tr_b16 a[8:9], v22 offset:0
ds_read_b64_tr_b16 a[10:11], v22 offset:4352
v_add_u32 v23, s51, v8
ds_read_b64_tr_b16 a[12:13], v23 offset:0
ds_read_b64_tr_b16 a[14:15], v23 offset:4352
v_add_u32 v20, s48, v8
ds_read_b64_tr_b16 a[16:17], v20 offset:17408
ds_read_b64_tr_b16 a[18:19], v20 offset:21760
v_add_u32 v21, s49, v8
ds_read_b64_tr_b16 a[20:21], v21 offset:17408
ds_read_b64_tr_b16 a[22:23], v21 offset:21760
v_add_u32 v22, s50, v8
ds_read_b64_tr_b16 a[24:25], v22 offset:17408
ds_read_b64_tr_b16 a[26:27], v22 offset:21760
v_add_u32 v23, s51, v8
ds_read_b64_tr_b16 a[28:29], v23 offset:17408
ds_read_b64_tr_b16 a[30:31], v23 offset:21760
v_add_u32 v20, s48, v8
ds_read_b64_tr_b16 a[32:33], v20 offset:34816
ds_read_b64_tr_b16 a[34:35], v20 offset:39168
v_add_u32 v21, s49, v8
ds_read_b64_tr_b16 a[36:37], v21 offset:34816
ds_read_b64_tr_b16 a[38:39], v21 offset:39168
v_add_u32 v22, s50, v8
ds_read_b64_tr_b16 a[40:41], v22 offset:34816
ds_read_b64_tr_b16 a[42:43], v22 offset:39168
v_add_u32 v23, s51, v8
ds_read_b64_tr_b16 a[44:45], v23 offset:34816
ds_read_b64_tr_b16 a[46:47], v23 offset:39168
s_waitcnt lgkmcnt(0)
s_barrier
s_mov_b32 s44, 0
s_add_u32 m0, s45, 0
s_nop 0
buffer_load_dwordx4 v12, s[8:11], s44 offen offset:0 lds
s_mov_b32 s44, 9216
s_add_u32 m0, s45, 1088
s_nop 0
buffer_load_dwordx4 v12, s[8:11], s44 offen offset:0 lds
s_mov_b32 s44, 18432
s_add_u32 m0, s45, 2176
s_nop 0
buffer_load_dwordx4 v12, s[8:11], s44 offen offset:0 lds
s_mov_b32 s44, 27648
s_add_u32 m0, s45, 3264
s_nop 0
buffer_load_dwordx4 v12, s[8:11], s44 offen offset:0 lds
s_mov_b32 s44, 589824
s_add_u32 m0, s45, 17408
s_nop 0
buffer_load_dwordx4 v12, s[8:11], s44 offen offset:0 lds
s_mov_b32 s44, 599040
s_add_u32 m0, s45, 18496
s_nop 0
buffer_load_dwordx4 v12, s[8:11], s44 offen offset:0 lds
s_mov_b32 s44, 608256
s_add_u32 m0, s45, 19584
s_nop 0
buffer_load_dwordx4 v12, s[8:11], s44 offen offset:0 lds
s_mov_b32 s44, 617472
s_add_u32 m0, s45, 20672
s_nop 0
buffer_load_dwordx4 v12, s[8:11], s44 offen offset:0 lds
s_mov_b32 s44, 1179648
s_add_u32 m0, s45, 34816
s_nop 0
buffer_load_dwordx4 v12, s[8:11], s44 offen offset:0 lds
s_mov_b32 s44, 1188864
s_add_u32 m0, s45, 35904
s_nop 0
buffer_load_dwordx4 v12, s[8:11], s44 offen offset:0 lds
s_mov_b32 s44, 1198080
s_add_u32 m0, s45, 36992
s_nop 0
buffer_load_dwordx4 v12, s[8:11], s44 offen offset:0 lds
s_mov_b32 s44, 1207296
s_add_u32 m0, s45, 38080
s_nop 0
buffer_load_dwordx4 v12, s[8:11], s44 offen offset:0 lds
s_waitcnt vmcnt(24)
s_barrier
v_add_u32 v20, s48, v9
ds_read_b64_tr_b16 a[48:49], v20 offset:0
ds_read_b64_tr_b16 a[50:51], v20 offset:4352
v_add_u32 v21, s49, v9
ds_read_b64_tr_b16 a[52:53], v21 offset:0
ds_read_b64_tr_b16 a[54:55], v21 offset:4352
v_add_u32 v22, s50, v9
ds_read_b64_tr_b16 a[56:57], v22 offset:0
ds_read_b64_tr_b16 a[58:59], v22 offset:4352
v_add_u32 v23, s51, v9
ds_read_b64_tr_b16 a[60:61], v23 offset:0
ds_read_b64_tr_b16 a[62:63], v23 offset:4352
v_add_u32 v20, s48, v9
ds_read_b64_tr_b16 a[64:65], v20 offset:17408
ds_read_b64_tr_b16 a[66:67], v20 offset:21760
v_add_u32 v21, s49, v9
ds_read_b64_tr_b16 a[68:69], v21 offset:17408
ds_read_b64_tr_b16 a[70:71], v21 offset:21760
v_add_u32 v22, s50, v9
ds_read_b64_tr_b16 a[72:73], v22 offset:17408
ds_read_b64_tr_b16 a[74:75], v22 offset:21760
v_add_u32 v23, s51, v9
ds_read_b64_tr_b16 a[76:77], v23 offset:17408
ds_read_b64_tr_b16 a[78:79], v23 offset:21760
v_add_u32 v20, s48, v9
ds_read_b64_tr_b16 a[80:81], v20 offset:34816
ds_read_b64_tr_b16 a[82:83], v20 offset:39168
v_add_u32 v21, s49, v9
ds_read_b64_tr_b16 a[84:85], v21 offset:34816
ds_read_b64_tr_b16 a[86:87], v21 offset:39168
v_add_u32 v22, s50, v9
ds_read_b64_tr_b16 a[88:89], v22 offset:34816
ds_read_b64_tr_b16 a[90:91], v22 offset:39168
v_add_u32 v23, s51, v9
ds_read_b64_tr_b16 a[92:93], v23 offset:34816
ds_read_b64_tr_b16 a[94:95], v23 offset:39168
s_waitcnt lgkmcnt(0)
s_barrier
s_mov_b32 s44, 1769472
s_add_u32 m0, s45, 52224
s_nop 0
buffer_load_dwordx4 v12, s[8:11], s44 offen offset:0 lds
s_mov_b32 s44, 1778688
s_add_u32 m0, s45, 53312
s_nop 0
buffer_load_dwordx4 v12, s[8:11], s44 offen offset:0 lds
s_mov_b32 s44, 1787904
s_add_u32 m0, s45, 54400
s_nop 0
buffer_load_dwordx4 v12, s[8:11], s44 offen offset:0 lds
s_mov_b32 s44, 1797120
s_add_u32 m0, s45, 55488
s_nop 0
buffer_load_dwordx4 v12, s[8:11], s44 offen offset:0 lds
s_mov_b32 s44, 2359296
s_add_u32 m0, s45, 69632
s_nop 0
buffer_load_dwordx4 v12, s[8:11], s44 offen offset:0 lds
s_mov_b32 s44, 2368512
s_add_u32 m0, s45, 70720
s_nop 0
buffer_load_dwordx4 v12, s[8:11], s44 offen offset:0 lds
s_mov_b32 s44, 2377728
s_add_u32 m0, s45, 71808
s_nop 0
buffer_load_dwordx4 v12, s[8:11], s44 offen offset:0 lds
s_mov_b32 s44, 2386944
s_add_u32 m0, s45, 72896
s_nop 0
buffer_load_dwordx4 v12, s[8:11], s44 offen offset:0 lds
s_mov_b32 s44, 2949120
s_add_u32 m0, s45, 87040
s_nop 0
buffer_load_dwordx4 v12, s[8:11], s44 offen offset:0 lds
s_mov_b32 s44, 2958336
s_add_u32 m0, s45, 88128
s_nop 0
buffer_load_dwordx4 v12, s[8:11], s44 offen offset:0 lds
s_mov_b32 s44, 2967552
s_add_u32 m0, s45, 89216
s_nop 0
buffer_load_dwordx4 v12, s[8:11], s44 offen offset:0 lds
s_mov_b32 s44, 2976768
s_add_u32 m0, s45, 90304
s_nop 0
buffer_load_dwordx4 v12, s[8:11], s44 offen offset:0 lds
s_waitcnt vmcnt(24)
s_barrier
v_add_u32 v20, s48, v10
ds_read_b64_tr_b16 a[96:97], v20 offset:0
ds_read_b64_tr_b16 a[98:99], v20 offset:4352
v_add_u32 v21, s49, v10
ds_read_b64_tr_b16 a[100:101], v21 offset:0
ds_read_b64_tr_b16 a[102:103], v21 offset:4352
v_add_u32 v22, s50, v10
ds_read_b64_tr_b16 a[104:105], v22 offset:0
ds_read_b64_tr_b16 a[106:107], v22 offset:4352
v_add_u32 v23, s51, v10
ds_read_b64_tr_b16 a[108:109], v23 offset:0
ds_read_b64_tr_b16 a[110:111], v23 offset:4352
v_add_u32 v20, s48, v10
ds_read_b64_tr_b16 a[112:113], v20 offset:17408
ds_read_b64_tr_b16 a[114:115], v20 offset:21760
v_add_u32 v21, s49, v10
ds_read_b64_tr_b16 a[116:117], v21 offset:17408
ds_read_b64_tr_b16 a[118:119], v21 offset:21760
v_add_u32 v22, s50, v10
ds_read_b64_tr_b16 a[120:121], v22 offset:17408
ds_read_b64_tr_b16 a[122:123], v22 offset:21760
v_add_u32 v23, s51, v10
ds_read_b64_tr_b16 a[124:125], v23 offset:17408
ds_read_b64_tr_b16 a[126:127], v23 offset:21760
v_add_u32 v20, s48, v10
ds_read_b64_tr_b16 a[128:129], v20 offset:34816
ds_read_b64_tr_b16 a[130:131], v20 offset:39168
v_add_u32 v21, s49, v10
ds_read_b64_tr_b16 a[132:133], v21 offset:34816
ds_read_b64_tr_b16 a[134:135], v21 offset:39168
v_add_u32 v22, s50, v10
ds_read_b64_tr_b16 a[136:137], v22 offset:34816
ds_read_b64_tr_b16 a[138:139], v22 offset:39168
v_add_u32 v23, s51, v10
ds_read_b64_tr_b16 a[140:141], v23 offset:34816
ds_read_b64_tr_b16 a[142:143], v23 offset:39168
s_waitcnt lgkmcnt(0)
s_barrier
s_mov_b32 s44, 3538944
s_add_u32 m0, s45, 104448
s_nop 0
buffer_load_dwordx4 v12, s[8:11], s44 offen offset:0 lds
s_mov_b32 s44, 3548160
s_add_u32 m0, s45, 105536
s_nop 0
buffer_load_dwordx4 v12, s[8:11], s44 offen offset:0 lds
s_mov_b32 s44, 3557376
s_add_u32 m0, s45, 106624
s_nop 0
buffer_load_dwordx4 v12, s[8:11], s44 offen offset:0 lds
s_mov_b32 s44, 3566592
s_add_u32 m0, s45, 107712
s_nop 0
buffer_load_dwordx4 v12, s[8:11], s44 offen offset:0 lds
s_mov_b32 s44, 4128768
s_add_u32 m0, s45, 121856
s_nop 0
buffer_load_dwordx4 v12, s[8:11], s44 offen offset:0 lds
s_mov_b32 s44, 4137984
s_add_u32 m0, s45, 122944
s_nop 0
buffer_load_dwordx4 v12, s[8:11], s44 offen offset:0 lds
s_mov_b32 s44, 4147200
s_add_u32 m0, s45, 124032
s_nop 0
buffer_load_dwordx4 v12, s[8:11], s44 offen offset:0 lds
s_mov_b32 s44, 4156416
s_add_u32 m0, s45, 125120
s_nop 0
buffer_load_dwordx4 v12, s[8:11], s44 offen offset:0 lds
s_mov_b32 s44, 4718592
s_add_u32 m0, s45, 139264
s_nop 0
buffer_load_dwordx4 v12, s[8:11], s44 offen offset:0 lds
s_mov_b32 s44, 4727808
s_add_u32 m0, s45, 140352
s_nop 0
buffer_load_dwordx4 v12, s[8:11], s44 offen offset:0 lds
s_mov_b32 s44, 4737024
s_add_u32 m0, s45, 141440
s_nop 0
buffer_load_dwordx4 v12, s[8:11], s44 offen offset:0 lds
s_mov_b32 s44, 4746240
s_add_u32 m0, s45, 142528
s_nop 0
buffer_load_dwordx4 v12, s[8:11], s44 offen offset:0 lds
s_waitcnt vmcnt(24)
s_barrier
v_add_u32 v20, s48, v8
ds_read_b64_tr_b16 a[144:145], v20 offset:0
ds_read_b64_tr_b16 a[146:147], v20 offset:4352
v_add_u32 v21, s49, v8
ds_read_b64_tr_b16 a[148:149], v21 offset:0
ds_read_b64_tr_b16 a[150:151], v21 offset:4352
v_add_u32 v22, s50, v8
ds_read_b64_tr_b16 a[152:153], v22 offset:0
ds_read_b64_tr_b16 a[154:155], v22 offset:4352
v_add_u32 v23, s51, v8
ds_read_b64_tr_b16 a[156:157], v23 offset:0
ds_read_b64_tr_b16 a[158:159], v23 offset:4352
v_add_u32 v20, s48, v8
ds_read_b64_tr_b16 a[160:161], v20 offset:17408
ds_read_b64_tr_b16 a[162:163], v20 offset:21760
v_add_u32 v21, s49, v8
ds_read_b64_tr_b16 a[164:165], v21 offset:17408
ds_read_b64_tr_b16 a[166:167], v21 offset:21760
v_add_u32 v22, s50, v8
ds_read_b64_tr_b16 a[168:169], v22 offset:17408
ds_read_b64_tr_b16 a[170:171], v22 offset:21760
v_add_u32 v23, s51, v8
ds_read_b64_tr_b16 a[172:173], v23 offset:17408
ds_read_b64_tr_b16 a[174:175], v23 offset:21760
v_add_u32 v20, s48, v8
ds_read_b64_tr_b16 a[176:177], v20 offset:34816
ds_read_b64_tr_b16 a[178:179], v20 offset:39168
v_add_u32 v21, s49, v8
ds_read_b64_tr_b16 a[180:181], v21 offset:34816
ds_read_b64_tr_b16 a[182:183], v21 offset:39168
v_add_u32 v22, s50, v8
ds_read_b64_tr_b16 a[184:185], v22 offset:34816
ds_read_b64_tr_b16 a[186:187], v22 offset:39168
v_add_u32 v23, s51, v8
ds_read_b64_tr_b16 a[188:189], v23 offset:34816
ds_read_b64_tr_b16 a[190:191], v23 offset:39168
s_waitcnt vmcnt(12)
s_barrier
v_add_u32 v20, s48, v9
ds_read_b64_tr_b16 a[192:193], v20 offset:0
ds_read_b64_tr_b16 a[194:195], v20 offset:4352
v_add_u32 v21, s49, v9
ds_read_b64_tr_b16 a[196:197], v21 offset:0
ds_read_b64_tr_b16 a[198:199], v21 offset:4352
v_add_u32 v22, s50, v9
ds_read_b64_tr_b16 a[200:201], v22 offset:0
ds_read_b64_tr_b16 a[202:203], v22 offset:4352
v_add_u32 v23, s51, v9
ds_read_b64_tr_b16 a[204:205], v23 offset:0
ds_read_b64_tr_b16 a[206:207], v23 offset:4352
v_add_u32 v20, s48, v9
ds_read_b64_tr_b16 a[208:209], v20 offset:17408
ds_read_b64_tr_b16 a[210:211], v20 offset:21760
v_add_u32 v21, s49, v9
ds_read_b64_tr_b16 a[212:213], v21 offset:17408
ds_read_b64_tr_b16 a[214:215], v21 offset:21760
v_add_u32 v22, s50, v9
ds_read_b64_tr_b16 a[216:217], v22 offset:17408
ds_read_b64_tr_b16 a[218:219], v22 offset:21760
v_add_u32 v23, s51, v9
ds_read_b64_tr_b16 a[220:221], v23 offset:17408
ds_read_b64_tr_b16 a[222:223], v23 offset:21760
v_add_u32 v20, s48, v9
ds_read_b64_tr_b16 a[224:225], v20 offset:34816
ds_read_b64_tr_b16 a[226:227], v20 offset:39168
v_add_u32 v21, s49, v9
ds_read_b64_tr_b16 a[228:229], v21 offset:34816
ds_read_b64_tr_b16 a[230:231], v21 offset:39168
v_add_u32 v22, s50, v9
ds_read_b64_tr_b16 a[232:233], v22 offset:34816
ds_read_b64_tr_b16 a[234:235], v22 offset:39168
v_add_u32 v23, s51, v9
ds_read_b64_tr_b16 a[236:237], v23 offset:34816
ds_read_b64_tr_b16 a[238:239], v23 offset:39168
s_waitcnt vmcnt(0)
s_barrier
v_add_u32 v20, s48, v10
ds_read_b64_tr_b16 a[240:241], v20 offset:0
ds_read_b64_tr_b16 a[242:243], v20 offset:4352
v_add_u32 v21, s49, v10
ds_read_b64_tr_b16 a[244:245], v21 offset:0
ds_read_b64_tr_b16 a[246:247], v21 offset:4352
v_add_u32 v22, s50, v10
ds_read_b64_tr_b16 a[248:249], v22 offset:0
ds_read_b64_tr_b16 a[250:251], v22 offset:4352
v_add_u32 v23, s51, v10
ds_read_b64_tr_b16 a[252:253], v23 offset:0
ds_read_b64_tr_b16 a[254:255], v23 offset:4352
v_add_u32 v20, s48, v10
ds_read_b64_tr_b16 v[188:189], v20 offset:17408
ds_read_b64_tr_b16 v[190:191], v20 offset:21760
v_add_u32 v21, s49, v10
ds_read_b64_tr_b16 v[192:193], v21 offset:17408
ds_read_b64_tr_b16 v[194:195], v21 offset:21760
v_add_u32 v22, s50, v10
ds_read_b64_tr_b16 v[196:197], v22 offset:17408
ds_read_b64_tr_b16 v[198:199], v22 offset:21760
v_add_u32 v23, s51, v10
ds_read_b64_tr_b16 v[200:201], v23 offset:17408
ds_read_b64_tr_b16 v[202:203], v23 offset:21760
v_add_u32 v20, s48, v10
ds_read_b64_tr_b16 v[204:205], v20 offset:34816
ds_read_b64_tr_b16 v[206:207], v20 offset:39168
v_add_u32 v21, s49, v10
ds_read_b64_tr_b16 v[208:209], v21 offset:34816
ds_read_b64_tr_b16 v[210:211], v21 offset:39168
v_add_u32 v22, s50, v10
ds_read_b64_tr_b16 v[212:213], v22 offset:34816
ds_read_b64_tr_b16 v[214:215], v22 offset:39168
v_add_u32 v23, s51, v10
ds_read_b64_tr_b16 v[216:217], v23 offset:34816
ds_read_b64_tr_b16 v[218:219], v23 offset:39168
s_waitcnt lgkmcnt(0)
s_barrier
v_lshrrev_b32 v8, 2, v0
v_lshl_add_u32 v8, s35, 4, v8
v_mul_u32_u24 v8, 9216, v8
v_and_b32 v9, 3, v0
v_lshl_add_u32 v8, v9, 4, v8
s_mul_i32 s45, s35, 9216
s_add_u32 s44, s46, 512
s_add_u32 m0, s45, 0
s_nop 0
buffer_load_dwordx4 v8, s[8:11], s44 offen lds
s_add_u32 s44, s46, 590336
s_add_u32 m0, s45, 1024
s_nop 0
buffer_load_dwordx4 v8, s[8:11], s44 offen lds
s_add_u32 s44, s46, 1180160
s_add_u32 m0, s45, 2048
s_nop 0
buffer_load_dwordx4 v8, s[8:11], s44 offen lds
s_add_u32 s44, s46, 1769984
s_add_u32 m0, s45, 3072
s_nop 0
buffer_load_dwordx4 v8, s[8:11], s44 offen lds
s_add_u32 s44, s46, 2359808
s_add_u32 m0, s45, 4096
s_nop 0
buffer_load_dwordx4 v8, s[8:11], s44 offen lds
s_add_u32 s44, s46, 2949632
s_add_u32 m0, s45, 5120
s_nop 0
buffer_load_dwordx4 v8, s[8:11], s44 offen lds
s_add_u32 s44, s46, 3539456
s_add_u32 m0, s45, 6144
s_nop 0
buffer_load_dwordx4 v8, s[8:11], s44 offen lds
s_add_u32 s44, s46, 4129280
s_add_u32 m0, s45, 7168
s_nop 0
buffer_load_dwordx4 v8, s[8:11], s44 offen lds
s_add_u32 s44, s46, 4719104
s_add_u32 m0, s45, 8192
s_nop 0
buffer_load_dwordx4 v8, s[8:11], s44 offen lds
v_lshrrev_b32 v10, 5, v0
v_lshlrev_b32 v10, 3, v10
v_bfe_u32 v11, v0, 2, 2
v_add_u32 v10, v10, v11
v_lshlrev_b32 v10, 6, v10
v_bfe_u32 v11, v0, 4, 1
v_lshl_add_u32 v10, v11, 5, v10
v_lshl_add_u32 v10, v9, 3, v10
v_add_u32 v10, s45, v10
s_waitcnt vmcnt(0)
ds_read_b64_tr_b16 v[220:221], v10 offset:0
ds_read_b64_tr_b16 v[222:223], v10 offset:256
ds_read_b64_tr_b16 v[224:225], v10 offset:1024
ds_read_b64_tr_b16 v[226:227], v10 offset:1280
ds_read_b64_tr_b16 v[228:229], v10 offset:2048
ds_read_b64_tr_b16 v[230:231], v10 offset:2304
ds_read_b64_tr_b16 v[232:233], v10 offset:3072
ds_read_b64_tr_b16 v[234:235], v10 offset:3328
ds_read_b64_tr_b16 v[236:237], v10 offset:4096
ds_read_b64_tr_b16 v[238:239], v10 offset:4352
ds_read_b64_tr_b16 v[240:241], v10 offset:5120
ds_read_b64_tr_b16 v[242:243], v10 offset:5376
ds_read_b64_tr_b16 v[244:245], v10 offset:6144
ds_read_b64_tr_b16 v[246:247], v10 offset:6400
ds_read_b64_tr_b16 v[248:249], v10 offset:7168
ds_read_b64_tr_b16 v[250:251], v10 offset:7424
ds_read_b64_tr_b16 v[252:253], v10 offset:8192
ds_read_b64_tr_b16 v[254:255], v10 offset:8448
s_waitcnt lgkmcnt(0)
s_barrier
v_lshl_add_u32 v48, s35, 6, v0
v_lshlrev_b32 v48, 20, v48
buffer_load_dword v50, v48, s[4:7], 0 offen
buffer_load_dword v50, v48, s[16:19], 0 offen
v_and_b32 v48, 7, v0
v_lshlrev_b32 v48, 3, v48
L_f1_cen1:
buffer_load_dwordx2 v[50:51], v48, s[24:27], s0 offen sc1
s_waitcnt vmcnt(0)
v_sad_u8 v49, v50, 0, 0
v_sad_u8 v49, v51, 0, v49
v_cmp_ne_u32 vcc, 32, v49
s_nop 0
s_cbranch_vccz L_f1_cend2
s_sleep 16
s_sub_u32 s37, s37, 1
s_cbranch_scc0 L_f1_cen1
s_movk_i32 s39, 65
s_branch L_bail
L_f1_cend2:
v_bcnt_u32_b32 v49, v50, 0
v_bcnt_u32_b32 v49, v51, v49
v_cmp_ne_u32 vcc, 1, v49
v_readlane_b32 s41, v49, s1
s_cbranch_vccz L_f1_cok3
s_cmp_eq_u32 s0, 0
s_cbranch_scc1 L_redo
L_f1_cok3:
s_cmp_eq_u32 s41, 1
s_cselect_b32 s36, 1, 0
s_cmp_eq_u32 s36, 0
s_cselect_b32 s45, 0x7ffffff0, 0
v_mov_b32 v14, s45
v_lshrrev_b32 v60, 3, v0
v_lshl_add_u32 v60, s35, 3, v60
v_bfe_u32 v61, v60, 1, 3
v_xor_b32 v61, v61, v0
v_and_b32 v61, 7, v61
v_mul_u32_u24 v1, 1152, v60
v_lshl_add_u32 v1, v61, 4, v1
v_and_b32 v60, 31, v0
v_bfe_u32 v61, v0, 1, 3
v_lshrrev_b32 v62, 5, v0
v_xor_b32 v61, v61, v62
s_lshl_b32 s45, s35, 1
v_xor_b32 v61, s45, v61
v_xor_b32 v62, 0, v61
v_lshlrev_b32 v62, 4, v62
v_lshl_add_u32 v2, v60, 7, v62
v_xor_b32 v62, 2, v61
v_lshlrev_b32 v62, 4, v62
v_lshl_add_u32 v3, v60, 7, v62
v_xor_b32 v62, 4, v61
v_lshlrev_b32 v62, 4, v62
v_lshl_add_u32 v4, v60, 7, v62
v_xor_b32 v62, 6, v61
v_lshlrev_b32 v62, 4, v62
v_lshl_add_u32 v5, v60, 7, v62
v_lshlrev_b32 v60, 4, v0
v_lshl_add_u32 v6, s35, 11, v60
s_lshr_b32 s44, s35, 1
s_and_b32 s45, s35, 1
v_lshl_add_u32 v7, s44, 10, v60
v_lshl_add_u32 v7, s45, 3, v7
v_add_u32 v7, 16384, v7
v_lshl_add_u32 v8, s35, 12, v60
v_lshl_add_u32 v9, s35, 10, v60
v_xor_b32 v9, 0x10000, v9
v_mov_b32 v10, 0
v_mov_b32 v11, 0
v_and_b32 v15, 7, v0
v_lshlrev_b32 v15, 2, v15
v_bfe_u32 v61, v0, 3, 2
v_lshl_add_u32 v15, v61, 7, v15
v_mov_b32 v13, 0xbdd2d3e8
v_lshrrev_b32 v61, 5, v0
v_lshlrev_b32 v61, 3, v61
v_lshl_add_u32 v62, s35, 6, v61
v_lshl_add_u32 v63, s35, 4, v61
buffer_load_dwordx2 v[68:69], v62, s[20:23], s46 offen offset:0
buffer_load_dwordx2 v[70:71], v62, s[20:23], s46 offen offset:16
buffer_load_dwordx2 v[72:73], v62, s[20:23], s46 offen offset:32
buffer_load_dwordx2 v[74:75], v62, s[20:23], s46 offen offset:48
buffer_load_dwordx2 v[76:77], v62, s[20:23], s46 offen offset:256
buffer_load_dwordx2 v[78:79], v62, s[20:23], s46 offen offset:272
buffer_load_dwordx2 v[80:81], v62, s[20:23], s46 offen offset:288
buffer_load_dwordx2 v[82:83], v62, s[20:23], s46 offen offset:304
buffer_load_dwordx2 v[66:67], v63, s[20:23], s46 offen offset:512
s_waitcnt vmcnt(0)
v_lshlrev_b32 v16, 16, v66
v_and_b32 v17, 0xffff0000, v66
v_lshlrev_b32 v18, 16, v67
v_and_b32 v19, 0xffff0000, v67
v_lshlrev_b32 v20, 16, v68
v_and_b32 v21, 0xffff0000, v68
v_lshlrev_b32 v22, 16, v69
v_and_b32 v23, 0xffff0000, v69
v_lshlrev_b32 v24, 16, v70
v_and_b32 v25, 0xffff0000, v70
v_lshlrev_b32 v26, 16, v71
v_and_b32 v27, 0xffff0000, v71
v_lshlrev_b32 v28, 16, v72
v_and_b32 v29, 0xffff0000, v72
v_lshlrev_b32 v30, 16, v73
v_and_b32 v31, 0xffff0000, v73
v_lshlrev_b32 v32, 16, v74
v_and_b32 v33, 0xffff0000, v74
v_lshlrev_b32 v34, 16, v75
v_and_b32 v35, 0xffff0000, v75
v_lshlrev_b32 v36, 16, v76
v_and_b32 v37, 0xffff0000, v76
v_lshlrev_b32 v38, 16, v77
v_and_b32 v39, 0xffff0000, v77
v_lshlrev_b32 v40, 16, v78
v_and_b32 v41, 0xffff0000, v78
v_lshlrev_b32 v42, 16, v79
v_and_b32 v43, 0xffff0000, v79
v_lshlrev_b32 v44, 16, v80
v_and_b32 v45, 0xffff0000, v80
v_lshlrev_b32 v46, 16, v81
v_and_b32 v47, 0xffff0000, v81
v_lshlrev_b32 v48, 16, v82
v_and_b32 v49, 0xffff0000, v82
v_lshlrev_b32 v50, 16, v83
v_and_b32 v51, 0xffff0000, v83
s_mul_i32 s48, s33, 2359296
s_add_u32 s48, s48, 6815744
s_lshl_b32 s51, s35, 10
s_lshl_b32 s53, s33, 9
s_add_u32 s53, s53, 8192
s_lshl_b32 s45, s33, 4
s_add_u32 s45, s45, s34
s_add_u32 s45, s45, 32
s_mul_i32 s57, s45, 73728
s_add_u32 s57, s57, 167772160
s_lshl_b32 s56, s45, 7
s_add_u32 s56, s56, 24576
s_lshl_b32 s44, s35, 2
s_add_u32 s56, s56, s44
s_add_u32 s58, s57, 8192
s_mov_b32 s38, 1
s_mov_b32 s65, 0
s_mov_b32 s8, 0
s_lshl_b32 s59, s33, 9
s_lshl_b32 s44, s34, 4
s_add_u32 s59, s59, s44
s_add_u32 s59, s59, 20480
v_and_b32 v0, 12, v15
v_xor_b32 v9, 0x10000, v9
L_f1_wait:
L_f1_poll4:
buffer_load_dword v11, v15, s[4:7], s53 offen sc1
s_waitcnt vmcnt(0)
v_cmp_gt_u32 vcc, s38, v11
s_nop 0
s_cbranch_vccz L_f1_pd5
s_sleep 1
s_sub_u32 s37, s37, 1
s_cbranch_scc0 L_f1_poll4
s_movk_i32 s39, 66
s_branch L_bail
L_f1_pd5:
s_add_u32 m0, s51, 0
s_nop 0
buffer_load_dwordx4 v1, s[4:7], s48 offen offset:0 sc1 lds
s_add_u32 m0, s51, 3968
s_nop 0
buffer_load_dwordx4 v1, s[4:7], s48 offen offset:128 sc1 lds
s_add_u32 m0, s51, 7936
s_nop 0
buffer_load_dwordx4 v1, s[4:7], s48 offen offset:256 sc1 lds
s_add_u32 m0, s51, 11904
s_nop 0
buffer_load_dwordx4 v1, s[4:7], s48 offen offset:384 sc1 lds
s_add_u32 m0, s51, 15872
s_nop 0
buffer_load_dwordx4 v1, s[4:7], s48 offen offset:512 sc1 lds
s_add_u32 m0, s51, 19840
s_nop 0
buffer_load_dwordx4 v1, s[4:7], s48 offen offset:640 sc1 lds
s_add_u32 m0, s51, 23808
s_nop 0
buffer_load_dwordx4 v1, s[4:7], s48 offen offset:768 sc1 lds
s_add_u32 m0, s51, 27776
s_nop 0
buffer_load_dwordx4 v1, s[4:7], s48 offen offset:896 sc1 lds
s_add_u32 m0, s51, 31744
s_nop 0
buffer_load_dwordx4 v1, s[4:7], s48 offen offset:1024 sc1 lds
s_waitcnt vmcnt(0)
s_barrier
buffer_load_dword v12, v0, s[4:7], s59 offen sc1
s_add_u32 s48, s48, 36864
s_xor_b32 s51, s51, 0x10000
s_sub_i32 s60, s38, 4
s_max_i32 s60, s60, 0
ds_read_b128 v[100:103], v2 offset:0
s_and_b32 s61, s38, 3
s_cselect_b32 s61, 1, -3
s_mul_i32 s61, s61, 18432
ds_read_b128 v[104:107], v3 offset:0
ds_read_b128 v[108:111], v4 offset:0
ds_read_b128 v[112:115], v5 offset:0
ds_read_b128 v[116:119], v2 offset:4096
ds_read_b128 v[120:123], v3 offset:4096
ds_read_b128 v[124:127], v4 offset:4096
ds_read_b128 v[128:131], v5 offset:4096
ds_read_b128 v[132:135], v2 offset:8192
ds_read_b128 v[136:139], v3 offset:8192
s_waitcnt lgkmcnt(9)
v_mfma_f32_32x32x16_bf16 v[84:99], v[220:223], v[100:103], 0
v_mfma_f32_32x32x16_bf16 v[52:67], a[0:3], v[100:103], v[20:35]
ds_read_b128 v[100:103], v4 offset:8192
s_waitcnt lgkmcnt(9)
v_mfma_f32_32x32x16_bf16 v[52:67], a[4:7], v[104:107], v[52:67]
ds_read_b128 v[104:107], v5 offset:8192
s_waitcnt lgkmcnt(9)
v_mfma_f32_32x32x16_bf16 v[52:67], a[8:11], v[108:111], v[52:67]
ds_read_b128 v[108:111], v2 offset:12288
s_waitcnt vmcnt(0)
v_cmp_gt_u32 vcc, s60, v12
s_nop 0
s_cbranch_vccnz L_slow18
L_ret18:
s_waitcnt lgkmcnt(9)
v_mfma_f32_32x32x16_bf16 v[52:67], a[12:15], v[112:115], v[52:67]
ds_read_b128 v[112:115], v3 offset:12288
s_waitcnt lgkmcnt(9)
v_mfma_f32_32x32x16_bf16 v[84:99], v[224:227], v[116:119], v[84:99]
v_mfma_f32_32x32x16_bf16 v[52:67], a[16:19], v[116:119], v[52:67]
ds_read_b128 v[116:119], v4 offset:12288
s_waitcnt lgkmcnt(9)
v_mfma_f32_32x32x16_bf16 v[52:67], a[20:23], v[120:123], v[52:67]
ds_read_b128 v[120:123], v5 offset:12288
s_waitcnt lgkmcnt(9)
v_mfma_f32_32x32x16_bf16 v[52:67], a[24:27], v[124:127], v[52:67]
ds_read_b128 v[124:127], v2 offset:16384
s_waitcnt lgkmcnt(9)
v_mfma_f32_32x32x16_bf16 v[52:67], a[28:31], v[128:131], v[52:67]
ds_read_b128 v[128:131], v3 offset:16384
s_waitcnt lgkmcnt(9)
v_mfma_f32_32x32x16_bf16 v[84:99], v[228:231], v[132:135], v[84:99]
v_mfma_f32_32x32x16_bf16 v[52:67], a[32:35], v[132:135], v[52:67]
ds_read_b128 v[132:135], v4 offset:16384
s_waitcnt lgkmcnt(9)
v_mfma_f32_32x32x16_bf16 v[52:67], a[36:39], v[136:139], v[52:67]
ds_read_b128 v[136:139], v5 offset:16384
s_waitcnt lgkmcnt(9)
v_mfma_f32_32x32x16_bf16 v[52:67], a[40:43], v[100:103], v[52:67]
ds_read_b128 v[100:103], v2 offset:20480
s_waitcnt lgkmcnt(9)
v_mfma_f32_32x32x16_bf16 v[52:67], a[44:47], v[104:107], v[52:67]
ds_read_b128 v[104:107], v3 offset:20480
s_waitcnt lgkmcnt(9)
v_mfma_f32_32x32x16_bf16 v[84:99], v[232:235], v[108:111], v[84:99]
v_mfma_f32_32x32x16_bf16 v[52:67], a[48:51], v[108:111], v[52:67]
ds_read_b128 v[108:111], v4 offset:20480
s_waitcnt lgkmcnt(9)
v_mfma_f32_32x32x16_bf16 v[52:67], a[52:55], v[112:115], v[52:67]
ds_read_b128 v[112:115], v5 offset:20480
s_waitcnt lgkmcnt(9)
v_mfma_f32_32x32x16_bf16 v[52:67], a[56:59], v[116:119], v[52:67]
ds_read_b128 v[116:119], v2 offset:24576
s_waitcnt lgkmcnt(9)
v_mfma_f32_32x32x16_bf16 v[52:67], a[60:63], v[120:123], v[52:67]
ds_read_b128 v[120:123], v3 offset:24576
s_waitcnt lgkmcnt(9)
v_mfma_f32_32x32x16_bf16 v[84:99], v[236:239], v[124:127], v[84:99]
v_mfma_f32_32x32x16_bf16 v[52:67], a[64:67], v[124:127], v[52:67]
ds_read_b128 v[124:127], v4 offset:24576
s_waitcnt lgkmcnt(9)
v_mfma_f32_32x32x16_bf16 v[52:67], a[68:71], v[128:131], v[52:67]
ds_read_b128 v[128:131], v5 offset:24576
s_waitcnt lgkmcnt(9)
v_mfma_f32_32x32x16_bf16 v[52:67], a[72:75], v[132:135], v[52:67]
ds_read_b128 v[132:135], v2 offset:28672
s_waitcnt lgkmcnt(9)
v_mfma_f32_32x32x16_bf16 v[52:67], a[76:79], v[136:139], v[52:67]
ds_read_b128 v[136:139], v3 offset:28672
s_waitcnt lgkmcnt(9)
v_mfma_f32_32x32x16_bf16 v[84:99], v[240:243], v[100:103], v[84:99]
v_mfma_f32_32x32x16_bf16 v[52:67], a[80:83], v[100:103], v[52:67]
ds_read_b128 v[100:103], v4 offset:28672
s_waitcnt lgkmcnt(9)
v_mfma_f32_32x32x16_bf16 v[52:67], a[84:87], v[104:107], v[52:67]
ds_read_b128 v[104:107], v5 offset:28672
s_waitcnt lgkmcnt(9)
v_mfma_f32_32x32x16_bf16 v[52:67], a[88:91], v[108:111], v[52:67]
ds_read_b128 v[108:111], v2 offset:32768
s_waitcnt lgkmcnt(9)
v_mfma_f32_32x32x16_bf16 v[52:67], a[92:95], v[112:115], v[52:67]
ds_read_b128 v[112:115], v3 offset:32768
s_waitcnt lgkmcnt(9)
v_mfma_f32_32x32x16_bf16 v[84:99], v[244:247], v[116:119], v[84:99]
v_mfma_f32_32x32x16_bf16 v[52:67], a[96:99], v[116:119], v[52:67]
ds_read_b128 v[116:119], v4 offset:32768
s_waitcnt lgkmcnt(9)
v_mfma_f32_32x32x16_bf16 v[52:67], a[100:103], v[120:123], v[52:67]
ds_read_b128 v[120:123], v5 offset:32768
s_waitcnt lgkmcnt(9)
v_mfma_f32_32x32x16_bf16 v[52:67], a[104:107], v[124:127], v[52:67]
ds_read_b128 v[124:127], v2 offset:0
s_waitcnt lgkmcnt(9)
v_mfma_f32_32x32x16_bf16 v[52:67], a[108:111], v[128:131], v[52:67]
ds_read_b128 v[128:131], v3 offset:0
s_waitcnt lgkmcnt(9)
v_mfma_f32_32x32x16_bf16 v[84:99], v[248:251], v[132:135], v[84:99]
v_mfma_f32_32x32x16_bf16 v[52:67], a[112:115], v[132:135], v[52:67]
ds_read_b128 v[132:135], v4 offset:0
s_waitcnt lgkmcnt(9)
v_mfma_f32_32x32x16_bf16 v[52:67], a[116:119], v[136:139], v[52:67]
ds_read_b128 v[136:139], v5 offset:0
s_waitcnt lgkmcnt(9)
v_mfma_f32_32x32x16_bf16 v[52:67], a[120:123], v[100:103], v[52:67]
ds_read_b128 v[100:103], v2 offset:4096
s_waitcnt lgkmcnt(9)
v_mfma_f32_32x32x16_bf16 v[52:67], a[124:127], v[104:107], v[52:67]
ds_read_b128 v[104:107], v3 offset:4096
s_waitcnt lgkmcnt(9)
v_mfma_f32_32x32x16_bf16 v[84:99], v[252:255], v[108:111], v[84:99]
v_mfma_f32_32x32x16_bf16 v[52:67], a[128:131], v[108:111], v[52:67]
ds_read_b128 v[108:111], v4 offset:4096
s_nop 2
ds_write_b128 v8, v[84:87] offset:36864
s_waitcnt lgkmcnt(10)
v_mfma_f32_32x32x16_bf16 v[52:67], a[132:135], v[112:115], v[52:67]
s_waitcnt lgkmcnt(9)
v_mfma_f32_32x32x16_bf16 v[52:67], a[136:139], v[116:119], v[52:67]
ds_read_b128 v[112:115], v5 offset:4096
ds_read_b128 v[116:119], v2 offset:8192
s_waitcnt lgkmcnt(10)
v_mfma_f32_32x32x16_bf16 v[52:67], a[140:143], v[120:123], v[52:67]
ds_read_b128 v[120:123], v3 offset:8192
ds_write_b128 v8, v[88:91] offset:37888
s_waitcnt lgkmcnt(11)
v_mfma_f32_32x32x16_bf16 v[68:83], a[144:147], v[124:127], v[36:51]
s_nop 3
v_mul_f32 v156, v52, v52
v_mul_f32 v157, v53, v53
v_mul_f32 v164, v60, v60
v_mul_f32 v165, v61, v61
s_waitcnt lgkmcnt(10)
v_mfma_f32_32x32x16_bf16 v[68:83], a[148:151], v[128:131], v[68:83]
ds_read_b128 v[124:127], v4 offset:8192
v_mul_f32 v158, v54, v54
v_mul_f32 v159, v55, v55
v_mul_f32 v166, v62, v62
ds_read_b128 v[128:131], v5 offset:8192
s_waitcnt lgkmcnt(11)
v_mfma_f32_32x32x16_bf16 v[68:83], a[152:155], v[132:135], v[68:83]
ds_read_b128 v[132:135], v2 offset:12288
v_mul_f32 v167, v63, v63
v_fmaak_f32 v156, v13, v156, 0xc0135761
v_fmaak_f32 v157, v13, v157, 0xc0135761
ds_write_b128 v8, v[92:95] offset:38912
s_waitcnt lgkmcnt(12)
v_mfma_f32_32x32x16_bf16 v[68:83], a[156:159], v[136:139], v[68:83]
v_fmaak_f32 v164, v13, v164, 0xc0135761
v_fmaak_f32 v165, v13, v165, 0xc0135761
v_mul_f32 v160, v56, v56
v_mul_f32 v161, v57, v57
v_mul_f32 v162, v58, v58
s_waitcnt lgkmcnt(11)
v_mfma_f32_32x32x16_bf16 v[68:83], a[160:163], v[100:103], v[68:83]
ds_read_b128 v[136:139], v3 offset:12288
v_mul_f32 v163, v59, v59
v_mul_f32 v168, v64, v64
v_mul_f32 v169, v65, v65
ds_read_b128 v[100:103], v4 offset:12288
s_waitcnt lgkmcnt(12)
v_mfma_f32_32x32x16_bf16 v[68:83], a[164:167], v[104:107], v[68:83]
ds_write_b128 v8, v[96:99] offset:39936
v_mul_f32 v170, v66, v66
v_mul_f32 v171, v67, v67
v_fmaak_f32 v158, v13, v158, 0xc0135761
s_waitcnt lgkmcnt(12)
v_mfma_f32_32x32x16_bf16 v[68:83], a[168:171], v[108:111], v[68:83]
v_fmaak_f32 v159, v13, v159, 0xc0135761
v_fmaak_f32 v166, v13, v166, 0xc0135761
v_fmaak_f32 v167, v13, v167, 0xc0135761
v_mul_f32 v156, v156, v52
v_mul_f32 v157, v157, v53
s_waitcnt lgkmcnt(10)
v_mfma_f32_32x32x16_bf16 v[68:83], a[172:175], v[112:115], v[68:83]
ds_read_b128 v[104:107], v5 offset:12288
v_mul_f32 v164, v164, v60
v_mul_f32 v165, v165, v61
v_fmaak_f32 v160, v13, v160, 0xc0135761
ds_read_b128 v[108:111], v2 offset:16384
s_waitcnt lgkmcnt(11)
v_mfma_f32_32x32x16_bf16 v[68:83], a[176:179], v[116:119], v[68:83]
buffer_load_dword v11, v15, s[4:7], s53 offen sc1
ds_read_b128 v[112:115], v3 offset:16384
v_fmaak_f32 v161, v13, v161, 0xc0135761
v_fmaak_f32 v162, v13, v162, 0xc0135761
s_waitcnt lgkmcnt(11)
v_mfma_f32_32x32x16_bf16 v[68:83], a[180:183], v[120:123], v[68:83]
ds_read_b128 v[116:119], v4 offset:16384
v_fmaak_f32 v163, v13, v163, 0xc0135761
v_fmaak_f32 v168, v13, v168, 0xc0135761
v_fmaak_f32 v169, v13, v169, 0xc0135761
ds_read_b128 v[120:123], v5 offset:16384
s_waitcnt lgkmcnt(11)
v_mfma_f32_32x32x16_bf16 v[68:83], a[184:187], v[124:127], v[68:83]
ds_read_b128 v[124:127], v2 offset:20480
s_waitcnt lgkmcnt(6)
s_barrier
v_fmaak_f32 v170, v13, v170, 0xc0135761
v_mfma_f32_32x32x16_bf16 v[68:83], a[188:191], v[128:131], v[68:83]
ds_read_b128 v[128:131], v3 offset:20480
v_fmaak_f32 v171, v13, v171, 0xc0135761
v_mul_f32 v158, v158, v54
v_mul_f32 v159, v159, v55
ds_read_b128 v[140:143], v9 offset:36864
v_mul_f32 v166, v166, v62
v_mfma_f32_32x32x16_bf16 v[68:83], a[192:195], v[132:135], v[68:83]
ds_read_b128 v[132:135], v4 offset:20480
v_mul_f32 v167, v167, v63
v_exp_f32 v156, v156
ds_read_b128 v[144:147], v9 offset:40960
v_exp_f32 v157, v157
v_mfma_f32_32x32x16_bf16 v[68:83], a[196:199], v[136:139], v[68:83]
ds_read_b128 v[136:139], v5 offset:20480
v_exp_f32 v164, v164
v_exp_f32 v165, v165
v_mul_f32 v160, v160, v56
v_mfma_f32_32x32x16_bf16 v[68:83], a[200:203], v[100:103], v[68:83]
ds_read_b128 v[100:103], v2 offset:24576
v_mul_f32 v161, v161, v57
v_mul_f32 v162, v162, v58
v_mul_f32 v163, v163, v59
ds_read_b128 v[148:151], v9 offset:45056
v_mul_f32 v168, v168, v64
s_waitcnt lgkmcnt(12)
v_mfma_f32_32x32x16_bf16 v[68:83], a[204:207], v[104:107], v[68:83]
ds_read_b128 v[104:107], v3 offset:24576
v_mul_f32 v169, v169, v65
v_mul_f32 v170, v170, v66
v_mul_f32 v171, v171, v67
ds_read_b128 v[152:155], v9 offset:49152
s_waitcnt lgkmcnt(13)
v_mfma_f32_32x32x16_bf16 v[68:83], a[208:211], v[108:111], v[68:83]
v_exp_f32 v158, v158
ds_read_b128 v[108:111], v4 offset:24576
v_exp_f32 v159, v159
s_waitcnt lgkmcnt(13)
v_mfma_f32_32x32x16_bf16 v[68:83], a[212:215], v[112:115], v[68:83]
v_exp_f32 v166, v166
ds_read_b128 v[112:115], v5 offset:24576
s_waitcnt lgkmcnt(7)
v_add_f32 v140, v140, v144
v_mfma_f32_32x32x16_bf16 v[68:83], a[216:219], v[116:119], v[68:83]
v_add_f32 v141, v141, v145
v_add_f32 v142, v142, v146
ds_read_b128 v[116:119], v2 offset:28672
v_add_f32 v143, v143, v147
v_add_f32 v140, v140, v16
v_add_f32 v141, v141, v17
v_mfma_f32_32x32x16_bf16 v[68:83], a[220:223], v[120:123], v[68:83]
v_add_f32 v142, v142, v18
v_add_f32 v143, v143, v19
ds_read_b128 v[120:123], v3 offset:28672
v_exp_f32 v167, v167
v_exp_f32 v160, v160
v_mfma_f32_32x32x16_bf16 v[68:83], a[224:227], v[124:127], v[68:83]
v_exp_f32 v161, v161
ds_read_b128 v[124:127], v4 offset:28672
s_waitcnt vmcnt(0)
s_add_u32 m0, s51, 0
s_nop 0
buffer_load_dwordx4 v1, s[4:7], s48 offen offset:0 sc1 lds
v_mfma_f32_32x32x16_bf16 v[68:83], a[228:231], v[128:131], v[68:83]
s_waitcnt lgkmcnt(5)
v_add_f32 v148, v148, v152
ds_read_b128 v[128:131], v5 offset:28672
v_add_f32 v149, v149, v153
v_add_f32 v150, v150, v154
v_add_f32 v151, v151, v155
v_mfma_f32_32x32x16_bf16 v[68:83], a[232:235], v[132:135], v[68:83]
s_add_u32 m0, s51, 3968
s_nop 0
buffer_load_dwordx4 v1, s[4:7], s48 offen offset:128 sc1 lds
v_add_f32 v140, v140, v148
v_add_f32 v141, v141, v149
ds_read_b128 v[132:135], v2 offset:32768
v_mfma_f32_32x32x16_bf16 v[68:83], a[236:239], v[136:139], v[68:83]
v_add_f32 v142, v142, v150
ds_read_b128 v[136:139], v3 offset:32768
v_add_f32 v143, v143, v151
v_mul_f32 v144, v140, v140
v_mul_f32 v145, v141, v141
v_mul_f32 v146, v142, v142
s_add_u32 m0, s51, 7936
s_nop 0
buffer_load_dwordx4 v1, s[4:7], s48 offen offset:256 sc1 lds
v_mfma_f32_32x32x16_bf16 v[68:83], a[240:243], v[100:103], v[68:83]
v_mul_f32 v147, v143, v143
ds_read_b128 v[100:103], v4 offset:32768
v_fmaak_f32 v144, v13, v144, 0xc0135761
v_fmaak_f32 v145, v13, v145, 0xc0135761
v_fmaak_f32 v146, v13, v146, 0xc0135761
v_fmaak_f32 v147, v13, v147, 0xc0135761
v_mfma_f32_32x32x16_bf16 v[68:83], a[244:247], v[104:107], v[68:83]
ds_read_b128 v[104:107], v5 offset:32768
v_mul_f32 v144, v144, v140
s_add_u32 m0, s51, 11904
s_nop 0
buffer_load_dwordx4 v1, s[4:7], s48 offen offset:384 sc1 lds
s_waitcnt lgkmcnt(9)
v_mfma_f32_32x32x16_bf16 v[68:83], a[248:251], v[108:111], v[68:83]
v_mul_f32 v145, v145, v141
v_mul_f32 v146, v146, v142
v_mul_f32 v147, v147, v143
v_exp_f32 v144, v144
s_waitcnt lgkmcnt(8)
v_mfma_f32_32x32x16_bf16 v[68:83], a[252:255], v[112:115], v[68:83]
v_exp_f32 v145, v145
s_add_u32 m0, s51, 15872
s_nop 0
buffer_load_dwordx4 v1, s[4:7], s48 offen offset:512 sc1 lds
s_waitcnt lgkmcnt(7)
v_mfma_f32_32x32x16_bf16 v[68:83], v[188:191], v[116:119], v[68:83]
v_exp_f32 v146, v146
v_exp_f32 v147, v147
v_exp_f32 v162, v162
s_waitcnt lgkmcnt(6)
v_mfma_f32_32x32x16_bf16 v[68:83], v[192:195], v[120:123], v[68:83]
s_add_u32 m0, s51, 19840
s_nop 0
buffer_load_dwordx4 v1, s[4:7], s48 offen offset:640 sc1 lds
v_exp_f32 v163, v163
s_waitcnt lgkmcnt(5)
v_mfma_f32_32x32x16_bf16 v[68:83], v[196:199], v[124:127], v[68:83]
v_exp_f32 v168, v168
v_exp_f32 v169, v169
v_exp_f32 v170, v170
s_add_u32 m0, s51, 23808
s_nop 0
buffer_load_dwordx4 v1, s[4:7], s48 offen offset:768 sc1 lds
s_waitcnt lgkmcnt(4)
v_mfma_f32_32x32x16_bf16 v[68:83], v[200:203], v[128:131], v[68:83]
v_exp_f32 v171, v171
v_add_f32 v156, 1.0, v156
v_add_f32 v157, 1.0, v157
v_add_f32 v164, 1.0, v164
s_waitcnt lgkmcnt(3)
v_mfma_f32_32x32x16_bf16 v[68:83], v[204:207], v[132:135], v[68:83]
v_add_f32 v165, 1.0, v165
s_add_u32 m0, s51, 27776
s_nop 0
buffer_load_dwordx4 v1, s[4:7], s48 offen offset:896 sc1 lds
s_waitcnt lgkmcnt(2)
v_mfma_f32_32x32x16_bf16 v[68:83], v[208:211], v[136:139], v[68:83]
v_add_f32 v144, 1.0, v144
v_add_f32 v145, 1.0, v145
v_add_f32 v158, 1.0, v158
v_add_f32 v159, 1.0, v159
v_add_f32 v166, 1.0, v166
s_waitcnt lgkmcnt(1)
v_mfma_f32_32x32x16_bf16 v[68:83], v[212:215], v[100:103], v[68:83]
v_add_f32 v167, 1.0, v167
s_add_u32 m0, s51, 31744
s_nop 0
buffer_load_dwordx4 v1, s[4:7], s48 offen offset:1024 sc1 lds
v_rcp_f32 v156, v156
s_waitcnt lgkmcnt(0)
v_mfma_f32_32x32x16_bf16 v[68:83], v[216:219], v[104:107], v[68:83]
v_rcp_f32 v157, v157
v_rcp_f32 v164, v164
v_rcp_f32 v165, v165
v_add_f32 v146, 1.0, v146
v_add_f32 v147, 1.0, v147
v_add_f32 v160, 1.0, v160
v_add_f32 v161, 1.0, v161
v_add_f32 v162, 1.0, v162
v_add_f32 v163, 1.0, v163
v_add_f32 v168, 1.0, v168
v_add_f32 v169, 1.0, v169
v_add_f32 v170, 1.0, v170
v_add_f32 v171, 1.0, v171
v_rcp_f32 v144, v144
v_rcp_f32 v145, v145
v_rcp_f32 v158, v158
v_rcp_f32 v159, v159
v_rcp_f32 v166, v166
v_rcp_f32 v167, v167
v_rcp_f32 v146, v146
v_rcp_f32 v147, v147
v_rcp_f32 v160, v160
v_rcp_f32 v161, v161
v_rcp_f32 v162, v162
v_rcp_f32 v163, v163
v_rcp_f32 v168, v168
v_rcp_f32 v169, v169
v_rcp_f32 v170, v170
v_rcp_f32 v171, v171
v_mul_f32 v52, v52, v156
v_mul_f32 v53, v53, v157
v_mul_f32 v60, v60, v164
v_mul_f32 v61, v61, v165
v_mul_f32 v140, v140, v144
v_mul_f32 v141, v141, v145
v_mul_f32 v54, v54, v158
v_mul_f32 v55, v55, v159
v_mul_f32 v62, v62, v166
v_mul_f32 v63, v63, v167
v_mul_f32 v142, v142, v146
v_mul_f32 v143, v143, v147
v_cvt_pk_bf16_f32 v140, v140, v141
v_cvt_pk_bf16_f32 v141, v142, v143
v_cvt_pk_bf16_f32 v52, v52, v53
buffer_store_dwordx2 v[140:141], v7, s[4:7], s57 offen
v_cvt_pk_bf16_f32 v60, v60, v61
v_mul_f32 v56, v56, v160
v_mul_f32 v57, v57, v161
v_mul_f32 v58, v58, v162
v_mul_f32 v59, v59, v163
v_mul_f32 v64, v64, v168
v_cvt_pk_bf16_f32 v53, v54, v55
v_cvt_pk_bf16_f32 v54, v56, v57
v_cvt_pk_bf16_f32 v55, v58, v59
v_mul_f32 v65, v65, v169
buffer_store_dwordx4 v[52:55], v6, s[4:7], s57 offen offset:0
v_mul_f32 v66, v66, v170
v_mul_f32 v67, v67, v171
v_cvt_pk_bf16_f32 v61, v62, v63
v_cvt_pk_bf16_f32 v62, v64, v65
v_cvt_pk_bf16_f32 v63, v66, v67
v_xor_b32 v2, 0x10000, v2
v_xor_b32 v3, 0x10000, v3
v_xor_b32 v4, 0x10000, v4
v_xor_b32 v5, 0x10000, v5
buffer_store_dwordx4 v[60:63], v6, s[4:7], s57 offen offset:1024
s_add_u32 s57, s57, s61
s_mov_b32 s65, s38
s_add_u32 s38, s38, 1
L_f1_loop:
s_cmp_gt_u32 s38, 64
s_cbranch_scc1 L_f1_drain
v_cmp_gt_u32 vcc, s38, v11
s_nop 0
s_cbranch_vccnz L_f1_drain
s_waitcnt vmcnt(3)
s_barrier
v_mul_f32 v172, v68, v68
v_mul_f32 v173, v69, v69
v_mul_f32 v180, v76, v76
v_mul_f32 v181, v77, v77
v_mul_f32 v174, v70, v70
v_mul_f32 v175, v71, v71
ds_read_b128 v[100:103], v2 offset:0
v_mul_f32 v182, v78, v78
v_mul_f32 v183, v79, v79
v_fmaak_f32 v172, v13, v172, 0xc0135761
ds_read_b128 v[104:107], v3 offset:0
v_fmaak_f32 v173, v13, v173, 0xc0135761
v_fmaak_f32 v180, v13, v180, 0xc0135761
v_fmaak_f32 v181, v13, v181, 0xc0135761
ds_read_b128 v[108:111], v4 offset:0
v_mul_f32 v176, v72, v72
v_mul_f32 v177, v73, v73
v_mul_f32 v178, v74, v74
ds_read_b128 v[112:115], v5 offset:0
v_mul_f32 v179, v75, v75
v_mul_f32 v184, v80, v80
v_mul_f32 v185, v81, v81
ds_read_b128 v[116:119], v2 offset:4096
v_mul_f32 v186, v82, v82
v_mul_f32 v187, v83, v83
v_fmaak_f32 v174, v13, v174, 0xc0135761
ds_read_b128 v[120:123], v3 offset:4096
v_fmaak_f32 v175, v13, v175, 0xc0135761
v_fmaak_f32 v182, v13, v182, 0xc0135761
v_fmaak_f32 v183, v13, v183, 0xc0135761
ds_read_b128 v[124:127], v4 offset:4096
v_mul_f32 v172, v172, v68
v_mul_f32 v173, v173, v69
v_mul_f32 v180, v180, v76
ds_read_b128 v[128:131], v5 offset:4096
v_mul_f32 v181, v181, v77
v_fmaak_f32 v176, v13, v176, 0xc0135761
v_fmaak_f32 v177, v13, v177, 0xc0135761
ds_read_b128 v[132:135], v2 offset:8192
v_fmaak_f32 v178, v13, v178, 0xc0135761
v_fmaak_f32 v179, v13, v179, 0xc0135761
v_fmaak_f32 v184, v13, v184, 0xc0135761
ds_read_b128 v[136:139], v3 offset:8192
v_fmaak_f32 v185, v13, v185, 0xc0135761
s_waitcnt lgkmcnt(9)
v_mfma_f32_32x32x16_bf16 v[84:99], v[220:223], v[100:103], 0
v_fmaak_f32 v186, v13, v186, 0xc0135761
v_fmaak_f32 v187, v13, v187, 0xc0135761
v_mul_f32 v174, v174, v70
v_mul_f32 v175, v175, v71
v_mul_f32 v182, v182, v78
v_mfma_f32_32x32x16_bf16 v[52:67], a[0:3], v[100:103], v[20:35]
ds_read_b128 v[100:103], v4 offset:8192
v_mul_f32 v183, v183, v79
v_exp_f32 v172, v172
v_exp_f32 v173, v173
s_waitcnt lgkmcnt(9)
v_mfma_f32_32x32x16_bf16 v[52:67], a[4:7], v[104:107], v[52:67]
ds_read_b128 v[104:107], v5 offset:8192
v_exp_f32 v180, v180
v_exp_f32 v181, v181
s_waitcnt lgkmcnt(9)
v_mfma_f32_32x32x16_bf16 v[52:67], a[8:11], v[108:111], v[52:67]
ds_read_b128 v[108:111], v2 offset:12288
v_mul_f32 v176, v176, v72
v_mul_f32 v177, v177, v73
v_mul_f32 v178, v178, v74
v_mul_f32 v179, v179, v75
s_waitcnt lgkmcnt(9)
v_mfma_f32_32x32x16_bf16 v[52:67], a[12:15], v[112:115], v[52:67]
ds_read_b128 v[112:115], v3 offset:12288
v_mul_f32 v184, v184, v80
v_mul_f32 v185, v185, v81
v_mul_f32 v186, v186, v82
v_mul_f32 v187, v187, v83
s_waitcnt lgkmcnt(9)
v_mfma_f32_32x32x16_bf16 v[84:99], v[224:227], v[116:119], v[84:99]
v_exp_f32 v174, v174
v_exp_f32 v175, v175
v_exp_f32 v182, v182
v_mfma_f32_32x32x16_bf16 v[52:67], a[16:19], v[116:119], v[52:67]
ds_read_b128 v[116:119], v4 offset:12288
v_exp_f32 v183, v183
v_exp_f32 v176, v176
v_exp_f32 v177, v177
s_waitcnt lgkmcnt(9)
v_mfma_f32_32x32x16_bf16 v[52:67], a[20:23], v[120:123], v[52:67]
ds_read_b128 v[120:123], v5 offset:12288
v_exp_f32 v178, v178
v_exp_f32 v179, v179
s_waitcnt lgkmcnt(9)
v_mfma_f32_32x32x16_bf16 v[52:67], a[24:27], v[124:127], v[52:67]
ds_read_b128 v[124:127], v2 offset:16384
v_exp_f32 v184, v184
v_exp_f32 v185, v185
s_waitcnt lgkmcnt(9)
v_mfma_f32_32x32x16_bf16 v[52:67], a[28:31], v[128:131], v[52:67]
ds_read_b128 v[128:131], v3 offset:16384
v_exp_f32 v186, v186
v_exp_f32 v187, v187
s_waitcnt lgkmcnt(9)
v_mfma_f32_32x32x16_bf16 v[84:99], v[228:231], v[132:135], v[84:99]
v_add_f32 v172, 1.0, v172
v_add_f32 v173, 1.0, v173
v_add_f32 v180, 1.0, v180
v_add_f32 v181, 1.0, v181
v_add_f32 v174, 1.0, v174
v_mfma_f32_32x32x16_bf16 v[52:67], a[32:35], v[132:135], v[52:67]
ds_read_b128 v[132:135], v4 offset:16384
v_add_f32 v175, 1.0, v175
v_add_f32 v182, 1.0, v182
v_add_f32 v183, 1.0, v183
v_rcp_f32 v172, v172
s_waitcnt lgkmcnt(9)
v_mfma_f32_32x32x16_bf16 v[52:67], a[36:39], v[136:139], v[52:67]
ds_read_b128 v[136:139], v5 offset:16384
v_rcp_f32 v173, v173
v_rcp_f32 v180, v180
s_waitcnt lgkmcnt(9)
v_mfma_f32_32x32x16_bf16 v[52:67], a[40:43], v[100:103], v[52:67]
ds_read_b128 v[100:103], v2 offset:20480
v_rcp_f32 v181, v181
v_add_f32 v176, 1.0, v176
v_add_f32 v177, 1.0, v177
s_waitcnt lgkmcnt(9)
v_mfma_f32_32x32x16_bf16 v[52:67], a[44:47], v[104:107], v[52:67]
ds_read_b128 v[104:107], v3 offset:20480
v_add_f32 v178, 1.0, v178
v_add_f32 v179, 1.0, v179
v_add_f32 v184, 1.0, v184
v_add_f32 v185, 1.0, v185
s_waitcnt lgkmcnt(9)
v_mfma_f32_32x32x16_bf16 v[84:99], v[232:235], v[108:111], v[84:99]
v_add_f32 v186, 1.0, v186
v_add_f32 v187, 1.0, v187
v_rcp_f32 v174, v174
v_rcp_f32 v175, v175
v_mfma_f32_32x32x16_bf16 v[52:67], a[48:51], v[108:111], v[52:67]
ds_read_b128 v[108:111], v4 offset:20480
v_rcp_f32 v182, v182
v_rcp_f32 v183, v183
v_rcp_f32 v176, v176
s_waitcnt lgkmcnt(9)
v_mfma_f32_32x32x16_bf16 v[52:67], a[52:55], v[112:115], v[52:67]
ds_read_b128 v[112:115], v5 offset:20480
v_rcp_f32 v177, v177
v_rcp_f32 v178, v178
s_waitcnt lgkmcnt(9)
v_mfma_f32_32x32x16_bf16 v[52:67], a[56:59], v[116:119], v[52:67]
ds_read_b128 v[116:119], v2 offset:24576
v_rcp_f32 v179, v179
v_rcp_f32 v184, v184
s_waitcnt lgkmcnt(9)
v_mfma_f32_32x32x16_bf16 v[52:67], a[60:63], v[120:123], v[52:67]
ds_read_b128 v[120:123], v3 offset:24576
v_rcp_f32 v185, v185
v_rcp_f32 v186, v186
s_waitcnt lgkmcnt(9)
v_mfma_f32_32x32x16_bf16 v[84:99], v[236:239], v[124:127], v[84:99]
v_rcp_f32 v187, v187
v_mul_f32 v68, v68, v172
v_mul_f32 v69, v69, v173
v_mul_f32 v76, v76, v180
v_mfma_f32_32x32x16_bf16 v[52:67], a[64:67], v[124:127], v[52:67]
ds_read_b128 v[124:127], v4 offset:24576
v_mul_f32 v77, v77, v181
v_mul_f32 v70, v70, v174
v_mul_f32 v71, v71, v175
v_mul_f32 v78, v78, v182
v_mul_f32 v79, v79, v183
s_waitcnt lgkmcnt(9)
v_mfma_f32_32x32x16_bf16 v[52:67], a[68:71], v[128:131], v[52:67]
ds_read_b128 v[128:131], v5 offset:24576
v_cvt_pk_bf16_f32 v68, v68, v69
v_cvt_pk_bf16_f32 v76, v76, v77
v_mul_f32 v72, v72, v176
v_mul_f32 v73, v73, v177
s_waitcnt lgkmcnt(9)
v_mfma_f32_32x32x16_bf16 v[52:67], a[72:75], v[132:135], v[52:67]
ds_read_b128 v[132:135], v2 offset:28672
v_mul_f32 v74, v74, v178
v_mul_f32 v75, v75, v179
v_cvt_pk_bf16_f32 v69, v70, v71
v_cvt_pk_bf16_f32 v70, v72, v73
s_waitcnt lgkmcnt(9)
v_mfma_f32_32x32x16_bf16 v[52:67], a[76:79], v[136:139], v[52:67]
ds_read_b128 v[136:139], v3 offset:28672
v_cvt_pk_bf16_f32 v71, v74, v75
v_mul_f32 v80, v80, v184
buffer_store_dwordx4 v[68:71], v6, s[4:7], s58 offen offset:0
s_waitcnt lgkmcnt(9)
v_mfma_f32_32x32x16_bf16 v[84:99], v[240:243], v[100:103], v[84:99]
v_mul_f32 v81, v81, v185
v_mul_f32 v82, v82, v186
v_mul_f32 v83, v83, v187
v_cvt_pk_bf16_f32 v77, v78, v79
v_cvt_pk_bf16_f32 v78, v80, v81
v_mfma_f32_32x32x16_bf16 v[52:67], a[80:83], v[100:103], v[52:67]
ds_read_b128 v[100:103], v4 offset:28672
v_cvt_pk_bf16_f32 v79, v82, v83
v_mov_b32 v12, s65
buffer_store_dwordx4 v[76:79], v6, s[4:7], s58 offen offset:1024
s_add_u32 s48, s48, 36864
s_waitcnt lgkmcnt(9)
v_mfma_f32_32x32x16_bf16 v[52:67], a[84:87], v[104:107], v[52:67]
ds_read_b128 v[104:107], v5 offset:28672
s_xor_b32 s51, s51, 0x10000
s_sub_i32 s60, s38, 4
s_and_b32 s61, s65, 3
s_cselect_b32 s61, 1, -3
s_mul_i32 s61, s61, 18432
s_waitcnt lgkmcnt(9)
v_mfma_f32_32x32x16_bf16 v[52:67], a[88:91], v[108:111], v[52:67]
ds_read_b128 v[108:111], v2 offset:32768
s_max_i32 s60, s60, 0
s_add_u32 s58, s58, s61
s_and_b32 s61, s38, 3
s_cselect_b32 s61, 1, -3
s_mul_i32 s61, s61, 18432
s_waitcnt lgkmcnt(9)
v_mfma_f32_32x32x16_bf16 v[52:67], a[92:95], v[112:115], v[52:67]
ds_read_b128 v[112:115], v3 offset:32768
s_waitcnt lgkmcnt(9)
v_mfma_f32_32x32x16_bf16 v[84:99], v[244:247], v[116:119], v[84:99]
v_mfma_f32_32x32x16_bf16 v[52:67], a[96:99], v[116:119], v[52:67]
ds_read_b128 v[116:119], v4 offset:32768
s_waitcnt lgkmcnt(9)
v_mfma_f32_32x32x16_bf16 v[52:67], a[100:103], v[120:123], v[52:67]
ds_read_b128 v[120:123], v5 offset:32768
s_waitcnt lgkmcnt(9)
v_mfma_f32_32x32x16_bf16 v[52:67], a[104:107], v[124:127], v[52:67]
ds_read_b128 v[124:127], v2 offset:0
s_waitcnt lgkmcnt(9)
v_mfma_f32_32x32x16_bf16 v[52:67], a[108:111], v[128:131], v[52:67]
ds_read_b128 v[128:131], v3 offset:0
s_waitcnt lgkmcnt(9)
v_mfma_f32_32x32x16_bf16 v[84:99], v[248:251], v[132:135], v[84:99]
v_mfma_f32_32x32x16_bf16 v[52:67], a[112:115], v[132:135], v[52:67]
ds_read_b128 v[132:135], v4 offset:0
s_waitcnt lgkmcnt(9)
v_mfma_f32_32x32x16_bf16 v[52:67], a[116:119], v[136:139], v[52:67]
ds_read_b128 v[136:139], v5 offset:0
s_waitcnt lgkmcnt(9)
v_mfma_f32_32x32x16_bf16 v[52:67], a[120:123], v[100:103], v[52:67]
ds_read_b128 v[100:103], v2 offset:4096
s_waitcnt lgkmcnt(9)
v_mfma_f32_32x32x16_bf16 v[52:67], a[124:127], v[104:107], v[52:67]
ds_read_b128 v[104:107], v3 offset:4096
s_waitcnt vmcnt(0)
s_cmp_eq_u32 s36, 0
s_cbranch_scc1 L_slow19
L_ret19:
buffer_store_dword v12, v14, s[4:7], s56 offen
s_waitcnt lgkmcnt(9)
v_mfma_f32_32x32x16_bf16 v[84:99], v[252:255], v[108:111], v[84:99]
buffer_load_dword v12, v0, s[4:7], s59 offen sc1
v_mfma_f32_32x32x16_bf16 v[52:67], a[128:131], v[108:111], v[52:67]
ds_read_b128 v[108:111], v4 offset:4096
s_nop 2
ds_write_b128 v8, v[84:87] offset:36864
s_waitcnt lgkmcnt(10)
v_mfma_f32_32x32x16_bf16 v[52:67], a[132:135], v[112:115], v[52:67]
s_waitcnt lgkmcnt(9)
v_mfma_f32_32x32x16_bf16 v[52:67], a[136:139], v[116:119], v[52:67]
ds_read_b128 v[112:115], v5 offset:4096
ds_read_b128 v[116:119], v2 offset:8192
s_waitcnt lgkmcnt(10)
v_mfma_f32_32x32x16_bf16 v[52:67], a[140:143], v[120:123], v[52:67]
ds_read_b128 v[120:123], v3 offset:8192
ds_write_b128 v8, v[88:91] offset:37888
s_waitcnt lgkmcnt(11)
v_mfma_f32_32x32x16_bf16 v[68:83], a[144:147], v[124:127], v[36:51]
s_nop 3
v_mul_f32 v156, v52, v52
v_mul_f32 v157, v53, v53
v_mul_f32 v164, v60, v60
v_mul_f32 v165, v61, v61
s_waitcnt lgkmcnt(10)
v_mfma_f32_32x32x16_bf16 v[68:83], a[148:151], v[128:131], v[68:83]
ds_read_b128 v[124:127], v4 offset:8192
v_mul_f32 v158, v54, v54
v_mul_f32 v159, v55, v55
v_mul_f32 v166, v62, v62
ds_read_b128 v[128:131], v5 offset:8192
s_waitcnt lgkmcnt(11)
v_mfma_f32_32x32x16_bf16 v[68:83], a[152:155], v[132:135], v[68:83]
ds_read_b128 v[132:135], v2 offset:12288
v_mul_f32 v167, v63, v63
v_fmaak_f32 v156, v13, v156, 0xc0135761
v_fmaak_f32 v157, v13, v157, 0xc0135761
ds_write_b128 v8, v[92:95] offset:38912
s_waitcnt lgkmcnt(12)
v_mfma_f32_32x32x16_bf16 v[68:83], a[156:159], v[136:139], v[68:83]
v_fmaak_f32 v164, v13, v164, 0xc0135761
v_fmaak_f32 v165, v13, v165, 0xc0135761
v_mul_f32 v160, v56, v56
v_mul_f32 v161, v57, v57
v_mul_f32 v162, v58, v58
s_waitcnt lgkmcnt(11)
v_mfma_f32_32x32x16_bf16 v[68:83], a[160:163], v[100:103], v[68:83]
ds_read_b128 v[136:139], v3 offset:12288
v_mul_f32 v163, v59, v59
v_mul_f32 v168, v64, v64
v_mul_f32 v169, v65, v65
ds_read_b128 v[100:103], v4 offset:12288
s_waitcnt lgkmcnt(12)
v_mfma_f32_32x32x16_bf16 v[68:83], a[164:167], v[104:107], v[68:83]
ds_write_b128 v8, v[96:99] offset:39936
v_mul_f32 v170, v66, v66
v_mul_f32 v171, v67, v67
v_fmaak_f32 v158, v13, v158, 0xc0135761
s_waitcnt lgkmcnt(12)
v_mfma_f32_32x32x16_bf16 v[68:83], a[168:171], v[108:111], v[68:83]
v_fmaak_f32 v159, v13, v159, 0xc0135761
v_fmaak_f32 v166, v13, v166, 0xc0135761
v_fmaak_f32 v167, v13, v167, 0xc0135761
v_mul_f32 v156, v156, v52
v_mul_f32 v157, v157, v53
s_waitcnt lgkmcnt(10)
v_mfma_f32_32x32x16_bf16 v[68:83], a[172:175], v[112:115], v[68:83]
ds_read_b128 v[104:107], v5 offset:12288
v_mul_f32 v164, v164, v60
v_mul_f32 v165, v165, v61
buffer_load_dword v11, v15, s[4:7], s53 offen sc1
s_waitcnt lgkmcnt(10)
v_mfma_f32_32x32x16_bf16 v[68:83], a[176:179], v[116:119], v[68:83]
ds_read_b128 v[108:111], v2 offset:16384
v_fmaak_f32 v160, v13, v160, 0xc0135761
v_fmaak_f32 v161, v13, v161, 0xc0135761
v_fmaak_f32 v162, v13, v162, 0xc0135761
ds_read_b128 v[112:115], v3 offset:16384
s_waitcnt lgkmcnt(11)
v_mfma_f32_32x32x16_bf16 v[68:83], a[180:183], v[120:123], v[68:83]
ds_read_b128 v[116:119], v4 offset:16384
v_fmaak_f32 v163, v13, v163, 0xc0135761
v_fmaak_f32 v168, v13, v168, 0xc0135761
v_fmaak_f32 v169, v13, v169, 0xc0135761
ds_read_b128 v[120:123], v5 offset:16384
s_waitcnt lgkmcnt(11)
v_mfma_f32_32x32x16_bf16 v[68:83], a[184:187], v[124:127], v[68:83]
ds_read_b128 v[124:127], v2 offset:20480
s_waitcnt lgkmcnt(6)
s_barrier
v_fmaak_f32 v170, v13, v170, 0xc0135761
v_mfma_f32_32x32x16_bf16 v[68:83], a[188:191], v[128:131], v[68:83]
ds_read_b128 v[128:131], v3 offset:20480
v_fmaak_f32 v171, v13, v171, 0xc0135761
v_mul_f32 v158, v158, v54
v_mul_f32 v159, v159, v55
ds_read_b128 v[140:143], v9 offset:36864
v_mul_f32 v166, v166, v62
v_mfma_f32_32x32x16_bf16 v[68:83], a[192:195], v[132:135], v[68:83]
ds_read_b128 v[132:135], v4 offset:20480
v_mul_f32 v167, v167, v63
v_exp_f32 v156, v156
ds_read_b128 v[144:147], v9 offset:40960
v_exp_f32 v157, v157
v_mfma_f32_32x32x16_bf16 v[68:83], a[196:199], v[136:139], v[68:83]
v_exp_f32 v164, v164
ds_read_b128 v[136:139], v5 offset:20480
v_exp_f32 v165, v165
v_mul_f32 v160, v160, v56
v_mfma_f32_32x32x16_bf16 v[68:83], a[200:203], v[100:103], v[68:83]
ds_read_b128 v[100:103], v2 offset:24576
v_mul_f32 v161, v161, v57
v_mul_f32 v162, v162, v58
v_mul_f32 v163, v163, v59
ds_read_b128 v[148:151], v9 offset:45056
v_mul_f32 v168, v168, v64
s_waitcnt lgkmcnt(12)
v_mfma_f32_32x32x16_bf16 v[68:83], a[204:207], v[104:107], v[68:83]
ds_read_b128 v[104:107], v3 offset:24576
v_mul_f32 v169, v169, v65
v_mul_f32 v170, v170, v66
v_mul_f32 v171, v171, v67
ds_read_b128 v[152:155], v9 offset:49152
s_waitcnt lgkmcnt(13)
v_mfma_f32_32x32x16_bf16 v[68:83], a[208:211], v[108:111], v[68:83]
v_exp_f32 v158, v158
ds_read_b128 v[108:111], v4 offset:24576
v_exp_f32 v159, v159
s_waitcnt lgkmcnt(13)
v_mfma_f32_32x32x16_bf16 v[68:83], a[212:215], v[112:115], v[68:83]
v_exp_f32 v166, v166
ds_read_b128 v[112:115], v5 offset:24576
s_waitcnt lgkmcnt(7)
v_add_f32 v140, v140, v144
v_mfma_f32_32x32x16_bf16 v[68:83], a[216:219], v[116:119], v[68:83]
v_add_f32 v141, v141, v145
v_add_f32 v142, v142, v146
ds_read_b128 v[116:119], v2 offset:28672
v_add_f32 v143, v143, v147
v_add_f32 v140, v140, v16
v_add_f32 v141, v141, v17
v_mfma_f32_32x32x16_bf16 v[68:83], a[220:223], v[120:123], v[68:83]
v_add_f32 v142, v142, v18
v_add_f32 v143, v143, v19
ds_read_b128 v[120:123], v3 offset:28672
v_exp_f32 v167, v167
v_exp_f32 v160, v160
s_waitcnt vmcnt(0)
s_add_u32 m0, s51, 0
s_nop 0
buffer_load_dwordx4 v1, s[4:7], s48 offen offset:0 sc1 lds
v_mfma_f32_32x32x16_bf16 v[68:83], a[224:227], v[124:127], v[68:83]
ds_read_b128 v[124:127], v4 offset:28672
s_waitcnt lgkmcnt(5)
v_add_f32 v148, v148, v152
v_add_f32 v149, v149, v153
v_add_f32 v150, v150, v154
v_add_f32 v151, v151, v155
v_mfma_f32_32x32x16_bf16 v[68:83], a[228:231], v[128:131], v[68:83]
ds_read_b128 v[128:131], v5 offset:28672
s_add_u32 m0, s51, 3968
s_nop 0
buffer_load_dwordx4 v1, s[4:7], s48 offen offset:128 sc1 lds
v_add_f32 v140, v140, v148
v_mfma_f32_32x32x16_bf16 v[68:83], a[232:235], v[132:135], v[68:83]
ds_read_b128 v[132:135], v2 offset:32768
v_add_f32 v141, v141, v149
v_add_f32 v142, v142, v150
v_add_f32 v143, v143, v151
v_mul_f32 v144, v140, v140
v_mul_f32 v145, v141, v141
v_mfma_f32_32x32x16_bf16 v[68:83], a[236:239], v[136:139], v[68:83]
ds_read_b128 v[136:139], v3 offset:32768
s_add_u32 m0, s51, 7936
s_nop 0
buffer_load_dwordx4 v1, s[4:7], s48 offen offset:256 sc1 lds
v_mul_f32 v146, v142, v142
v_mfma_f32_32x32x16_bf16 v[68:83], a[240:243], v[100:103], v[68:83]
ds_read_b128 v[100:103], v4 offset:32768
v_mul_f32 v147, v143, v143
v_fmaak_f32 v144, v13, v144, 0xc0135761
v_fmaak_f32 v145, v13, v145, 0xc0135761
v_fmaak_f32 v146, v13, v146, 0xc0135761
v_fmaak_f32 v147, v13, v147, 0xc0135761
v_mfma_f32_32x32x16_bf16 v[68:83], a[244:247], v[104:107], v[68:83]
ds_read_b128 v[104:107], v5 offset:32768
s_add_u32 m0, s51, 11904
s_nop 0
buffer_load_dwordx4 v1, s[4:7], s48 offen offset:384 sc1 lds
v_mul_f32 v144, v144, v140
s_waitcnt lgkmcnt(9)
v_mfma_f32_32x32x16_bf16 v[68:83], a[248:251], v[108:111], v[68:83]
v_mul_f32 v145, v145, v141
v_mul_f32 v146, v146, v142
v_mul_f32 v147, v147, v143
v_exp_f32 v144, v144
s_waitcnt lgkmcnt(8)
v_mfma_f32_32x32x16_bf16 v[68:83], a[252:255], v[112:115], v[68:83]
s_add_u32 m0, s51, 15872
s_nop 0
buffer_load_dwordx4 v1, s[4:7], s48 offen offset:512 sc1 lds
v_exp_f32 v145, v145
s_waitcnt lgkmcnt(7)
v_mfma_f32_32x32x16_bf16 v[68:83], v[188:191], v[116:119], v[68:83]
v_exp_f32 v146, v146
v_exp_f32 v147, v147
v_exp_f32 v161, v161
s_waitcnt lgkmcnt(6)
v_mfma_f32_32x32x16_bf16 v[68:83], v[192:195], v[120:123], v[68:83]
s_add_u32 m0, s51, 19840
s_nop 0
buffer_load_dwordx4 v1, s[4:7], s48 offen offset:640 sc1 lds
v_exp_f32 v162, v162
s_waitcnt lgkmcnt(5)
v_mfma_f32_32x32x16_bf16 v[68:83], v[196:199], v[124:127], v[68:83]
v_exp_f32 v163, v163
v_exp_f32 v168, v168
v_exp_f32 v169, v169
s_add_u32 m0, s51, 23808
s_nop 0
buffer_load_dwordx4 v1, s[4:7], s48 offen offset:768 sc1 lds
s_waitcnt lgkmcnt(4)
v_mfma_f32_32x32x16_bf16 v[68:83], v[200:203], v[128:131], v[68:83]
v_exp_f32 v170, v170
v_exp_f32 v171, v171
v_add_f32 v156, 1.0, v156
s_waitcnt lgkmcnt(3)
v_mfma_f32_32x32x16_bf16 v[68:83], v[204:207], v[132:135], v[68:83]
s_add_u32 m0, s51, 27776
s_nop 0
buffer_load_dwordx4 v1, s[4:7], s48 offen offset:896 sc1 lds
v_add_f32 v157, 1.0, v157
s_waitcnt lgkmcnt(2)
v_mfma_f32_32x32x16_bf16 v[68:83], v[208:211], v[136:139], v[68:83]
v_add_f32 v164, 1.0, v164
v_add_f32 v165, 1.0, v165
v_add_f32 v144, 1.0, v144
v_add_f32 v145, 1.0, v145
v_add_f32 v158, 1.0, v158
s_waitcnt lgkmcnt(1)
v_mfma_f32_32x32x16_bf16 v[68:83], v[212:215], v[100:103], v[68:83]
s_add_u32 m0, s51, 31744
s_nop 0
buffer_load_dwordx4 v1, s[4:7], s48 offen offset:1024 sc1 lds
v_add_f32 v159, 1.0, v159
s_waitcnt lgkmcnt(0)
v_mfma_f32_32x32x16_bf16 v[68:83], v[216:219], v[104:107], v[68:83]
v_add_f32 v166, 1.0, v166
v_add_f32 v167, 1.0, v167
v_rcp_f32 v156, v156
v_rcp_f32 v157, v157
v_rcp_f32 v164, v164
v_rcp_f32 v165, v165
v_add_f32 v146, 1.0, v146
v_add_f32 v147, 1.0, v147
v_add_f32 v160, 1.0, v160
v_add_f32 v161, 1.0, v161
v_add_f32 v162, 1.0, v162
v_add_f32 v163, 1.0, v163
v_add_f32 v168, 1.0, v168
v_add_f32 v169, 1.0, v169
v_add_f32 v170, 1.0, v170
v_add_f32 v171, 1.0, v171
v_rcp_f32 v144, v144
v_rcp_f32 v145, v145
v_rcp_f32 v158, v158
v_rcp_f32 v159, v159
v_rcp_f32 v166, v166
v_rcp_f32 v167, v167
v_rcp_f32 v146, v146
v_rcp_f32 v147, v147
v_rcp_f32 v160, v160
v_rcp_f32 v161, v161
v_rcp_f32 v162, v162
v_rcp_f32 v163, v163
v_rcp_f32 v168, v168
v_rcp_f32 v169, v169
v_rcp_f32 v170, v170
v_rcp_f32 v171, v171
v_mul_f32 v52, v52, v156
v_mul_f32 v53, v53, v157
v_mul_f32 v60, v60, v164
v_mul_f32 v61, v61, v165
v_mul_f32 v140, v140, v144
v_mul_f32 v141, v141, v145
v_mul_f32 v54, v54, v158
v_mul_f32 v55, v55, v159
v_mul_f32 v62, v62, v166
v_mul_f32 v63, v63, v167
v_mul_f32 v142, v142, v146
v_mul_f32 v143, v143, v147
v_cvt_pk_bf16_f32 v140, v140, v141
v_cvt_pk_bf16_f32 v141, v142, v143
v_cmp_gt_u32 vcc, s60, v12
s_nop 0
s_cbranch_vccnz L_slow20
L_ret20:
buffer_store_dwordx2 v[140:141], v7, s[4:7], s57 offen
v_cvt_pk_bf16_f32 v52, v52, v53
v_cvt_pk_bf16_f32 v60, v60, v61
v_mul_f32 v56, v56, v160
v_mul_f32 v57, v57, v161
v_mul_f32 v58, v58, v162
v_mul_f32 v59, v59, v163
v_mul_f32 v64, v64, v168
v_cvt_pk_bf16_f32 v53, v54, v55
v_cvt_pk_bf16_f32 v54, v56, v57
v_cvt_pk_bf16_f32 v55, v58, v59
v_mul_f32 v65, v65, v169
buffer_store_dwordx4 v[52:55], v6, s[4:7], s57 offen offset:0
v_mul_f32 v66, v66, v170
v_mul_f32 v67, v67, v171
v_cvt_pk_bf16_f32 v61, v62, v63
v_cvt_pk_bf16_f32 v62, v64, v65
v_cvt_pk_bf16_f32 v63, v66, v67
v_xor_b32 v2, 0x10000, v2
v_xor_b32 v3, 0x10000, v3
v_xor_b32 v4, 0x10000, v4
v_xor_b32 v5, 0x10000, v5
buffer_store_dwordx4 v[60:63], v6, s[4:7], s57 offen offset:1024
s_add_u32 s57, s57, s61
s_mov_b32 s65, s38
s_add_u32 s38, s38, 1
s_branch L_f1_loop
L_f1_drain:
v_mul_f32 v172, v68, v68
v_mul_f32 v173, v69, v69
v_mul_f32 v180, v76, v76
v_mul_f32 v181, v77, v77
v_mul_f32 v174, v70, v70
v_mul_f32 v175, v71, v71
v_mul_f32 v182, v78, v78
v_mul_f32 v183, v79, v79
v_fmaak_f32 v172, v13, v172, 0xc0135761
v_fmaak_f32 v173, v13, v173, 0xc0135761
v_fmaak_f32 v180, v13, v180, 0xc0135761
v_fmaak_f32 v181, v13, v181, 0xc0135761
v_mul_f32 v176, v72, v72
v_mul_f32 v177, v73, v73
v_mul_f32 v178, v74, v74
v_mul_f32 v179, v75, v75
v_mul_f32 v184, v80, v80
v_mul_f32 v185, v81, v81
v_mul_f32 v186, v82, v82
v_mul_f32 v187, v83, v83
v_fmaak_f32 v174, v13, v174, 0xc0135761
v_fmaak_f32 v175, v13, v175, 0xc0135761
v_fmaak_f32 v182, v13, v182, 0xc0135761
v_fmaak_f32 v183, v13, v183, 0xc0135761
v_mul_f32 v172, v172, v68
v_mul_f32 v173, v173, v69
v_mul_f32 v180, v180, v76
v_mul_f32 v181, v181, v77
v_fmaak_f32 v176, v13, v176, 0xc0135761
v_fmaak_f32 v177, v13, v177, 0xc0135761
v_fmaak_f32 v178, v13, v178, 0xc0135761
v_fmaak_f32 v179, v13, v179, 0xc0135761
v_fmaak_f32 v184, v13, v184, 0xc0135761
v_fmaak_f32 v185, v13, v185, 0xc0135761
v_fmaak_f32 v186, v13, v186, 0xc0135761
v_fmaak_f32 v187, v13, v187, 0xc0135761
v_mul_f32 v174, v174, v70
v_mul_f32 v175, v175, v71
v_mul_f32 v182, v182, v78
v_mul_f32 v183, v183, v79
v_exp_f32 v172, v172
v_exp_f32 v173, v173
v_exp_f32 v180, v180
v_exp_f32 v181, v181
v_mul_f32 v176, v176, v72
v_mul_f32 v177, v177, v73
v_mul_f32 v178, v178, v74
v_mul_f32 v179, v179, v75
v_mul_f32 v184, v184, v80
v_mul_f32 v185, v185, v81
v_mul_f32 v186, v186, v82
v_mul_f32 v187, v187, v83
v_exp_f32 v174, v174
v_exp_f32 v175, v175
v_exp_f32 v182, v182
v_exp_f32 v183, v183
v_exp_f32 v176, v176
v_exp_f32 v177, v177
v_exp_f32 v178, v178
v_exp_f32 v179, v179
v_exp_f32 v184, v184
v_exp_f32 v185, v185
v_exp_f32 v186, v186
v_exp_f32 v187, v187
v_add_f32 v172, 1.0, v172
v_add_f32 v173, 1.0, v173
v_add_f32 v180, 1.0, v180
v_add_f32 v181, 1.0, v181
v_add_f32 v174, 1.0, v174
v_add_f32 v175, 1.0, v175
v_add_f32 v182, 1.0, v182
v_add_f32 v183, 1.0, v183
v_rcp_f32 v172, v172
v_rcp_f32 v173, v173
v_rcp_f32 v180, v180
v_rcp_f32 v181, v181
v_add_f32 v176, 1.0, v176
v_add_f32 v177, 1.0, v177
v_add_f32 v178, 1.0, v178
v_add_f32 v179, 1.0, v179
v_add_f32 v184, 1.0, v184
v_add_f32 v185, 1.0, v185
v_add_f32 v186, 1.0, v186
v_add_f32 v187, 1.0, v187
v_rcp_f32 v174, v174
v_rcp_f32 v175, v175
v_rcp_f32 v182, v182
v_rcp_f32 v183, v183
v_rcp_f32 v176, v176
v_rcp_f32 v177, v177
v_rcp_f32 v178, v178
v_rcp_f32 v179, v179
v_rcp_f32 v184, v184
v_rcp_f32 v185, v185
v_rcp_f32 v186, v186
v_rcp_f32 v187, v187
v_mul_f32 v68, v68, v172
v_mul_f32 v69, v69, v173
v_mul_f32 v76, v76, v180
v_mul_f32 v77, v77, v181
v_mul_f32 v70, v70, v174
v_mul_f32 v71, v71, v175
v_cvt_pk_bf16_f32 v68, v68, v69
v_mul_f32 v72, v72, v176
v_mul_f32 v73, v73, v177
v_mul_f32 v74, v74, v178
v_mul_f32 v75, v75, v179
v_cvt_pk_bf16_f32 v69, v70, v71
v_cvt_pk_bf16_f32 v70, v72, v73
v_cvt_pk_bf16_f32 v71, v74, v75
v_mul_f32 v78, v78, v182
buffer_store_dwordx4 v[68:71], v6, s[4:7], s58 offen offset:0
v_mul_f32 v79, v79, v183
v_cvt_pk_bf16_f32 v76, v76, v77
v_mul_f32 v80, v80, v184
v_mul_f32 v81, v81, v185
v_mul_f32 v82, v82, v186
v_mul_f32 v83, v83, v187
v_cvt_pk_bf16_f32 v77, v78, v79
v_cvt_pk_bf16_f32 v78, v80, v81
v_cvt_pk_bf16_f32 v79, v82, v83
v_mov_b32 v12, s65
buffer_store_dwordx4 v[76:79], v6, s[4:7], s58 offen offset:1024
s_and_b32 s61, s65, 3
s_cselect_b32 s61, 1, -3
s_mul_i32 s61, s61, 18432
s_add_u32 s58, s58, s61
s_waitcnt vmcnt(0)
s_cmp_eq_u32 s36, 0
s_cbranch_scc1 L_slow21
L_ret21:
buffer_store_dword v12, v14, s[4:7], s56 offen
s_cmp_le_u32 s38, 64
s_cbranch_scc1 L_f1_wait
s_endpgm
L_slow18:
L_f1o_poll1:
buffer_load_dword v12, v0, s[4:7], s59 offen sc1
s_waitcnt vmcnt(0)
v_cmp_gt_u32 vcc, s60, v12
s_nop 0
s_cbranch_vccz L_f1o_pd2
s_sleep 1
s_sub_u32 s37, s37, 1
s_cbranch_scc0 L_f1o_poll1
s_movk_i32 s39, 55
s_branch L_bail
L_f1o_pd2:
s_branch L_ret18
L_slow19:
s_waitcnt vmcnt(0)
buffer_wbl2 sc1
s_waitcnt vmcnt(0)
buffer_store_dword v12, v10, s[4:7], s56 offen sc1
s_branch L_ret19
L_slow20:
L_f1o_poll3:
buffer_load_dword v12, v0, s[4:7], s59 offen sc1
s_waitcnt vmcnt(0)
v_cmp_gt_u32 vcc, s60, v12
s_nop 0
s_cbranch_vccz L_f1o_pd4
s_sleep 1
s_sub_u32 s37, s37, 1
s_cbranch_scc0 L_f1o_poll3
s_movk_i32 s39, 55
s_branch L_bail
L_f1o_pd4:
s_branch L_ret20
L_slow21:
s_waitcnt vmcnt(0)
buffer_wbl2 sc1
s_waitcnt vmcnt(0)
buffer_store_dword v12, v10, s[4:7], s56 offen sc1
s_branch L_ret21
L_backm:
s_mov_b32 s12, s84
s_and_b32 s13, s85, 0xffff
s_mov_b32 s14, 5308416
s_mov_b32 s15, 0x20000
s_mov_b32 s28, s86
s_and_b32 s29, s87, 0xffff
s_mov_b32 s30, 1152
s_mov_b32 s31, 0x20000
s_cmp_eq_u32 s33, 0
s_cselect_b32 s16, s92, s88
s_cselect_b32 s17, s93, s89
s_mov_b32 s44, 2359296
s_cselect_b32 s18, 268435456, s44
s_and_b32 s17, s17, 0xffff
s_mov_b32 s19, 0x20000
s_sub_u32 s34, s34, 16
s_mul_i32 s46, s34, 331776
v_lshlrev_b32 v8, 4, v0
v_lshrrev_b32 v9, 5, v0
v_lshlrev_b32 v9, 2, v9
v_bfe_u32 v10, v0, 2, 2
v_add_u32 v9, v9, v10
v_mul_u32_u24 v9, 1152, v9
v_bfe_u32 v11, v0, 4, 1
v_and_b32 v12, 3, v0
v_lshl_add_u32 v10, v11, 5, v9
v_lshl_add_u32 v10, v12, 3, v10
v_lshl_add_u32 v9, v11, 3, v9
v_lshl_add_u32 v9, v12, 4, v9
s_and_b32 s45, s35, 1
s_lshl_b32 s45, s45, 6
s_add_u32 s45, s45, 1024
v_add_u32 v10, s45, v10
v_lshl_add_u32 v9, s35, 8, v9
s_lshl_b32 s45, s35, 10
s_add_u32 s43, s45, 0
s_mov_b32 m0, s43
s_add_u32 s44, s43, s46
s_add_u32 s44, s44, 0
buffer_load_dwordx4 v8, s[12:15], s44 offen lds
s_add_u32 s43, s45, 4096
s_mov_b32 m0, s43
s_add_u32 s44, s43, s46
s_add_u32 s44, s44, 0
buffer_load_dwordx4 v8, s[12:15], s44 offen lds
s_add_u32 s43, s45, 8192
s_mov_b32 m0, s43
s_add_u32 s44, s43, s46
s_add_u32 s44, s44, 0
buffer_load_dwordx4 v8, s[12:15], s44 offen lds
s_add_u32 s43, s45, 12288
s_mov_b32 m0, s43
s_add_u32 s44, s43, s46
s_add_u32 s44, s44, 0
buffer_load_dwordx4 v8, s[12:15], s44 offen lds
s_add_u32 s43, s45, 16384
s_mov_b32 m0, s43
s_add_u32 s44, s43, s46
s_add_u32 s44, s44, 0
buffer_load_dwordx4 v8, s[12:15], s44 offen lds
s_add_u32 s43, s45, 20480
s_mov_b32 m0, s43
s_add_u32 s44, s43, s46
s_add_u32 s44, s44, 0
buffer_load_dwordx4 v8, s[12:15], s44 offen lds
s_add_u32 s43, s45, 24576
s_mov_b32 m0, s43
s_add_u32 s44, s43, s46
s_add_u32 s44, s44, 0
buffer_load_dwordx4 v8, s[12:15], s44 offen lds
s_add_u32 s43, s45, 28672
s_mov_b32 m0, s43
s_add_u32 s44, s43, s46
s_add_u32 s44, s44, 0
buffer_load_dwordx4 v8, s[12:15], s44 offen lds
s_add_u32 s43, s45, 32768
s_mov_b32 m0, s43
s_add_u32 s44, s43, s46
s_add_u32 s44, s44, 0
buffer_load_dwordx4 v8, s[12:15], s44 offen lds
s_add_u32 s43, s45, 36864
s_mov_b32 m0, s43
s_add_u32 s44, s43, s46
s_add_u32 s44, s44, 0
buffer_load_dwordx4 v8, s[12:15], s44 offen lds
s_add_u32 s43, s45, 40960
s_mov_b32 m0, s43
s_add_u32 s44, s43, s46
s_add_u32 s44, s44, 0
buffer_load_dwordx4 v8, s[12:15], s44 offen lds
s_add_u32 s43, s45, 45056
s_mov_b32 m0, s43
s_add_u32 s44, s43, s46
s_add_u32 s44, s44, 0
buffer_load_dwordx4 v8, s[12:15], s44 offen lds
s_add_u32 s43, s45, 49152
s_mov_b32 m0, s43
s_add_u32 s44, s43, s46
s_add_u32 s44, s44, 0
buffer_load_dwordx4 v8, s[12:15], s44 offen lds
s_add_u32 s43, s45, 53248
s_mov_b32 m0, s43
s_add_u32 s44, s43, s46
s_add_u32 s44, s44, 0
buffer_load_dwordx4 v8, s[12:15], s44 offen lds
s_add_u32 s43, s45, 57344
s_mov_b32 m0, s43
s_add_u32 s44, s43, s46
s_add_u32 s44, s44, 0
buffer_load_dwordx4 v8, s[12:15], s44 offen lds
s_add_u32 s43, s45, 61440
s_mov_b32 m0, s43
s_add_u32 s44, s43, s46
s_add_u32 s44, s44, 0
buffer_load_dwordx4 v8, s[12:15], s44 offen lds
s_add_u32 s43, s45, 65536
s_mov_b32 m0, s43
s_add_u32 s44, s43, s46
s_add_u32 s44, s44, 0
buffer_load_dwordx4 v8, s[12:15], s44 offen lds
s_add_u32 s43, s45, 69632
s_mov_b32 m0, s43
s_add_u32 s44, s43, s46
s_add_u32 s44, s44, 0
buffer_load_dwordx4 v8, s[12:15], s44 offen lds
s_add_u32 s43, s45, 73728
s_mov_b32 m0, s43
s_add_u32 s44, s43, s46
s_add_u32 s44, s44, 0
buffer_load_dwordx4 v8, s[12:15], s44 offen lds
s_add_u32 s43, s45, 77824
s_mov_b32 m0, s43
s_add_u32 s44, s43, s46
s_add_u32 s44, s44, 0
buffer_load_dwordx4 v8, s[12:15], s44 offen lds
s_add_u32 s43, s45, 81920
s_mov_b32 m0, s43
s_add_u32 s44, s43, s46
s_add_u32 s44, s44, 0
buffer_load_dwordx4 v8, s[12:15], s44 offen lds
s_add_u32 s43, s45, 86016
s_mov_b32 m0, s43
s_add_u32 s44, s43, s46
s_add_u32 s44, s44, 0
buffer_load_dwordx4 v8, s[12:15], s44 offen lds
s_add_u32 s43, s45, 90112
s_mov_b32 m0, s43
s_add_u32 s44, s43, s46
s_add_u32 s44, s44, 0
buffer_load_dwordx4 v8, s[12:15], s44 offen lds
s_add_u32 s43, s45, 94208
s_mov_b32 m0, s43
s_add_u32 s44, s43, s46
s_add_u32 s44, s44, 0
buffer_load_dwordx4 v8, s[12:15], s44 offen lds
s_add_u32 s43, s45, 98304
s_mov_b32 m0, s43
s_add_u32 s44, s43, s46
s_add_u32 s44, s44, 0
buffer_load_dwordx4 v8, s[12:15], s44 offen lds
s_add_u32 s43, s45, 102400
s_mov_b32 m0, s43
s_add_u32 s44, s43, s46
s_add_u32 s44, s44, 0
buffer_load_dwordx4 v8, s[12:15], s44 offen lds
s_add_u32 s43, s45, 106496
s_mov_b32 m0, s43
s_add_u32 s44, s43, s46
s_add_u32 s44, s44, 0
buffer_load_dwordx4 v8, s[12:15], s44 offen lds
s_add_u32 s43, s45, 110592
s_mov_b32 m0, s43
s_add_u32 s44, s43, s46
s_add_u32 s44, s44, 0
buffer_load_dwordx4 v8, s[12:15], s44 offen lds
s_add_u32 s43, s45, 114688
s_mov_b32 m0, s43
s_add_u32 s44, s43, s46
s_add_u32 s44, s44, 0
buffer_load_dwordx4 v8, s[12:15], s44 offen lds
s_add_u32 s43, s45, 118784
s_mov_b32 m0, s43
s_add_u32 s44, s43, s46
s_add_u32 s44, s44, 0
buffer_load_dwordx4 v8, s[12:15], s44 offen lds
s_add_u32 s43, s45, 122880
s_mov_b32 m0, s43
s_add_u32 s44, s43, s46
s_add_u32 s44, s44, 0
buffer_load_dwordx4 v8, s[12:15], s44 offen lds
s_add_u32 s43, s45, 126976
s_mov_b32 m0, s43
s_add_u32 s44, s43, s46
s_add_u32 s44, s44, 0
buffer_load_dwordx4 v8, s[12:15], s44 offen lds
s_add_u32 s43, s45, 131072
s_mov_b32 m0, s43
s_add_u32 s44, s43, s46
s_add_u32 s44, s44, 0
buffer_load_dwordx4 v8, s[12:15], s44 offen lds
s_add_u32 s43, s45, 135168
s_mov_b32 m0, s43
s_add_u32 s44, s43, s46
s_add_u32 s44, s44, 0
buffer_load_dwordx4 v8, s[12:15], s44 offen lds
s_add_u32 s43, s45, 139264
s_mov_b32 m0, s43
s_add_u32 s44, s43, s46
s_add_u32 s44, s44, 0
buffer_load_dwordx4 v8, s[12:15], s44 offen lds
s_add_u32 s43, s45, 143360
s_mov_b32 m0, s43
s_add_u32 s44, s43, s46
s_add_u32 s44, s44, 0
buffer_load_dwordx4 v8, s[12:15], s44 offen lds
s_waitcnt vmcnt(0)
s_barrier
v_add_u32 v11, 0, v9
v_add_u32 v12, 0, v10
ds_read_b64_tr_b16 a[0:1], v11 offset:0
ds_read_b64_tr_b16 a[72:73], v11 offset:64
ds_read_b64_tr_b16 a[144:145], v11 offset:128
ds_read_b64_tr_b16 a[216:217], v11 offset:192
ds_read_b64_tr_b16 v[184:185], v12 offset:0
ds_read_b64_tr_b16 a[2:3], v11 offset:9216
ds_read_b64_tr_b16 a[74:75], v11 offset:9280
ds_read_b64_tr_b16 a[146:147], v11 offset:9344
ds_read_b64_tr_b16 a[218:219], v11 offset:9408
ds_read_b64_tr_b16 v[186:187], v12 offset:9216
ds_read_b64_tr_b16 a[4:5], v11 offset:18432
ds_read_b64_tr_b16 a[76:77], v11 offset:18496
ds_read_b64_tr_b16 a[148:149], v11 offset:18560
ds_read_b64_tr_b16 a[220:221], v11 offset:18624
ds_read_b64_tr_b16 v[188:189], v12 offset:18432
ds_read_b64_tr_b16 a[6:7], v11 offset:27648
ds_read_b64_tr_b16 a[78:79], v11 offset:27712
ds_read_b64_tr_b16 a[150:151], v11 offset:27776
ds_read_b64_tr_b16 a[222:223], v11 offset:27840
ds_read_b64_tr_b16 v[190:191], v12 offset:27648
ds_read_b64_tr_b16 a[8:9], v11 offset:36864
ds_read_b64_tr_b16 a[80:81], v11 offset:36928
ds_read_b64_tr_b16 a[152:153], v11 offset:36992
ds_read_b64_tr_b16 a[224:225], v11 offset:37056
ds_read_b64_tr_b16 v[192:193], v12 offset:36864
ds_read_b64_tr_b16 a[10:11], v11 offset:46080
ds_read_b64_tr_b16 a[82:83], v11 offset:46144
ds_read_b64_tr_b16 a[154:155], v11 offset:46208
ds_read_b64_tr_b16 a[226:227], v11 offset:46272
ds_read_b64_tr_b16 v[194:195], v12 offset:46080
ds_read_b64_tr_b16 a[12:13], v11 offset:55296
ds_read_b64_tr_b16 a[84:85], v11 offset:55360
ds_read_b64_tr_b16 a[156:157], v11 offset:55424
ds_read_b64_tr_b16 a[228:229], v11 offset:55488
ds_read_b64_tr_b16 v[196:197], v12 offset:55296
v_add_u32 v11, 57600, v9
v_add_u32 v12, 57600, v10
ds_read_b64_tr_b16 a[14:15], v11 offset:6912
ds_read_b64_tr_b16 a[86:87], v11 offset:6976
ds_read_b64_tr_b16 a[158:159], v11 offset:7040
ds_read_b64_tr_b16 a[230:231], v11 offset:7104
ds_read_b64_tr_b16 v[198:199], v12 offset:6912
ds_read_b64_tr_b16 a[16:17], v11 offset:16128
ds_read_b64_tr_b16 a[88:89], v11 offset:16192
ds_read_b64_tr_b16 a[160:161], v11 offset:16256
ds_read_b64_tr_b16 a[232:233], v11 offset:16320
ds_read_b64_tr_b16 v[200:201], v12 offset:16128
ds_read_b64_tr_b16 a[18:19], v11 offset:25344
ds_read_b64_tr_b16 a[90:91], v11 offset:25408
ds_read_b64_tr_b16 a[162:163], v11 offset:25472
ds_read_b64_tr_b16 a[234:235], v11 offset:25536
ds_read_b64_tr_b16 v[202:203], v12 offset:25344
ds_read_b64_tr_b16 a[20:21], v11 offset:34560
ds_read_b64_tr_b16 a[92:93], v11 offset:34624
ds_read_b64_tr_b16 a[164:165], v11 offset:34688
ds_read_b64_tr_b16 a[236:237], v11 offset:34752
ds_read_b64_tr_b16 v[204:205], v12 offset:34560
ds_read_b64_tr_b16 a[22:23], v11 offset:43776
ds_read_b64_tr_b16 a[94:95], v11 offset:43840
ds_read_b64_tr_b16 a[166:167], v11 offset:43904
ds_read_b64_tr_b16 a[238:239], v11 offset:43968
ds_read_b64_tr_b16 v[206:207], v12 offset:43776
ds_read_b64_tr_b16 a[24:25], v11 offset:52992
ds_read_b64_tr_b16 a[96:97], v11 offset:53056
ds_read_b64_tr_b16 a[168:169], v11 offset:53120
ds_read_b64_tr_b16 a[240:241], v11 offset:53184
ds_read_b64_tr_b16 v[208:209], v12 offset:52992
v_add_u32 v11, 115200, v9
v_add_u32 v12, 115200, v10
ds_read_b64_tr_b16 a[26:27], v11 offset:4608
ds_read_b64_tr_b16 a[98:99], v11 offset:4672
ds_read_b64_tr_b16 a[170:171], v11 offset:4736
ds_read_b64_tr_b16 a[242:243], v11 offset:4800
ds_read_b64_tr_b16 v[210:211], v12 offset:4608
ds_read_b64_tr_b16 a[28:29], v11 offset:13824
ds_read_b64_tr_b16 a[100:101], v11 offset:13888
ds_read_b64_tr_b16 a[172:173], v11 offset:13952
ds_read_b64_tr_b16 a[244:245], v11 offset:14016
ds_read_b64_tr_b16 v[212:213], v12 offset:13824
ds_read_b64_tr_b16 a[30:31], v11 offset:23040
ds_read_b64_tr_b16 a[102:103], v11 offset:23104
ds_read_b64_tr_b16 a[174:175], v11 offset:23168
ds_read_b64_tr_b16 a[246:247], v11 offset:23232
ds_read_b64_tr_b16 v[214:215], v12 offset:23040
s_waitcnt lgkmcnt(0)
s_barrier
s_add_u32 s43, s45, 0
s_mov_b32 m0, s43
s_add_u32 s44, s43, s46
s_add_u32 s44, s44, 147456
buffer_load_dwordx4 v8, s[12:15], s44 offen lds
s_add_u32 s43, s45, 4096
s_mov_b32 m0, s43
s_add_u32 s44, s43, s46
s_add_u32 s44, s44, 147456
buffer_load_dwordx4 v8, s[12:15], s44 offen lds
s_add_u32 s43, s45, 8192
s_mov_b32 m0, s43
s_add_u32 s44, s43, s46
s_add_u32 s44, s44, 147456
buffer_load_dwordx4 v8, s[12:15], s44 offen lds
s_add_u32 s43, s45, 12288
s_mov_b32 m0, s43
s_add_u32 s44, s43, s46
s_add_u32 s44, s44, 147456
buffer_load_dwordx4 v8, s[12:15], s44 offen lds
s_add_u32 s43, s45, 16384
s_mov_b32 m0, s43
s_add_u32 s44, s43, s46
s_add_u32 s44, s44, 147456
buffer_load_dwordx4 v8, s[12:15], s44 offen lds
s_add_u32 s43, s45, 20480
s_mov_b32 m0, s43
s_add_u32 s44, s43, s46
s_add_u32 s44, s44, 147456
buffer_load_dwordx4 v8, s[12:15], s44 offen lds
s_add_u32 s43, s45, 24576
s_mov_b32 m0, s43
s_add_u32 s44, s43, s46
s_add_u32 s44, s44, 147456
buffer_load_dwordx4 v8, s[12:15], s44 offen lds
s_add_u32 s43, s45, 28672
s_mov_b32 m0, s43
s_add_u32 s44, s43, s46
s_add_u32 s44, s44, 147456
buffer_load_dwordx4 v8, s[12:15], s44 offen lds
s_add_u32 s43, s45, 32768
s_mov_b32 m0, s43
s_add_u32 s44, s43, s46
s_add_u32 s44, s44, 147456
buffer_load_dwordx4 v8, s[12:15], s44 offen lds
s_add_u32 s43, s45, 36864
s_mov_b32 m0, s43
s_add_u32 s44, s43, s46
s_add_u32 s44, s44, 147456
buffer_load_dwordx4 v8, s[12:15], s44 offen lds
s_add_u32 s43, s45, 40960
s_mov_b32 m0, s43
s_add_u32 s44, s43, s46
s_add_u32 s44, s44, 147456
buffer_load_dwordx4 v8, s[12:15], s44 offen lds
s_add_u32 s43, s45, 45056
s_mov_b32 m0, s43
s_add_u32 s44, s43, s46
s_add_u32 s44, s44, 147456
buffer_load_dwordx4 v8, s[12:15], s44 offen lds
s_add_u32 s43, s45, 49152
s_mov_b32 m0, s43
s_add_u32 s44, s43, s46
s_add_u32 s44, s44, 147456
buffer_load_dwordx4 v8, s[12:15], s44 offen lds
s_add_u32 s43, s45, 53248
s_mov_b32 m0, s43
s_add_u32 s44, s43, s46
s_add_u32 s44, s44, 147456
buffer_load_dwordx4 v8, s[12:15], s44 offen lds
s_add_u32 s43, s45, 57344
s_mov_b32 m0, s43
s_add_u32 s44, s43, s46
s_add_u32 s44, s44, 147456
buffer_load_dwordx4 v8, s[12:15], s44 offen lds
s_add_u32 s43, s45, 61440
s_mov_b32 m0, s43
s_add_u32 s44, s43, s46
s_add_u32 s44, s44, 147456
buffer_load_dwordx4 v8, s[12:15], s44 offen lds
s_add_u32 s43, s45, 65536
s_mov_b32 m0, s43
s_add_u32 s44, s43, s46
s_add_u32 s44, s44, 147456
buffer_load_dwordx4 v8, s[12:15], s44 offen lds
s_add_u32 s43, s45, 69632
s_mov_b32 m0, s43
s_add_u32 s44, s43, s46
s_add_u32 s44, s44, 147456
buffer_load_dwordx4 v8, s[12:15], s44 offen lds
s_add_u32 s43, s45, 73728
s_mov_b32 m0, s43
s_add_u32 s44, s43, s46
s_add_u32 s44, s44, 147456
buffer_load_dwordx4 v8, s[12:15], s44 offen lds
s_add_u32 s43, s45, 77824
s_mov_b32 m0, s43
s_add_u32 s44, s43, s46
s_add_u32 s44, s44, 147456
buffer_load_dwordx4 v8, s[12:15], s44 offen lds
s_add_u32 s43, s45, 81920
s_mov_b32 m0, s43
s_add_u32 s44, s43, s46
s_add_u32 s44, s44, 147456
buffer_load_dwordx4 v8, s[12:15], s44 offen lds
s_add_u32 s43, s45, 86016
s_mov_b32 m0, s43
s_add_u32 s44, s43, s46
s_add_u32 s44, s44, 147456
buffer_load_dwordx4 v8, s[12:15], s44 offen lds
s_add_u32 s43, s45, 90112
s_mov_b32 m0, s43
s_add_u32 s44, s43, s46
s_add_u32 s44, s44, 147456
buffer_load_dwordx4 v8, s[12:15], s44 offen lds
s_add_u32 s43, s45, 94208
s_mov_b32 m0, s43
s_add_u32 s44, s43, s46
s_add_u32 s44, s44, 147456
buffer_load_dwordx4 v8, s[12:15], s44 offen lds
s_add_u32 s43, s45, 98304
s_mov_b32 m0, s43
s_add_u32 s44, s43, s46
s_add_u32 s44, s44, 147456
buffer_load_dwordx4 v8, s[12:15], s44 offen lds
s_add_u32 s43, s45, 102400
s_mov_b32 m0, s43
s_add_u32 s44, s43, s46
s_add_u32 s44, s44, 147456
buffer_load_dwordx4 v8, s[12:15], s44 offen lds
s_add_u32 s43, s45, 106496
s_mov_b32 m0, s43
s_add_u32 s44, s43, s46
s_add_u32 s44, s44, 147456
buffer_load_dwordx4 v8, s[12:15], s44 offen lds
s_add_u32 s43, s45, 110592
s_mov_b32 m0, s43
s_add_u32 s44, s43, s46
s_add_u32 s44, s44, 147456
buffer_load_dwordx4 v8, s[12:15], s44 offen lds
s_add_u32 s43, s45, 114688
s_mov_b32 m0, s43
s_add_u32 s44, s43, s46
s_add_u32 s44, s44, 147456
buffer_load_dwordx4 v8, s[12:15], s44 offen lds
s_add_u32 s43, s45, 118784
s_mov_b32 m0, s43
s_add_u32 s44, s43, s46
s_add_u32 s44, s44, 147456
buffer_load_dwordx4 v8, s[12:15], s44 offen lds
s_add_u32 s43, s45, 122880
s_mov_b32 m0, s43
s_add_u32 s44, s43, s46
s_add_u32 s44, s44, 147456
buffer_load_dwordx4 v8, s[12:15], s44 offen lds
s_add_u32 s43, s45, 126976
s_mov_b32 m0, s43
s_add_u32 s44, s43, s46
s_add_u32 s44, s44, 147456
buffer_load_dwordx4 v8, s[12:15], s44 offen lds
s_add_u32 s43, s45, 131072
s_mov_b32 m0, s43
s_add_u32 s44, s43, s46
s_add_u32 s44, s44, 147456
buffer_load_dwordx4 v8, s[12:15], s44 offen lds
s_add_u32 s43, s45, 135168
s_mov_b32 m0, s43
s_add_u32 s44, s43, s46
s_add_u32 s44, s44, 147456
buffer_load_dwordx4 v8, s[12:15], s44 offen lds
s_add_u32 s43, s45, 139264
s_mov_b32 m0, s43
s_add_u32 s44, s43, s46
s_add_u32 s44, s44, 147456
buffer_load_dwordx4 v8, s[12:15], s44 offen lds
s_add_u32 s43, s45, 143360
s_mov_b32 m0, s43
s_add_u32 s44, s43, s46
s_add_u32 s44, s44, 147456
buffer_load_dwordx4 v8, s[12:15], s44 offen lds
s_waitcnt vmcnt(0)
s_barrier
v_add_u32 v11, 0, v9
v_add_u32 v12, 0, v10
ds_read_b64_tr_b16 a[32:33], v11 offset:0
ds_read_b64_tr_b16 a[104:105], v11 offset:64
ds_read_b64_tr_b16 a[176:177], v11 offset:128
ds_read_b64_tr_b16 a[248:249], v11 offset:192
ds_read_b64_tr_b16 v[216:217], v12 offset:0
ds_read_b64_tr_b16 a[34:35], v11 offset:9216
ds_read_b64_tr_b16 a[106:107], v11 offset:9280
ds_read_b64_tr_b16 a[178:179], v11 offset:9344
ds_read_b64_tr_b16 a[250:251], v11 offset:9408
ds_read_b64_tr_b16 v[218:219], v12 offset:9216
ds_read_b64_tr_b16 a[36:37], v11 offset:18432
ds_read_b64_tr_b16 a[108:109], v11 offset:18496
ds_read_b64_tr_b16 a[180:181], v11 offset:18560
ds_read_b64_tr_b16 a[252:253], v11 offset:18624
ds_read_b64_tr_b16 v[220:221], v12 offset:18432
ds_read_b64_tr_b16 a[38:39], v11 offset:27648
ds_read_b64_tr_b16 a[110:111], v11 offset:27712
ds_read_b64_tr_b16 a[182:183], v11 offset:27776
ds_read_b64_tr_b16 a[254:255], v11 offset:27840
ds_read_b64_tr_b16 v[222:223], v12 offset:27648
ds_read_b64_tr_b16 a[40:41], v11 offset:36864
ds_read_b64_tr_b16 a[112:113], v11 offset:36928
ds_read_b64_tr_b16 a[184:185], v11 offset:36992
ds_read_b64_tr_b16 v[152:153], v11 offset:37056
ds_read_b64_tr_b16 v[224:225], v12 offset:36864
ds_read_b64_tr_b16 a[42:43], v11 offset:46080
ds_read_b64_tr_b16 a[114:115], v11 offset:46144
ds_read_b64_tr_b16 a[186:187], v11 offset:46208
ds_read_b64_tr_b16 v[154:155], v11 offset:46272
ds_read_b64_tr_b16 v[226:227], v12 offset:46080
ds_read_b64_tr_b16 a[44:45], v11 offset:55296
ds_read_b64_tr_b16 a[116:117], v11 offset:55360
ds_read_b64_tr_b16 a[188:189], v11 offset:55424
ds_read_b64_tr_b16 v[156:157], v11 offset:55488
ds_read_b64_tr_b16 v[228:229], v12 offset:55296
v_add_u32 v11, 57600, v9
v_add_u32 v12, 57600, v10
ds_read_b64_tr_b16 a[46:47], v11 offset:6912
ds_read_b64_tr_b16 a[118:119], v11 offset:6976
ds_read_b64_tr_b16 a[190:191], v11 offset:7040
ds_read_b64_tr_b16 v[158:159], v11 offset:7104
ds_read_b64_tr_b16 v[230:231], v12 offset:6912
ds_read_b64_tr_b16 a[48:49], v11 offset:16128
ds_read_b64_tr_b16 a[120:121], v11 offset:16192
ds_read_b64_tr_b16 a[192:193], v11 offset:16256
ds_read_b64_tr_b16 v[160:161], v11 offset:16320
ds_read_b64_tr_b16 v[232:233], v12 offset:16128
ds_read_b64_tr_b16 a[50:51], v11 offset:25344
ds_read_b64_tr_b16 a[122:123], v11 offset:25408
ds_read_b64_tr_b16 a[194:195], v11 offset:25472
ds_read_b64_tr_b16 v[162:163], v11 offset:25536
ds_read_b64_tr_b16 v[234:235], v12 offset:25344
ds_read_b64_tr_b16 a[52:53], v11 offset:34560
ds_read_b64_tr_b16 a[124:125], v11 offset:34624
ds_read_b64_tr_b16 a[196:197], v11 offset:34688
ds_read_b64_tr_b16 v[164:165], v11 offset:34752
ds_read_b64_tr_b16 v[236:237], v12 offset:34560
ds_read_b64_tr_b16 a[54:55], v11 offset:43776
ds_read_b64_tr_b16 a[126:127], v11 offset:43840
ds_read_b64_tr_b16 a[198:199], v11 offset:43904
ds_read_b64_tr_b16 v[166:167], v11 offset:43968
ds_read_b64_tr_b16 v[238:239], v12 offset:43776
ds_read_b64_tr_b16 a[56:57], v11 offset:52992
ds_read_b64_tr_b16 a[128:129], v11 offset:53056
ds_read_b64_tr_b16 a[200:201], v11 offset:53120
ds_read_b64_tr_b16 v[168:169], v11 offset:53184
ds_read_b64_tr_b16 v[240:241], v12 offset:52992
v_add_u32 v11, 115200, v9
v_add_u32 v12, 115200, v10
ds_read_b64_tr_b16 a[58:59], v11 offset:4608
ds_read_b64_tr_b16 a[130:131], v11 offset:4672
ds_read_b64_tr_b16 a[202:203], v11 offset:4736
ds_read_b64_tr_b16 v[170:171], v11 offset:4800
ds_read_b64_tr_b16 v[242:243], v12 offset:4608
ds_read_b64_tr_b16 a[60:61], v11 offset:13824
ds_read_b64_tr_b16 a[132:133], v11 offset:13888
ds_read_b64_tr_b16 a[204:205], v11 offset:13952
ds_read_b64_tr_b16 v[172:173], v11 offset:14016
ds_read_b64_tr_b16 v[244:245], v12 offset:13824
ds_read_b64_tr_b16 a[62:63], v11 offset:23040
ds_read_b64_tr_b16 a[134:135], v11 offset:23104
ds_read_b64_tr_b16 a[206:207], v11 offset:23168
ds_read_b64_tr_b16 v[174:175], v11 offset:23232
ds_read_b64_tr_b16 v[246:247], v12 offset:23040
s_waitcnt lgkmcnt(0)
s_barrier
s_add_u32 s43, s45, 0
s_mov_b32 m0, s43
s_add_u32 s44, s43, s46
s_add_u32 s44, s44, 294912
buffer_load_dwordx4 v8, s[12:15], s44 offen lds
s_add_u32 s43, s45, 4096
s_mov_b32 m0, s43
s_add_u32 s44, s43, s46
s_add_u32 s44, s44, 294912
buffer_load_dwordx4 v8, s[12:15], s44 offen lds
s_add_u32 s43, s45, 8192
s_mov_b32 m0, s43
s_add_u32 s44, s43, s46
s_add_u32 s44, s44, 294912
buffer_load_dwordx4 v8, s[12:15], s44 offen lds
s_add_u32 s43, s45, 12288
s_mov_b32 m0, s43
s_add_u32 s44, s43, s46
s_add_u32 s44, s44, 294912
buffer_load_dwordx4 v8, s[12:15], s44 offen lds
s_add_u32 s43, s45, 16384
s_mov_b32 m0, s43
s_add_u32 s44, s43, s46
s_add_u32 s44, s44, 294912
buffer_load_dwordx4 v8, s[12:15], s44 offen lds
s_add_u32 s43, s45, 20480
s_mov_b32 m0, s43
s_add_u32 s44, s43, s46
s_add_u32 s44, s44, 294912
buffer_load_dwordx4 v8, s[12:15], s44 offen lds
s_add_u32 s43, s45, 24576
s_mov_b32 m0, s43
s_add_u32 s44, s43, s46
s_add_u32 s44, s44, 294912
buffer_load_dwordx4 v8, s[12:15], s44 offen lds
s_add_u32 s43, s45, 28672
s_mov_b32 m0, s43
s_add_u32 s44, s43, s46
s_add_u32 s44, s44, 294912
buffer_load_dwordx4 v8, s[12:15], s44 offen lds
s_add_u32 s43, s45, 32768
s_mov_b32 m0, s43
s_add_u32 s44, s43, s46
s_add_u32 s44, s44, 294912
buffer_load_dwordx4 v8, s[12:15], s44 offen lds
s_waitcnt vmcnt(0)
s_barrier
v_add_u32 v11, 0, v9
v_add_u32 v12, 0, v10
ds_read_b64_tr_b16 a[64:65], v11 offset:0
ds_read_b64_tr_b16 a[136:137], v11 offset:64
ds_read_b64_tr_b16 a[208:209], v11 offset:128
ds_read_b64_tr_b16 v[176:177], v11 offset:192
ds_read_b64_tr_b16 v[248:249], v12 offset:0
ds_read_b64_tr_b16 a[66:67], v11 offset:9216
ds_read_b64_tr_b16 a[138:139], v11 offset:9280
ds_read_b64_tr_b16 a[210:211], v11 offset:9344
ds_read_b64_tr_b16 v[178:179], v11 offset:9408
ds_read_b64_tr_b16 v[250:251], v12 offset:9216
ds_read_b64_tr_b16 a[68:69], v11 offset:18432
ds_read_b64_tr_b16 a[140:141], v11 offset:18496
ds_read_b64_tr_b16 a[212:213], v11 offset:18560
ds_read_b64_tr_b16 v[180:181], v11 offset:18624
ds_read_b64_tr_b16 v[252:253], v12 offset:18432
ds_read_b64_tr_b16 a[70:71], v11 offset:27648
ds_read_b64_tr_b16 a[142:143], v11 offset:27712
ds_read_b64_tr_b16 a[214:215], v11 offset:27776
ds_read_b64_tr_b16 v[182:183], v11 offset:27840
ds_read_b64_tr_b16 v[254:255], v12 offset:27648
s_waitcnt lgkmcnt(0)
s_barrier
v_lshl_add_u32 v48, s35, 6, v0
v_lshlrev_b32 v48, 20, v48
buffer_load_dword v50, v48, s[4:7], 0 offen
buffer_load_dword v50, v48, s[16:19], 0 offen
v_and_b32 v48, 7, v0
v_lshlrev_b32 v48, 3, v48
L_om_cen1:
buffer_load_dwordx2 v[50:51], v48, s[24:27], s0 offen sc1
s_waitcnt vmcnt(0)
v_sad_u8 v49, v50, 0, 0
v_sad_u8 v49, v51, 0, v49
v_cmp_ne_u32 vcc, 32, v49
s_nop 0
s_cbranch_vccz L_om_cend2
s_sleep 16
s_sub_u32 s37, s37, 1
s_cbranch_scc0 L_om_cen1
s_movk_i32 s39, 81
s_branch L_bail
L_om_cend2:
v_bcnt_u32_b32 v49, v50, 0
v_bcnt_u32_b32 v49, v51, v49
v_cmp_ne_u32 vcc, 1, v49
v_readlane_b32 s41, v49, s1
s_cbranch_vccz L_om_cok3
s_cmp_eq_u32 s0, 0
s_cbranch_scc1 L_redo
L_om_cok3:
s_cmp_eq_u32 s41, 1
s_cselect_b32 s36, 1, 0
v_lshlrev_b32 v1, 4, v0
v_mov_b32 v2, v1
v_and_b32 v48, 31, v0
v_lshrrev_b32 v49, 5, v0
v_and_b32 v50, 15, v0
v_lshrrev_b32 v51, 4, v0
v_mul_u32_u24 v3, 2304, v51
v_lshl_add_u32 v3, v50, 4, v3
v_lshl_add_u32 v3, s35, 8, v3
v_lshlrev_b32 v5, 2, v0
v_mov_b32 v6, 0
v_mov_b32 v9, 0
v_and_b32 v8, 3, v0
v_lshlrev_b32 v8, 2, v8
s_cmp_eq_u32 s36, 0
s_cselect_b32 s45, 0x7ffffff0, 0
v_mov_b32 v7, s45
s_lshl_b32 s45, s33, 9
s_add_u32 s54, s45, 20480
s_add_u32 s56, s45, 12288
s_lshl_b32 s55, s34, 2
s_add_u32 s55, s55, s35
s_lshl_b32 s55, s55, 2
s_add_u32 s55, s55, s54
s_add_u32 s41, s54, 2048
s_lshl_b32 s45, s33, 21
s_add_u32 s45, s45, 54525952
s_mul_i32 s57, s34, 36864
s_add_u32 s57, s57, s45
s_add_u32 s58, s57, 9216
s_add_u32 s59, s57, 18432
s_add_u32 s60, s57, 27648
s_lshl_b32 s46, s34, 1
s_and_b32 s47, s35, 1
s_add_u32 s46, s46, s47
s_mul_i32 s46, s46, 1152
s_add_u32 s10, s46, s45
s_add_u32 s11, s10, 147456
s_add_u32 s12, s10, 294912
s_add_u32 s13, s10, 442368
s_lshl_b32 s45, s33, 4
s_add_u32 s45, s45, s34
s_add_u32 s45, s45, 32
s_mul_i32 s48, s45, 73728
s_add_u32 s48, s48, 167772160
s_lshl_b32 s53, s45, 7
s_add_u32 s53, s53, 24576
s_mul_i32 s45, s33, 2359296
s_add_u32 s45, s45, s46
s_add_u32 s94, s45, 11534336
s_cmp_eq_u32 s33, 0
s_cselect_b32 s95, 16252928, 0
s_mov_b32 s44, 18612224
s_cselect_b32 s96, 4456448, s44
s_add_u32 s95, s95, s46
s_add_u32 s96, s96, s46
s_lshl_b32 s51, s35, 12
s_add_u32 s48, s48, s51
s_mul_i32 s49, s35, 3072
s_sub_u32 s49, 16384, s49
s_mov_b32 s38, 1
s_mov_b32 s65, 0
s_mov_b32 s66, -1
v_lshl_add_u32 v56, s35, 6, v0
v_lshlrev_b32 v56, 7, v56
v_add_u32 v57, 4096, v56
s_add_u32 s44, s57, 0
buffer_load_dword v58, v56, s[4:7], s44 offen sc1
buffer_load_dword v58, v57, s[4:7], s44 offen sc1
s_add_u32 s44, s57, 1048576
buffer_load_dword v58, v56, s[4:7], s44 offen sc1
buffer_load_dword v58, v57, s[4:7], s44 offen sc1
s_sub_u32 s44, s48, s51
buffer_load_dword v58, v56, s[4:7], s44 offen sc1
s_add_u32 s44, s44, 32768
buffer_load_dword v58, v56, s[4:7], s44 offen sc1
s_add_u32 s44, s44, 32768
buffer_load_dword v58, v56, s[4:7], s44 offen sc1
s_add_u32 s44, s44, 32768
s_waitcnt vmcnt(0)
s_cmp_ge_u32 s35, 2
s_cbranch_scc1 L_om_hi
v_mul_u32_u24 v4, 1152, v48
v_lshl_add_u32 v4, v49, 4, v4
v_lshl_add_u32 v4, s35, 6, v4
v_cmp_gt_u32 vcc, s38, v9
s_nop 0
s_cbranch_vccnz L_slow22
L_ret22:
s_barrier
buffer_load_dword v9, v8, s[4:7], s53 offen sc1
s_and_b32 s61, s38, 3
s_cselect_b32 s61, 1, -3
s_mul_i32 s61, s61, 18432
s_add_u32 s48, s48, s61
s_xor_b32 s51, s51, 0x8000
ds_read_b128 v[112:115], v2 offset:0
s_add_u32 s44, s48, s49
ds_read_b128 v[116:119], v2 offset:1024
ds_read_b128 v[120:123], v2 offset:2048
ds_read_b128 v[12:15], v2 offset:0
ds_read_b128 v[148:151], v2 offset:1024
s_waitcnt lgkmcnt(4)
v_mfma_f32_32x32x16_bf16 v[16:31], v[112:115], a[0:3], 0
v_mfma_f32_32x32x16_bf16 v[32:47], v[112:115], a[72:75], 0
v_mfma_f32_32x32x16_bf16 v[48:63], v[112:115], a[144:147], 0
v_mfma_f32_32x32x16_bf16 v[64:79], v[112:115], a[216:219], 0
ds_read_b128 v[112:115], v2 offset:3072
s_waitcnt vmcnt(0)
s_mov_b32 m0, s51
s_nop 0
buffer_load_dwordx4 v1, s[4:7], s48 offen offset:0 sc1 lds
s_waitcnt lgkmcnt(4)
v_mfma_f32_32x32x16_bf16 v[16:31], v[116:119], a[4:7], v[16:31]
s_mov_b32 m0, s51
s_nop 0
buffer_load_dwordx4 v1, s[4:7], s48 offen offset:1024 sc1 lds
v_mfma_f32_32x32x16_bf16 v[32:47], v[116:119], a[76:79], v[32:47]
s_mov_b32 m0, s51
s_nop 0
buffer_load_dwordx4 v1, s[4:7], s48 offen offset:2048 sc1 lds
v_mfma_f32_32x32x16_bf16 v[48:63], v[116:119], a[148:151], v[48:63]
s_mov_b32 m0, s51
s_nop 0
buffer_load_dwordx4 v1, s[4:7], s48 offen offset:3072 sc1 lds
v_mfma_f32_32x32x16_bf16 v[64:79], v[116:119], a[220:223], v[64:79]
ds_read_b128 v[116:119], v2 offset:4096
s_add_u32 m0, s51, s49
s_nop 0
buffer_load_dwordx4 v1, s[4:7], s44 offen sc1 lds
s_waitcnt lgkmcnt(4)
v_mfma_f32_32x32x16_bf16 v[16:31], v[120:123], a[8:11], v[16:31]
v_mfma_f32_32x32x16_bf16 v[32:47], v[120:123], a[80:83], v[32:47]
v_mfma_f32_32x32x16_bf16 v[48:63], v[120:123], a[152:155], v[48:63]
v_mfma_f32_32x32x16_bf16 v[64:79], v[120:123], a[224:227], v[64:79]
ds_read_b128 v[120:123], v2 offset:5120
s_waitcnt lgkmcnt(2)
v_mfma_f32_32x32x16_bf16 v[16:31], v[112:115], a[12:15], v[16:31]
v_mfma_f32_32x32x16_bf16 v[32:47], v[112:115], a[84:87], v[32:47]
v_mfma_f32_32x32x16_bf16 v[48:63], v[112:115], a[156:159], v[48:63]
v_mfma_f32_32x32x16_bf16 v[64:79], v[112:115], a[228:231], v[64:79]
ds_read_b128 v[112:115], v2 offset:6144
s_waitcnt lgkmcnt(2)
v_mfma_f32_32x32x16_bf16 v[16:31], v[116:119], a[16:19], v[16:31]
v_mfma_f32_32x32x16_bf16 v[32:47], v[116:119], a[88:91], v[32:47]
v_mfma_f32_32x32x16_bf16 v[48:63], v[116:119], a[160:163], v[48:63]
v_mfma_f32_32x32x16_bf16 v[64:79], v[116:119], a[232:235], v[64:79]
ds_read_b128 v[116:119], v2 offset:7168
s_waitcnt lgkmcnt(2)
v_mfma_f32_32x32x16_bf16 v[16:31], v[120:123], a[20:23], v[16:31]
v_mfma_f32_32x32x16_bf16 v[32:47], v[120:123], a[92:95], v[32:47]
v_mfma_f32_32x32x16_bf16 v[48:63], v[120:123], a[164:167], v[48:63]
v_mfma_f32_32x32x16_bf16 v[64:79], v[120:123], a[236:239], v[64:79]
ds_read_b128 v[120:123], v2 offset:8192
s_waitcnt lgkmcnt(2)
v_mfma_f32_32x32x16_bf16 v[16:31], v[112:115], a[24:27], v[16:31]
v_mfma_f32_32x32x16_bf16 v[32:47], v[112:115], a[96:99], v[32:47]
v_mfma_f32_32x32x16_bf16 v[48:63], v[112:115], a[168:171], v[48:63]
v_mfma_f32_32x32x16_bf16 v[64:79], v[112:115], a[240:243], v[64:79]
ds_read_b128 v[112:115], v2 offset:9216
s_waitcnt lgkmcnt(2)
v_mfma_f32_32x32x16_bf16 v[16:31], v[116:119], a[28:31], v[16:31]
v_mfma_f32_32x32x16_bf16 v[32:47], v[116:119], a[100:103], v[32:47]
v_mfma_f32_32x32x16_bf16 v[48:63], v[116:119], a[172:175], v[48:63]
v_mfma_f32_32x32x16_bf16 v[64:79], v[116:119], a[244:247], v[64:79]
ds_read_b128 v[116:119], v2 offset:10240
s_waitcnt lgkmcnt(2)
v_mfma_f32_32x32x16_bf16 v[16:31], v[120:123], a[32:35], v[16:31]
v_mfma_f32_32x32x16_bf16 v[32:47], v[120:123], a[104:107], v[32:47]
v_mfma_f32_32x32x16_bf16 v[48:63], v[120:123], a[176:179], v[48:63]
v_mfma_f32_32x32x16_bf16 v[64:79], v[120:123], a[248:251], v[64:79]
ds_read_b128 v[120:123], v2 offset:11264
s_waitcnt lgkmcnt(2)
v_mfma_f32_32x32x16_bf16 v[16:31], v[112:115], a[36:39], v[16:31]
v_mfma_f32_32x32x16_bf16 v[32:47], v[112:115], a[108:111], v[32:47]
v_mfma_f32_32x32x16_bf16 v[48:63], v[112:115], a[180:183], v[48:63]
v_mfma_f32_32x32x16_bf16 v[64:79], v[112:115], a[252:255], v[64:79]
ds_read_b128 v[112:115], v2 offset:12288
s_waitcnt lgkmcnt(2)
v_mfma_f32_32x32x16_bf16 v[16:31], v[116:119], a[40:43], v[16:31]
v_mfma_f32_32x32x16_bf16 v[32:47], v[116:119], a[112:115], v[32:47]
v_mfma_f32_32x32x16_bf16 v[48:63], v[116:119], a[184:187], v[48:63]
v_mfma_f32_32x32x16_bf16 v[64:79], v[116:119], v[152:155], v[64:79]
ds_read_b128 v[116:119], v2 offset:13312
s_waitcnt lgkmcnt(2)
v_mfma_f32_32x32x16_bf16 v[16:31], v[120:123], a[44:47], v[16:31]
v_mfma_f32_32x32x16_bf16 v[32:47], v[120:123], a[116:119], v[32:47]
v_mfma_f32_32x32x16_bf16 v[48:63], v[120:123], a[188:191], v[48:63]
v_mfma_f32_32x32x16_bf16 v[64:79], v[120:123], v[156:159], v[64:79]
ds_read_b128 v[120:123], v2 offset:14336
s_waitcnt lgkmcnt(2)
v_mfma_f32_32x32x16_bf16 v[16:31], v[112:115], a[48:51], v[16:31]
v_mfma_f32_32x32x16_bf16 v[32:47], v[112:115], a[120:123], v[32:47]
v_mfma_f32_32x32x16_bf16 v[48:63], v[112:115], a[192:195], v[48:63]
v_mfma_f32_32x32x16_bf16 v[64:79], v[112:115], v[160:163], v[64:79]
ds_read_b128 v[112:115], v2 offset:15360
s_waitcnt lgkmcnt(2)
v_mfma_f32_32x32x16_bf16 v[16:31], v[116:119], a[52:55], v[16:31]
v_mfma_f32_32x32x16_bf16 v[32:47], v[116:119], a[124:127], v[32:47]
v_mfma_f32_32x32x16_bf16 v[48:63], v[116:119], a[196:199], v[48:63]
v_mfma_f32_32x32x16_bf16 v[64:79], v[116:119], v[164:167], v[64:79]
ds_read_b128 v[116:119], v2 offset:16384
s_waitcnt lgkmcnt(2)
v_mfma_f32_32x32x16_bf16 v[16:31], v[120:123], a[56:59], v[16:31]
v_mfma_f32_32x32x16_bf16 v[32:47], v[120:123], a[128:131], v[32:47]
v_mfma_f32_32x32x16_bf16 v[48:63], v[120:123], a[200:203], v[48:63]
v_mfma_f32_32x32x16_bf16 v[64:79], v[120:123], v[168:171], v[64:79]
ds_read_b128 v[120:123], v2 offset:17408
s_waitcnt lgkmcnt(2)
v_mfma_f32_32x32x16_bf16 v[16:31], v[112:115], a[60:63], v[16:31]
v_mfma_f32_32x32x16_bf16 v[32:47], v[112:115], a[132:135], v[32:47]
v_mfma_f32_32x32x16_bf16 v[48:63], v[112:115], a[204:207], v[48:63]
v_mfma_f32_32x32x16_bf16 v[64:79], v[112:115], v[172:175], v[64:79]
ds_read_b128 v[112:115], v2 offset:2048
s_waitcnt lgkmcnt(2)
v_mfma_f32_32x32x16_bf16 v[16:31], v[116:119], a[64:67], v[16:31]
v_mfma_f32_32x32x16_bf16 v[32:47], v[116:119], a[136:139], v[32:47]
v_mfma_f32_32x32x16_bf16 v[48:63], v[116:119], a[208:211], v[48:63]
v_mfma_f32_32x32x16_bf16 v[64:79], v[116:119], v[176:179], v[64:79]
ds_read_b128 v[116:119], v2 offset:3072
s_waitcnt lgkmcnt(2)
v_mfma_f32_32x32x16_bf16 v[16:31], v[120:123], a[68:71], v[16:31]
v_mfma_f32_32x32x16_bf16 v[32:47], v[120:123], a[140:143], v[32:47]
v_mfma_f32_32x32x16_bf16 v[48:63], v[120:123], a[212:215], v[48:63]
s_nop 3
v_cvt_pk_bf16_f32 v80, v16, v32
v_cvt_pk_bf16_f32 v82, v18, v34
v_cvt_pk_bf16_f32 v84, v17, v33
v_mfma_f32_32x32x16_bf16 v[64:79], v[120:123], v[180:183], v[64:79]
ds_read_b128 v[120:123], v2 offset:4096
v_permlane16_swap_b32 v80, v82
v_cvt_pk_bf16_f32 v86, v19, v35
v_cvt_pk_bf16_f32 v88, v20, v36
v_cvt_pk_bf16_f32 v90, v22, v38
v_mfma_f32_32x32x16_bf16 v[124:139], v[184:187], v[12:15], 0
ds_read_b128 v[12:15], v2 offset:5120
v_permlane16_swap_b32 v84, v86
s_nop 1
v_cvt_pk_bf16_f32 v81, v48, v64
v_cvt_pk_bf16_f32 v83, v50, v66
v_cvt_pk_bf16_f32 v85, v49, v65
v_mfma_f32_32x32x16_bf16 v[124:139], v[188:191], v[148:151], v[124:139]
ds_read_b128 v[148:151], v2 offset:6144
v_permlane16_swap_b32 v81, v83
buffer_store_dwordx4 v[80:83], v3, s[4:7], s57 offen offset:0
v_cvt_pk_bf16_f32 v87, v51, v67
s_waitcnt lgkmcnt(4)
v_mfma_f32_32x32x16_bf16 v[124:139], v[192:195], v[112:115], v[124:139]
ds_read_b128 v[112:115], v2 offset:7168
v_permlane16_swap_b32 v85, v87
v_cvt_pk_bf16_f32 v89, v52, v68
v_cvt_pk_bf16_f32 v91, v54, v70
s_waitcnt lgkmcnt(4)
v_mfma_f32_32x32x16_bf16 v[124:139], v[196:199], v[116:119], v[124:139]
ds_read_b128 v[116:119], v2 offset:8192
v_permlane16_swap_b32 v88, v90
buffer_store_dwordx4 v[84:87], v3, s[4:7], s57 offen offset:1152
s_waitcnt lgkmcnt(4)
v_mfma_f32_32x32x16_bf16 v[124:139], v[200:203], v[120:123], v[124:139]
ds_read_b128 v[120:123], v2 offset:9216
v_permlane16_swap_b32 v89, v91
v_cvt_pk_bf16_f32 v92, v21, v37
v_cvt_pk_bf16_f32 v94, v23, v39
s_waitcnt lgkmcnt(4)
v_mfma_f32_32x32x16_bf16 v[124:139], v[204:207], v[12:15], v[124:139]
ds_read_b128 v[12:15], v2 offset:10240
v_cvt_pk_bf16_f32 v93, v53, v69
v_cvt_pk_bf16_f32 v95, v55, v71
buffer_store_dwordx4 v[88:91], v3, s[4:7], s58 offen offset:0
s_waitcnt lgkmcnt(4)
v_mfma_f32_32x32x16_bf16 v[124:139], v[208:211], v[148:151], v[124:139]
ds_read_b128 v[148:151], v2 offset:11264
v_permlane16_swap_b32 v92, v94
v_permlane16_swap_b32 v93, v95
v_cvt_pk_bf16_f32 v96, v24, v40
s_waitcnt lgkmcnt(4)
v_mfma_f32_32x32x16_bf16 v[124:139], v[212:215], v[112:115], v[124:139]
ds_read_b128 v[112:115], v2 offset:12288
v_cvt_pk_bf16_f32 v98, v26, v42
buffer_store_dwordx4 v[92:95], v3, s[4:7], s58 offen offset:1152
v_cvt_pk_bf16_f32 v97, v56, v72
s_waitcnt lgkmcnt(4)
v_mfma_f32_32x32x16_bf16 v[124:139], v[216:219], v[116:119], v[124:139]
ds_read_b128 v[116:119], v2 offset:13312
v_cvt_pk_bf16_f32 v99, v58, v74
v_permlane16_swap_b32 v96, v98
s_nop 0
v_permlane16_swap_b32 v97, v99
s_waitcnt lgkmcnt(4)
v_mfma_f32_32x32x16_bf16 v[124:139], v[220:223], v[120:123], v[124:139]
ds_read_b128 v[120:123], v2 offset:14336
buffer_store_dwordx4 v[96:99], v3, s[4:7], s59 offen offset:0
v_cvt_pk_bf16_f32 v100, v25, v41
v_cvt_pk_bf16_f32 v102, v27, v43
s_waitcnt lgkmcnt(4)
v_mfma_f32_32x32x16_bf16 v[124:139], v[224:227], v[12:15], v[124:139]
ds_read_b128 v[12:15], v2 offset:15360
v_cvt_pk_bf16_f32 v101, v57, v73
v_cvt_pk_bf16_f32 v103, v59, v75
v_permlane16_swap_b32 v100, v102
s_waitcnt lgkmcnt(4)
v_mfma_f32_32x32x16_bf16 v[124:139], v[228:231], v[148:151], v[124:139]
ds_read_b128 v[148:151], v2 offset:16384
v_permlane16_swap_b32 v101, v103
buffer_store_dwordx4 v[100:103], v3, s[4:7], s59 offen offset:1152
s_waitcnt lgkmcnt(4)
v_mfma_f32_32x32x16_bf16 v[124:139], v[232:235], v[112:115], v[124:139]
ds_read_b128 v[112:115], v2 offset:17408
v_cvt_pk_bf16_f32 v104, v28, v44
v_cvt_pk_bf16_f32 v106, v30, v46
v_cvt_pk_bf16_f32 v105, v60, v76
v_cvt_pk_bf16_f32 v107, v62, v78
s_waitcnt lgkmcnt(4)
v_mfma_f32_32x32x16_bf16 v[124:139], v[236:239], v[116:119], v[124:139]
v_permlane16_swap_b32 v104, v106
v_permlane16_swap_b32 v105, v107
buffer_store_dwordx4 v[104:107], v3, s[4:7], s60 offen offset:0
s_waitcnt lgkmcnt(3)
v_mfma_f32_32x32x16_bf16 v[124:139], v[240:243], v[120:123], v[124:139]
v_cvt_pk_bf16_f32 v108, v29, v45
v_cvt_pk_bf16_f32 v110, v31, v47
v_cvt_pk_bf16_f32 v109, v61, v77
v_cvt_pk_bf16_f32 v111, v63, v79
v_permlane16_swap_b32 v108, v110
s_waitcnt lgkmcnt(2)
v_mfma_f32_32x32x16_bf16 v[124:139], v[244:247], v[12:15], v[124:139]
v_permlane16_swap_b32 v109, v111
buffer_store_dwordx4 v[108:111], v3, s[4:7], s60 offen offset:1152
v_xor_b32 v2, 0x8000, v2
s_waitcnt lgkmcnt(1)
v_mfma_f32_32x32x16_bf16 v[124:139], v[248:251], v[148:151], v[124:139]
v_xor_b32 v3, 1048576, v3
s_waitcnt lgkmcnt(0)
v_mfma_f32_32x32x16_bf16 v[124:139], v[252:255], v[112:115], v[124:139]
s_nop 11
v_cvt_pk_bf16_f32 v140, v124, v126
v_cvt_pk_bf16_f32 v141, v128, v130
v_cvt_pk_bf16_f32 v142, v125, v127
v_cvt_pk_bf16_f32 v143, v129, v131
v_cvt_pk_bf16_f32 v144, v132, v134
buffer_store_dwordx4 v[140:143], v4, s[4:7], s57 offen offset:1024
v_cvt_pk_bf16_f32 v145, v136, v138
v_cvt_pk_bf16_f32 v146, v133, v135
v_cvt_pk_bf16_f32 v147, v137, v139
buffer_store_dwordx4 v[144:147], v4, s[4:7], s57 offen offset:1056
v_xor_b32 v4, 1048576, v4
s_add_u32 s38, s38, 1
s_add_u32 s65, s65, 1
s_add_u32 s66, s66, 1
s_waitcnt vmcnt(10)
v_cmp_gt_u32 vcc, s38, v9
s_nop 0
s_cbranch_vccnz L_slow23
L_ret23:
s_barrier
v_mov_b32 v11, s65
s_and_b32 s61, s38, 3
s_cselect_b32 s61, 1, -3
s_mul_i32 s61, s61, 18432
s_add_u32 s48, s48, s61
s_xor_b32 s51, s51, 0x8000
s_add_u32 s44, s48, s49
ds_read_b128 v[112:115], v2 offset:0
ds_read_b128 v[116:119], v2 offset:1024
ds_read_b128 v[120:123], v2 offset:2048
ds_read_b128 v[12:15], v2 offset:0
ds_read_b128 v[148:151], v2 offset:1024
s_waitcnt lgkmcnt(4)
v_mfma_f32_32x32x16_bf16 v[16:31], v[112:115], a[0:3], 0
v_mfma_f32_32x32x16_bf16 v[32:47], v[112:115], a[72:75], 0
v_mfma_f32_32x32x16_bf16 v[48:63], v[112:115], a[144:147], 0
v_mfma_f32_32x32x16_bf16 v[64:79], v[112:115], a[216:219], 0
ds_read_b128 v[112:115], v2 offset:3072
s_waitcnt vmcnt(0)
s_cmp_eq_u32 s36, 0
s_cbranch_scc1 L_slow24
L_ret24:
buffer_store_dword v11, v7, s[4:7], s55 offen
s_waitcnt lgkmcnt(4)
v_mfma_f32_32x32x16_bf16 v[16:31], v[116:119], a[4:7], v[16:31]
v_mfma_f32_32x32x16_bf16 v[32:47], v[116:119], a[76:79], v[32:47]
v_mfma_f32_32x32x16_bf16 v[48:63], v[116:119], a[148:151], v[48:63]
v_mfma_f32_32x32x16_bf16 v[64:79], v[116:119], a[220:223], v[64:79]
ds_read_b128 v[116:119], v2 offset:4096
s_waitcnt lgkmcnt(4)
v_mfma_f32_32x32x16_bf16 v[16:31], v[120:123], a[8:11], v[16:31]
v_mfma_f32_32x32x16_bf16 v[32:47], v[120:123], a[80:83], v[32:47]
v_mfma_f32_32x32x16_bf16 v[48:63], v[120:123], a[152:155], v[48:63]
v_mfma_f32_32x32x16_bf16 v[64:79], v[120:123], a[224:227], v[64:79]
ds_read_b128 v[120:123], v2 offset:5120
s_waitcnt lgkmcnt(2)
v_mfma_f32_32x32x16_bf16 v[16:31], v[112:115], a[12:15], v[16:31]
v_mfma_f32_32x32x16_bf16 v[32:47], v[112:115], a[84:87], v[32:47]
v_mfma_f32_32x32x16_bf16 v[48:63], v[112:115], a[156:159], v[48:63]
v_mfma_f32_32x32x16_bf16 v[64:79], v[112:115], a[228:231], v[64:79]
ds_read_b128 v[112:115], v2 offset:6144
s_waitcnt lgkmcnt(2)
v_mfma_f32_32x32x16_bf16 v[16:31], v[116:119], a[16:19], v[16:31]
v_mfma_f32_32x32x16_bf16 v[32:47], v[116:119], a[88:91], v[32:47]
v_mfma_f32_32x32x16_bf16 v[48:63], v[116:119], a[160:163], v[48:63]
v_mfma_f32_32x32x16_bf16 v[64:79], v[116:119], a[232:235], v[64:79]
ds_read_b128 v[116:119], v2 offset:7168
buffer_load_dword v10, v5, s[4:7], s54 offen sc1
s_waitcnt lgkmcnt(2)
v_mfma_f32_32x32x16_bf16 v[16:31], v[120:123], a[20:23], v[16:31]
v_mfma_f32_32x32x16_bf16 v[32:47], v[120:123], a[92:95], v[32:47]
v_mfma_f32_32x32x16_bf16 v[48:63], v[120:123], a[164:167], v[48:63]
v_mfma_f32_32x32x16_bf16 v[64:79], v[120:123], a[236:239], v[64:79]
ds_read_b128 v[120:123], v2 offset:8192
s_waitcnt lgkmcnt(2)
v_mfma_f32_32x32x16_bf16 v[16:31], v[112:115], a[24:27], v[16:31]
v_mfma_f32_32x32x16_bf16 v[32:47], v[112:115], a[96:99], v[32:47]
v_mfma_f32_32x32x16_bf16 v[48:63], v[112:115], a[168:171], v[48:63]
v_mfma_f32_32x32x16_bf16 v[64:79], v[112:115], a[240:243], v[64:79]
ds_read_b128 v[112:115], v2 offset:9216
s_waitcnt lgkmcnt(2)
v_mfma_f32_32x32x16_bf16 v[16:31], v[116:119], a[28:31], v[16:31]
v_mfma_f32_32x32x16_bf16 v[32:47], v[116:119], a[100:103], v[32:47]
s_waitcnt vmcnt(0)
v_cmp_gt_u32 vcc, s65, v10
s_nop 0
s_cbranch_vccnz L_slow25
L_ret25:
v_mfma_f32_32x32x16_bf16 v[48:63], v[116:119], a[172:175], v[48:63]
v_mfma_f32_32x32x16_bf16 v[64:79], v[116:119], a[244:247], v[64:79]
ds_read_b128 v[116:119], v2 offset:10240
s_waitcnt lgkmcnt(2)
v_mfma_f32_32x32x16_bf16 v[16:31], v[120:123], a[32:35], v[16:31]
v_mfma_f32_32x32x16_bf16 v[32:47], v[120:123], a[104:107], v[32:47]
v_mfma_f32_32x32x16_bf16 v[48:63], v[120:123], a[176:179], v[48:63]
v_mfma_f32_32x32x16_bf16 v[64:79], v[120:123], a[248:251], v[64:79]
ds_read_b128 v[120:123], v2 offset:11264
s_waitcnt lgkmcnt(2)
v_mfma_f32_32x32x16_bf16 v[16:31], v[112:115], a[36:39], v[16:31]
v_mfma_f32_32x32x16_bf16 v[32:47], v[112:115], a[108:111], v[32:47]
v_mfma_f32_32x32x16_bf16 v[48:63], v[112:115], a[180:183], v[48:63]
v_mfma_f32_32x32x16_bf16 v[64:79], v[112:115], a[252:255], v[64:79]
ds_read_b128 v[112:115], v2 offset:12288
s_waitcnt lgkmcnt(2)
v_mfma_f32_32x32x16_bf16 v[16:31], v[116:119], a[40:43], v[16:31]
v_mfma_f32_32x32x16_bf16 v[32:47], v[116:119], a[112:115], v[32:47]
v_mfma_f32_32x32x16_bf16 v[48:63], v[116:119], a[184:187], v[48:63]
v_mfma_f32_32x32x16_bf16 v[64:79], v[116:119], v[152:155], v[64:79]
ds_read_b128 v[116:119], v2 offset:13312
s_waitcnt lgkmcnt(2)
v_mfma_f32_32x32x16_bf16 v[16:31], v[120:123], a[44:47], v[16:31]
v_mfma_f32_32x32x16_bf16 v[32:47], v[120:123], a[116:119], v[32:47]
v_mfma_f32_32x32x16_bf16 v[48:63], v[120:123], a[188:191], v[48:63]
v_mfma_f32_32x32x16_bf16 v[64:79], v[120:123], v[156:159], v[64:79]
ds_read_b128 v[120:123], v2 offset:14336
s_waitcnt lgkmcnt(2)
v_mfma_f32_32x32x16_bf16 v[16:31], v[112:115], a[48:51], v[16:31]
v_mfma_f32_32x32x16_bf16 v[32:47], v[112:115], a[120:123], v[32:47]
v_mfma_f32_32x32x16_bf16 v[48:63], v[112:115], a[192:195], v[48:63]
v_mfma_f32_32x32x16_bf16 v[64:79], v[112:115], v[160:163], v[64:79]
ds_read_b128 v[112:115], v2 offset:15360
s_waitcnt lgkmcnt(2)
v_mfma_f32_32x32x16_bf16 v[16:31], v[116:119], a[52:55], v[16:31]
v_mfma_f32_32x32x16_bf16 v[32:47], v[116:119], a[124:127], v[32:47]
v_mfma_f32_32x32x16_bf16 v[48:63], v[116:119], a[196:199], v[48:63]
v_mfma_f32_32x32x16_bf16 v[64:79], v[116:119], v[164:167], v[64:79]
ds_read_b128 v[116:119], v2 offset:16384
s_waitcnt lgkmcnt(2)
v_mfma_f32_32x32x16_bf16 v[16:31], v[120:123], a[56:59], v[16:31]
buffer_load_dword v9, v8, s[4:7], s53 offen sc1
v_mfma_f32_32x32x16_bf16 v[32:47], v[120:123], a[128:131], v[32:47]
v_mfma_f32_32x32x16_bf16 v[48:63], v[120:123], a[200:203], v[48:63]
v_mfma_f32_32x32x16_bf16 v[64:79], v[120:123], v[168:171], v[64:79]
ds_read_b128 v[120:123], v2 offset:17408
s_waitcnt lgkmcnt(2)
v_mfma_f32_32x32x16_bf16 v[16:31], v[112:115], a[60:63], v[16:31]
v_mfma_f32_32x32x16_bf16 v[32:47], v[112:115], a[132:135], v[32:47]
v_mfma_f32_32x32x16_bf16 v[48:63], v[112:115], a[204:207], v[48:63]
v_mfma_f32_32x32x16_bf16 v[64:79], v[112:115], v[172:175], v[64:79]
ds_read_b128 v[112:115], v2 offset:2048
s_waitcnt lgkmcnt(2)
v_mfma_f32_32x32x16_bf16 v[16:31], v[116:119], a[64:67], v[16:31]
v_mfma_f32_32x32x16_bf16 v[32:47], v[116:119], a[136:139], v[32:47]
v_mfma_f32_32x32x16_bf16 v[48:63], v[116:119], a[208:211], v[48:63]
s_waitcnt vmcnt(0)
s_mov_b32 m0, s51
s_nop 0
buffer_load_dwordx4 v1, s[4:7], s48 offen offset:0 sc1 lds
v_mfma_f32_32x32x16_bf16 v[64:79], v[116:119], v[176:179], v[64:79]
ds_read_b128 v[116:119], v2 offset:3072
s_mov_b32 m0, s51
s_nop 0
buffer_load_dwordx4 v1, s[4:7], s48 offen offset:1024 sc1 lds
s_waitcnt lgkmcnt(2)
v_mfma_f32_32x32x16_bf16 v[16:31], v[120:123], a[68:71], v[16:31]
v_mfma_f32_32x32x16_bf16 v[32:47], v[120:123], a[140:143], v[32:47]
s_mov_b32 m0, s51
s_nop 0
buffer_load_dwordx4 v1, s[4:7], s48 offen offset:2048 sc1 lds
v_mfma_f32_32x32x16_bf16 v[48:63], v[120:123], a[212:215], v[48:63]
s_mov_b32 m0, s51
s_nop 0
buffer_load_dwordx4 v1, s[4:7], s48 offen offset:3072 sc1 lds
v_mfma_f32_32x32x16_bf16 v[64:79], v[120:123], v[180:183], v[64:79]
ds_read_b128 v[120:123], v2 offset:4096
v_cvt_pk_bf16_f32 v80, v16, v32
v_cvt_pk_bf16_f32 v82, v18, v34
v_cvt_pk_bf16_f32 v84, v17, v33
v_cvt_pk_bf16_f32 v86, v19, v35
v_permlane16_swap_b32 v80, v82
v_mfma_f32_32x32x16_bf16 v[124:139], v[184:187], v[12:15], 0
s_add_u32 m0, s51, s49
s_nop 0
buffer_load_dwordx4 v1, s[4:7], s44 offen sc1 lds
ds_read_b128 v[12:15], v2 offset:5120
s_nop 0
v_cvt_pk_bf16_f32 v81, v48, v64
v_mfma_f32_32x32x16_bf16 v[124:139], v[188:191], v[148:151], v[124:139]
ds_read_b128 v[148:151], v2 offset:6144
v_cvt_pk_bf16_f32 v83, v50, v66
v_cvt_pk_bf16_f32 v85, v49, v65
v_cvt_pk_bf16_f32 v87, v51, v67
v_permlane16_swap_b32 v81, v83
s_waitcnt lgkmcnt(4)
v_mfma_f32_32x32x16_bf16 v[124:139], v[192:195], v[112:115], v[124:139]
ds_read_b128 v[112:115], v2 offset:7168
buffer_store_dwordx4 v[80:83], v3, s[4:7], s57 offen offset:0
v_permlane16_swap_b32 v84, v86
s_waitcnt lgkmcnt(4)
v_mfma_f32_32x32x16_bf16 v[124:139], v[196:199], v[116:119], v[124:139]
ds_read_b128 v[116:119], v2 offset:8192
v_permlane16_swap_b32 v85, v87
v_cvt_pk_bf16_f32 v88, v20, v36
v_cvt_pk_bf16_f32 v90, v22, v38
s_waitcnt lgkmcnt(4)
v_mfma_f32_32x32x16_bf16 v[124:139], v[200:203], v[120:123], v[124:139]
ds_read_b128 v[120:123], v2 offset:9216
buffer_store_dwordx4 v[84:87], v3, s[4:7], s57 offen offset:1152
v_cvt_pk_bf16_f32 v89, v52, v68
v_cvt_pk_bf16_f32 v91, v54, v70
v_permlane16_swap_b32 v88, v90
s_nop 0
v_permlane16_swap_b32 v89, v91
s_waitcnt lgkmcnt(4)
v_mfma_f32_32x32x16_bf16 v[124:139], v[204:207], v[12:15], v[124:139]
ds_read_b128 v[12:15], v2 offset:10240
v_cvt_pk_bf16_f32 v92, v21, v37
v_cvt_pk_bf16_f32 v94, v23, v39
v_cvt_pk_bf16_f32 v93, v53, v69
v_cvt_pk_bf16_f32 v95, v55, v71
s_waitcnt lgkmcnt(4)
v_mfma_f32_32x32x16_bf16 v[124:139], v[208:211], v[148:151], v[124:139]
ds_read_b128 v[148:151], v2 offset:11264
buffer_store_dwordx4 v[88:91], v3, s[4:7], s58 offen offset:0
v_permlane16_swap_b32 v92, v94
s_waitcnt lgkmcnt(4)
v_mfma_f32_32x32x16_bf16 v[124:139], v[212:215], v[112:115], v[124:139]
ds_read_b128 v[112:115], v2 offset:12288
v_permlane16_swap_b32 v93, v95
v_cvt_pk_bf16_f32 v96, v24, v40
v_cvt_pk_bf16_f32 v98, v26, v42
s_waitcnt lgkmcnt(4)
v_mfma_f32_32x32x16_bf16 v[124:139], v[216:219], v[116:119], v[124:139]
ds_read_b128 v[116:119], v2 offset:13312
buffer_store_dwordx4 v[92:95], v3, s[4:7], s58 offen offset:1152
v_cvt_pk_bf16_f32 v97, v56, v72
v_cvt_pk_bf16_f32 v99, v58, v74
s_waitcnt lgkmcnt(4)
v_mfma_f32_32x32x16_bf16 v[124:139], v[220:223], v[120:123], v[124:139]
ds_read_b128 v[120:123], v2 offset:14336
v_permlane16_swap_b32 v96, v98
v_permlane16_swap_b32 v97, v99
v_cvt_pk_bf16_f32 v100, v25, v41
s_waitcnt lgkmcnt(4)
v_mfma_f32_32x32x16_bf16 v[124:139], v[224:227], v[12:15], v[124:139]
ds_read_b128 v[12:15], v2 offset:15360
buffer_store_dwordx4 v[96:99], v3, s[4:7], s59 offen offset:0
v_cvt_pk_bf16_f32 v102, v27, v43
v_cvt_pk_bf16_f32 v101, v57, v73
s_waitcnt lgkmcnt(4)
v_mfma_f32_32x32x16_bf16 v[124:139], v[228:231], v[148:151], v[124:139]
ds_read_b128 v[148:151], v2 offset:16384
v_cvt_pk_bf16_f32 v103, v59, v75
v_permlane16_swap_b32 v100, v102
s_nop 0
v_permlane16_swap_b32 v101, v103
s_waitcnt lgkmcnt(4)
v_mfma_f32_32x32x16_bf16 v[124:139], v[232:235], v[112:115], v[124:139]
ds_read_b128 v[112:115], v2 offset:17408
buffer_store_dwordx4 v[100:103], v3, s[4:7], s59 offen offset:1152
v_cvt_pk_bf16_f32 v104, v28, v44
v_cvt_pk_bf16_f32 v106, v30, v46
s_waitcnt lgkmcnt(4)
v_mfma_f32_32x32x16_bf16 v[124:139], v[236:239], v[116:119], v[124:139]
v_cvt_pk_bf16_f32 v105, v60, v76
v_cvt_pk_bf16_f32 v107, v62, v78
v_permlane16_swap_b32 v104, v106
s_nop 0
v_permlane16_swap_b32 v105, v107
s_waitcnt lgkmcnt(3)
v_mfma_f32_32x32x16_bf16 v[124:139], v[240:243], v[120:123], v[124:139]
buffer_store_dwordx4 v[104:107], v3, s[4:7], s60 offen offset:0
v_cvt_pk_bf16_f32 v108, v29, v45
v_cvt_pk_bf16_f32 v110, v31, v47
v_cvt_pk_bf16_f32 v109, v61, v77
s_waitcnt lgkmcnt(2)
v_mfma_f32_32x32x16_bf16 v[124:139], v[244:247], v[12:15], v[124:139]
v_cvt_pk_bf16_f32 v111, v63, v79
v_permlane16_swap_b32 v108, v110
s_nop 0
v_permlane16_swap_b32 v109, v111
s_waitcnt lgkmcnt(1)
v_mfma_f32_32x32x16_bf16 v[124:139], v[248:251], v[148:151], v[124:139]
buffer_store_dwordx4 v[108:111], v3, s[4:7], s60 offen offset:1152
v_xor_b32 v2, 0x8000, v2
v_xor_b32 v3, 1048576, v3
s_waitcnt lgkmcnt(0)
v_mfma_f32_32x32x16_bf16 v[124:139], v[252:255], v[112:115], v[124:139]
s_nop 11
v_cvt_pk_bf16_f32 v140, v124, v126
v_cvt_pk_bf16_f32 v141, v128, v130
v_cvt_pk_bf16_f32 v142, v125, v127
v_cvt_pk_bf16_f32 v143, v129, v131
v_cvt_pk_bf16_f32 v144, v132, v134
buffer_store_dwordx4 v[140:143], v4, s[4:7], s57 offen offset:1024
v_cvt_pk_bf16_f32 v145, v136, v138
v_cvt_pk_bf16_f32 v146, v133, v135
v_cvt_pk_bf16_f32 v147, v137, v139
buffer_store_dwordx4 v[144:147], v4, s[4:7], s57 offen offset:1056
v_xor_b32 v4, 1048576, v4
s_add_u32 s38, s38, 1
s_add_u32 s65, s65, 1
s_add_u32 s66, s66, 1
s_waitcnt vmcnt(0)
L_o_loopmlo:
s_waitcnt vmcnt(10)
v_cmp_gt_u32 vcc, s38, v9
s_nop 0
s_cbranch_vccnz L_slow26
L_ret26:
s_barrier
v_mov_b32 v11, s65
s_xor_b32 s51, s51, 0x8000
s_and_b32 s61, s38, 3
s_cselect_b32 s61, 1, -3
s_mul_i32 s61, s61, 18432
s_add_u32 s48, s48, s61
s_add_u32 s44, s48, s49
ds_read_b128 v[112:115], v2 offset:0
ds_read_b128 v[116:119], v2 offset:1024
ds_read_b128 v[120:123], v2 offset:2048
ds_read_b128 v[12:15], v2 offset:0
ds_read_b128 v[148:151], v2 offset:1024
s_waitcnt lgkmcnt(4)
v_mfma_f32_32x32x16_bf16 v[16:31], v[112:115], a[0:3], 0
v_mfma_f32_32x32x16_bf16 v[32:47], v[112:115], a[72:75], 0
v_mfma_f32_32x32x16_bf16 v[48:63], v[112:115], a[144:147], 0
v_mfma_f32_32x32x16_bf16 v[64:79], v[112:115], a[216:219], 0
ds_read_b128 v[112:115], v2 offset:3072
s_waitcnt vmcnt(0)
s_cmp_eq_u32 s36, 0
s_cbranch_scc1 L_slow27
L_ret27:
buffer_store_dword v11, v7, s[4:7], s55 offen
s_waitcnt lgkmcnt(4)
v_mfma_f32_32x32x16_bf16 v[16:31], v[116:119], a[4:7], v[16:31]
v_mfma_f32_32x32x16_bf16 v[32:47], v[116:119], a[76:79], v[32:47]
v_mfma_f32_32x32x16_bf16 v[48:63], v[116:119], a[148:151], v[48:63]
v_mfma_f32_32x32x16_bf16 v[64:79], v[116:119], a[220:223], v[64:79]
ds_read_b128 v[116:119], v2 offset:4096
s_waitcnt lgkmcnt(4)
v_mfma_f32_32x32x16_bf16 v[16:31], v[120:123], a[8:11], v[16:31]
v_mfma_f32_32x32x16_bf16 v[32:47], v[120:123], a[80:83], v[32:47]
v_mfma_f32_32x32x16_bf16 v[48:63], v[120:123], a[152:155], v[48:63]
s_waitcnt lgkmcnt(1)
v_mfma_f32_32x32x16_bf16 v[16:31], v[112:115], a[12:15], v[16:31]
v_mfma_f32_32x32x16_bf16 v[64:79], v[120:123], a[224:227], v[64:79]
ds_read_b128 v[120:123], v2 offset:5120
v_mfma_f32_32x32x16_bf16 v[32:47], v[112:115], a[84:87], v[32:47]
v_mfma_f32_32x32x16_bf16 v[48:63], v[112:115], a[156:159], v[48:63]
s_waitcnt lgkmcnt(1)
v_mfma_f32_32x32x16_bf16 v[16:31], v[116:119], a[16:19], v[16:31]
v_mfma_f32_32x32x16_bf16 v[64:79], v[112:115], a[228:231], v[64:79]
ds_read_b128 v[112:115], v2 offset:6144
v_mfma_f32_32x32x16_bf16 v[32:47], v[116:119], a[88:91], v[32:47]
v_mfma_f32_32x32x16_bf16 v[48:63], v[116:119], a[160:163], v[48:63]
v_mfma_f32_32x32x16_bf16 v[64:79], v[116:119], a[232:235], v[64:79]
ds_read_b128 v[116:119], v2 offset:7168
buffer_load_dword v10, v5, s[4:7], s54 offen sc1
s_waitcnt lgkmcnt(2)
v_mfma_f32_32x32x16_bf16 v[16:31], v[120:123], a[20:23], v[16:31]
v_mfma_f32_32x32x16_bf16 v[32:47], v[120:123], a[92:95], v[32:47]
v_mfma_f32_32x32x16_bf16 v[48:63], v[120:123], a[164:167], v[48:63]
v_mfma_f32_32x32x16_bf16 v[64:79], v[120:123], a[236:239], v[64:79]
ds_read_b128 v[120:123], v2 offset:8192
s_waitcnt lgkmcnt(2)
v_mfma_f32_32x32x16_bf16 v[16:31], v[112:115], a[24:27], v[16:31]
v_mfma_f32_32x32x16_bf16 v[32:47], v[112:115], a[96:99], v[32:47]
v_mfma_f32_32x32x16_bf16 v[48:63], v[112:115], a[168:171], v[48:63]
v_mfma_f32_32x32x16_bf16 v[64:79], v[112:115], a[240:243], v[64:79]
ds_read_b128 v[112:115], v2 offset:9216
s_waitcnt lgkmcnt(2)
v_mfma_f32_32x32x16_bf16 v[16:31], v[116:119], a[28:31], v[16:31]
v_mfma_f32_32x32x16_bf16 v[32:47], v[116:119], a[100:103], v[32:47]
s_waitcnt vmcnt(0)
v_cmp_gt_u32 vcc, s65, v10
s_nop 0
s_cbranch_vccnz L_slow28
L_ret28:
v_mfma_f32_32x32x16_bf16 v[48:63], v[116:119], a[172:175], v[48:63]
v_mfma_f32_32x32x16_bf16 v[64:79], v[116:119], a[244:247], v[64:79]
ds_read_b128 v[116:119], v2 offset:10240
s_waitcnt lgkmcnt(2)
v_mfma_f32_32x32x16_bf16 v[16:31], v[120:123], a[32:35], v[16:31]
v_mfma_f32_32x32x16_bf16 v[32:47], v[120:123], a[104:107], v[32:47]
v_mfma_f32_32x32x16_bf16 v[48:63], v[120:123], a[176:179], v[48:63]
v_mfma_f32_32x32x16_bf16 v[64:79], v[120:123], a[248:251], v[64:79]
ds_read_b128 v[120:123], v2 offset:11264
s_waitcnt lgkmcnt(2)
v_mfma_f32_32x32x16_bf16 v[16:31], v[112:115], a[36:39], v[16:31]
v_mfma_f32_32x32x16_bf16 v[32:47], v[112:115], a[108:111], v[32:47]
v_mfma_f32_32x32x16_bf16 v[48:63], v[112:115], a[180:183], v[48:63]
v_mfma_f32_32x32x16_bf16 v[64:79], v[112:115], a[252:255], v[64:79]
ds_read_b128 v[112:115], v2 offset:12288
s_waitcnt lgkmcnt(2)
v_mfma_f32_32x32x16_bf16 v[32:47], v[116:119], a[112:115], v[32:47]
v_mfma_f32_32x32x16_bf16 v[16:31], v[116:119], a[40:43], v[16:31]
v_mfma_f32_32x32x16_bf16 v[48:63], v[116:119], a[184:187], v[48:63]
v_mfma_f32_32x32x16_bf16 v[64:79], v[116:119], v[152:155], v[64:79]
ds_read_b128 v[116:119], v2 offset:13312
s_waitcnt lgkmcnt(2)
v_mfma_f32_32x32x16_bf16 v[16:31], v[120:123], a[44:47], v[16:31]
v_mfma_f32_32x32x16_bf16 v[32:47], v[120:123], a[116:119], v[32:47]
v_mfma_f32_32x32x16_bf16 v[48:63], v[120:123], a[188:191], v[48:63]
v_mfma_f32_32x32x16_bf16 v[64:79], v[120:123], v[156:159], v[64:79]
ds_read_b128 v[120:123], v2 offset:14336
s_waitcnt lgkmcnt(2)
v_mfma_f32_32x32x16_bf16 v[16:31], v[112:115], a[48:51], v[16:31]
v_mfma_f32_32x32x16_bf16 v[32:47], v[112:115], a[120:123], v[32:47]
v_mfma_f32_32x32x16_bf16 v[48:63], v[112:115], a[192:195], v[48:63]
v_mfma_f32_32x32x16_bf16 v[64:79], v[112:115], v[160:163], v[64:79]
ds_read_b128 v[112:115], v2 offset:15360
s_waitcnt lgkmcnt(2)
v_mfma_f32_32x32x16_bf16 v[16:31], v[116:119], a[52:55], v[16:31]
v_mfma_f32_32x32x16_bf16 v[32:47], v[116:119], a[124:127], v[32:47]
v_mfma_f32_32x32x16_bf16 v[48:63], v[116:119], a[196:199], v[48:63]
v_mfma_f32_32x32x16_bf16 v[64:79], v[116:119], v[164:167], v[64:79]
ds_read_b128 v[116:119], v2 offset:16384
s_waitcnt lgkmcnt(2)
v_mfma_f32_32x32x16_bf16 v[16:31], v[120:123], a[56:59], v[16:31]
buffer_load_dword v9, v8, s[4:7], s53 offen sc1
v_mfma_f32_32x32x16_bf16 v[32:47], v[120:123], a[128:131], v[32:47]
v_mfma_f32_32x32x16_bf16 v[48:63], v[120:123], a[200:203], v[48:63]
v_mfma_f32_32x32x16_bf16 v[64:79], v[120:123], v[168:171], v[64:79]
ds_read_b128 v[120:123], v2 offset:17408
s_waitcnt lgkmcnt(2)
v_mfma_f32_32x32x16_bf16 v[16:31], v[112:115], a[60:63], v[16:31]
v_mfma_f32_32x32x16_bf16 v[32:47], v[112:115], a[132:135], v[32:47]
v_mfma_f32_32x32x16_bf16 v[48:63], v[112:115], a[204:207], v[48:63]
v_mfma_f32_32x32x16_bf16 v[64:79], v[112:115], v[172:175], v[64:79]
ds_read_b128 v[112:115], v2 offset:2048
s_waitcnt lgkmcnt(2)
v_mfma_f32_32x32x16_bf16 v[16:31], v[116:119], a[64:67], v[16:31]
v_mfma_f32_32x32x16_bf16 v[32:47], v[116:119], a[136:139], v[32:47]
v_mfma_f32_32x32x16_bf16 v[48:63], v[116:119], a[208:211], v[48:63]
s_waitcnt vmcnt(0)
s_mov_b32 m0, s51
s_nop 0
buffer_load_dwordx4 v1, s[4:7], s48 offen offset:0 sc1 lds
v_mfma_f32_32x32x16_bf16 v[64:79], v[116:119], v[176:179], v[64:79]
ds_read_b128 v[116:119], v2 offset:3072
s_mov_b32 m0, s51
s_nop 0
buffer_load_dwordx4 v1, s[4:7], s48 offen offset:1024 sc1 lds
s_waitcnt lgkmcnt(2)
v_mfma_f32_32x32x16_bf16 v[16:31], v[120:123], a[68:71], v[16:31]
v_mfma_f32_32x32x16_bf16 v[32:47], v[120:123], a[140:143], v[32:47]
s_mov_b32 m0, s51
s_nop 0
buffer_load_dwordx4 v1, s[4:7], s48 offen offset:2048 sc1 lds
v_mfma_f32_32x32x16_bf16 v[48:63], v[120:123], a[212:215], v[48:63]
s_nop 3
v_cvt_pk_bf16_f32 v82, v18, v34
s_mov_b32 m0, s51
s_nop 0
buffer_load_dwordx4 v1, s[4:7], s48 offen offset:3072 sc1 lds
v_mfma_f32_32x32x16_bf16 v[64:79], v[120:123], v[180:183], v[64:79]
ds_read_b128 v[120:123], v2 offset:4096
v_cvt_pk_bf16_f32 v80, v16, v32
v_cvt_pk_bf16_f32 v86, v19, v35
v_cvt_pk_bf16_f32 v84, v17, v33
v_permlane16_swap_b32 v80, v82
v_mfma_f32_32x32x16_bf16 v[124:139], v[184:187], v[12:15], 0
s_add_u32 m0, s51, s49
s_nop 0
buffer_load_dwordx4 v1, s[4:7], s44 offen sc1 lds
ds_read_b128 v[12:15], v2 offset:5120
s_nop 0
v_cvt_pk_bf16_f32 v83, v50, v66
v_mfma_f32_32x32x16_bf16 v[124:139], v[188:191], v[148:151], v[124:139]
ds_read_b128 v[148:151], v2 offset:6144
v_cvt_pk_bf16_f32 v81, v48, v64
v_permlane16_swap_b32 v84, v86
s_nop 0
v_permlane16_swap_b32 v81, v83
s_waitcnt lgkmcnt(4)
v_mfma_f32_32x32x16_bf16 v[124:139], v[192:195], v[112:115], v[124:139]
ds_read_b128 v[112:115], v2 offset:7168
buffer_store_dwordx4 v[80:83], v3, s[4:7], s57 offen offset:0
v_cvt_pk_bf16_f32 v87, v51, v67
v_cvt_pk_bf16_f32 v85, v49, v65
s_waitcnt lgkmcnt(4)
v_mfma_f32_32x32x16_bf16 v[124:139], v[196:199], v[116:119], v[124:139]
ds_read_b128 v[116:119], v2 offset:8192
v_permlane16_swap_b32 v85, v87
v_cvt_pk_bf16_f32 v88, v20, v36
v_cvt_pk_bf16_f32 v90, v22, v38
s_waitcnt lgkmcnt(4)
v_mfma_f32_32x32x16_bf16 v[124:139], v[200:203], v[120:123], v[124:139]
ds_read_b128 v[120:123], v2 offset:9216
buffer_store_dwordx4 v[84:87], v3, s[4:7], s57 offen offset:1152
v_cvt_pk_bf16_f32 v89, v52, v68
v_cvt_pk_bf16_f32 v91, v54, v70
v_permlane16_swap_b32 v88, v90
s_nop 0
v_permlane16_swap_b32 v89, v91
s_waitcnt lgkmcnt(4)
v_mfma_f32_32x32x16_bf16 v[124:139], v[204:207], v[12:15], v[124:139]
ds_read_b128 v[12:15], v2 offset:10240
v_cvt_pk_bf16_f32 v94, v23, v39
v_cvt_pk_bf16_f32 v92, v21, v37
v_cvt_pk_bf16_f32 v95, v55, v71
v_cvt_pk_bf16_f32 v93, v53, v69
s_waitcnt lgkmcnt(4)
v_mfma_f32_32x32x16_bf16 v[124:139], v[208:211], v[148:151], v[124:139]
ds_read_b128 v[148:151], v2 offset:11264
buffer_store_dwordx4 v[88:91], v3, s[4:7], s58 offen offset:0
v_permlane16_swap_b32 v93, v95
s_waitcnt lgkmcnt(4)
v_mfma_f32_32x32x16_bf16 v[124:139], v[212:215], v[112:115], v[124:139]
ds_read_b128 v[112:115], v2 offset:12288
v_permlane16_swap_b32 v92, v94
v_cvt_pk_bf16_f32 v96, v24, v40
v_cvt_pk_bf16_f32 v97, v56, v72
s_waitcnt lgkmcnt(4)
v_mfma_f32_32x32x16_bf16 v[124:139], v[216:219], v[116:119], v[124:139]
ds_read_b128 v[116:119], v2 offset:13312
buffer_store_dwordx4 v[92:95], v3, s[4:7], s58 offen offset:1152
v_cvt_pk_bf16_f32 v98, v26, v42
v_cvt_pk_bf16_f32 v99, v58, v74
s_waitcnt lgkmcnt(4)
v_mfma_f32_32x32x16_bf16 v[124:139], v[220:223], v[120:123], v[124:139]
ds_read_b128 v[120:123], v2 offset:14336
v_permlane16_swap_b32 v96, v98
v_permlane16_swap_b32 v97, v99
v_cvt_pk_bf16_f32 v101, v57, v73
s_waitcnt lgkmcnt(4)
v_mfma_f32_32x32x16_bf16 v[124:139], v[224:227], v[12:15], v[124:139]
ds_read_b128 v[12:15], v2 offset:15360
buffer_store_dwordx4 v[96:99], v3, s[4:7], s59 offen offset:0
v_cvt_pk_bf16_f32 v100, v25, v41
v_cvt_pk_bf16_f32 v103, v59, v75
s_waitcnt lgkmcnt(4)
v_mfma_f32_32x32x16_bf16 v[124:139], v[228:231], v[148:151], v[124:139]
ds_read_b128 v[148:151], v2 offset:16384
v_cvt_pk_bf16_f32 v102, v27, v43
v_permlane16_swap_b32 v101, v103
s_nop 0
v_permlane16_swap_b32 v100, v102
s_waitcnt lgkmcnt(4)
v_mfma_f32_32x32x16_bf16 v[124:139], v[232:235], v[112:115], v[124:139]
ds_read_b128 v[112:115], v2 offset:17408
buffer_store_dwordx4 v[100:103], v3, s[4:7], s59 offen offset:1152
v_cvt_pk_bf16_f32 v104, v28, v44
v_cvt_pk_bf16_f32 v107, v62, v78
s_waitcnt lgkmcnt(4)
v_mfma_f32_32x32x16_bf16 v[124:139], v[236:239], v[116:119], v[124:139]
v_cvt_pk_bf16_f32 v105, v60, v76
v_cvt_pk_bf16_f32 v106, v30, v46
v_cvt_pk_bf16_f32 v108, v29, v45
v_permlane16_swap_b32 v105, v107
s_waitcnt lgkmcnt(3)
v_mfma_f32_32x32x16_bf16 v[124:139], v[240:243], v[120:123], v[124:139]
v_permlane16_swap_b32 v104, v106
buffer_store_dwordx4 v[104:107], v3, s[4:7], s60 offen offset:0
v_cvt_pk_bf16_f32 v109, v61, v77
s_waitcnt lgkmcnt(2)
v_mfma_f32_32x32x16_bf16 v[124:139], v[244:247], v[12:15], v[124:139]
v_cvt_pk_bf16_f32 v110, v31, v47
v_cvt_pk_bf16_f32 v111, v63, v79
v_xor_b32 v2, 0x8000, v2
v_permlane16_swap_b32 v108, v110
s_waitcnt lgkmcnt(1)
v_mfma_f32_32x32x16_bf16 v[124:139], v[248:251], v[148:151], v[124:139]
v_permlane16_swap_b32 v109, v111
buffer_store_dwordx4 v[108:111], v3, s[4:7], s60 offen offset:1152
v_xor_b32 v3, 1048576, v3
s_waitcnt lgkmcnt(0)
v_mfma_f32_32x32x16_bf16 v[124:139], v[252:255], v[112:115], v[124:139]
s_nop 11
v_cvt_pk_bf16_f32 v140, v124, v126
v_cvt_pk_bf16_f32 v141, v128, v130
v_cvt_pk_bf16_f32 v142, v125, v127
v_cvt_pk_bf16_f32 v143, v129, v131
v_cvt_pk_bf16_f32 v146, v133, v135
buffer_store_dwordx4 v[140:143], v4, s[4:7], s57 offen offset:1024
v_cvt_pk_bf16_f32 v144, v132, v134
v_cvt_pk_bf16_f32 v147, v137, v139
v_cvt_pk_bf16_f32 v145, v136, v138
buffer_store_dwordx4 v[144:147], v4, s[4:7], s57 offen offset:1056
v_xor_b32 v4, 1048576, v4
s_add_u32 s38, s38, 1
s_add_u32 s65, s65, 1
s_add_u32 s66, s66, 1
s_cmp_le_u32 s38, 64
s_cbranch_scc1 L_o_loopmlo
v_mov_b32 v11, s65
s_waitcnt vmcnt(0)
s_cmp_eq_u32 s36, 0
s_cbranch_scc1 L_slow29
L_ret29:
buffer_store_dword v11, v7, s[4:7], s55 offen
buffer_load_dword v10, v5, s[4:7], s54 offen sc1
s_waitcnt vmcnt(0)
v_cmp_gt_u32 vcc, s65, v10
s_nop 0
s_cbranch_vccnz L_slow30
L_ret30:
s_add_u32 s38, s38, 1
s_add_u32 s65, s65, 1
s_add_u32 s66, s66, 1
s_endpgm
L_om_hi:
v_mul_u32_u24 v4, 36864, v51
v_lshl_add_u32 v4, v50, 4, v4
v_lshrrev_b32 v52, 3, v0
v_mul_u32_u24 v12, 36864, v52
v_and_b32 v52, 7, v0
v_lshl_add_u32 v12, v52, 4, v12
v_and_b32 v13, 60, v0
v_lshlrev_b32 v13, 2, v13
v_and_b32 v52, 1, v0
v_lshl_add_u32 v13, v52, 3, v13
v_bfe_u32 v53, v0, 1, 1
v_lshl_add_u32 v13, v53, 2, v13
v_bfe_u32 v53, v0, 1, 2
v_lshlrev_b32 v14, 5, v53
v_lshl_add_u32 v14, v52, 3, v14
v_lshl_add_u32 v14, v49, 4, v14
v_bfe_u32 v53, v0, 4, 1
v_lshl_add_u32 v14, v53, 2, v14
v_add_u32 v14, 1024, v14
v_bfe_u32 v52, v0, 2, 2
v_and_b32 v53, 3, v0
v_lshl_add_u32 v52, v53, 2, v52
v_and_b32 v53, 1, v52
v_lshlrev_b32 v53, 4, v53
v_mov_b32 v54, 0x3f80
v_lshlrev_b32 v53, v53, v54
v_lshrrev_b32 v52, 1, v52
v_cmp_eq_u32 vcc, 0, v52
s_nop 1
v_cndmask_b32 v124, 0, v53, vcc
v_cmp_eq_u32 vcc, 1, v52
s_nop 1
v_cndmask_b32 v125, 0, v53, vcc
v_cmp_eq_u32 vcc, 2, v52
s_nop 1
v_cndmask_b32 v126, 0, v53, vcc
v_cmp_eq_u32 vcc, 3, v52
s_nop 1
v_cndmask_b32 v127, 0, v53, vcc
s_mov_b32 s8, 0xaaaaaaaa
s_mov_b32 s9, 0xaaaaaaaa
s_and_b32 s46, s35, 1
s_or_b32 s46, s46, s34
s_cselect_b32 s40, 0, -1
s_cselect_b32 s46, 0x7ffffff0, 0
v_mov_b32 v15, s46
s_mov_b32 s67, 0
v_and_b32 v52, 60, v0
v_lshlrev_b32 v52, 2, v52
v_and_b32 v53, 3, v0
v_lshl_add_u32 v52, v53, 1, v52
buffer_load_ushort v128, v52, s[28:31], 0 offen offset:0
buffer_load_ushort v129, v52, s[28:31], 0 offen offset:8
buffer_load_ushort v130, v52, s[28:31], 0 offen offset:256
buffer_load_ushort v131, v52, s[28:31], 0 offen offset:264
buffer_load_ushort v132, v52, s[28:31], 0 offen offset:512
buffer_load_ushort v133, v52, s[28:31], 0 offen offset:520
buffer_load_ushort v134, v52, s[28:31], 0 offen offset:768
buffer_load_ushort v135, v52, s[28:31], 0 offen offset:776
buffer_load_dword v137, v14, s[28:31], 0 offen
s_waitcnt vmcnt(8)
v_lshlrev_b32 v128, 16, v128
s_waitcnt vmcnt(7)
v_lshlrev_b32 v129, 16, v129
s_waitcnt vmcnt(6)
v_lshlrev_b32 v130, 16, v130
s_waitcnt vmcnt(5)
v_lshlrev_b32 v131, 16, v131
s_waitcnt vmcnt(4)
v_lshlrev_b32 v132, 16, v132
s_waitcnt vmcnt(3)
v_lshlrev_b32 v133, 16, v133
s_waitcnt vmcnt(2)
v_lshlrev_b32 v134, 16, v134
s_waitcnt vmcnt(1)
v_lshlrev_b32 v135, 16, v135
s_waitcnt vmcnt(0)
v_lshlrev_b32 v136, 16, v137
v_and_b32 v137, 0xffff0000, v137
v_mul_f32 v136, 0.5, v136
v_mul_f32 v137, 0.5, v137
v_mov_b32 v138, 0
v_mov_b32 v139, 0
s_and_b32 s47, s35, 1
s_lshl_b32 s47, s47, 13
s_add_u32 s47, s47, 0x10000
v_add_u32 v13, s47, v13
v_add_u32 v14, s47, v14
v_add_u32 v52, 1024, v1
v_mov_b32 v53, 0x7ffffff0
v_cmp_gt_u32 vcc, 8, v0
s_nop 1
v_cndmask_b32 v15, v53, v52, vcc
v_or_b32 v0, 8, v5
v_cmp_gt_u32 vcc, s38, v9
s_nop 0
s_cbranch_vccnz L_slow31
L_ret31:
s_barrier
buffer_load_dword v9, v8, s[4:7], s53 offen sc1
s_and_b32 s61, s38, 3
s_cselect_b32 s61, 1, -3
s_mul_i32 s61, s61, 18432
s_add_u32 s48, s48, s61
s_xor_b32 s51, s51, 0x8000
ds_read_b128 v[112:115], v2 offset:0
ds_read_b128 v[116:119], v2 offset:1024
ds_read_b128 v[120:123], v2 offset:2048
ds_read_b128 v[148:151], v2 offset:3072
s_waitcnt lgkmcnt(3)
v_mfma_f32_32x32x16_bf16 v[16:31], v[112:115], a[0:3], 0
v_mfma_f32_32x32x16_bf16 v[32:47], v[112:115], a[72:75], 0
v_mfma_f32_32x32x16_bf16 v[48:63], v[112:115], a[144:147], 0
v_mfma_f32_32x32x16_bf16 v[64:79], v[112:115], a[216:219], 0
ds_read_b128 v[112:115], v2 offset:4096
s_waitcnt vmcnt(0)
s_mov_b32 m0, s51
s_nop 0
buffer_load_dwordx4 v1, s[4:7], s48 offen offset:0 sc1 lds
s_waitcnt lgkmcnt(3)
v_mfma_f32_32x32x16_bf16 v[16:31], v[116:119], a[4:7], v[16:31]
s_mov_b32 m0, s51
s_nop 0
buffer_load_dwordx4 v1, s[4:7], s48 offen offset:1024 sc1 lds
v_mfma_f32_32x32x16_bf16 v[32:47], v[116:119], a[76:79], v[32:47]
s_mov_b32 m0, s51
s_nop 0
buffer_load_dwordx4 v1, s[4:7], s48 offen offset:2048 sc1 lds
v_mfma_f32_32x32x16_bf16 v[48:63], v[116:119], a[148:151], v[48:63]
s_mov_b32 m0, s51
s_nop 0
buffer_load_dwordx4 v1, s[4:7], s48 offen offset:3072 sc1 lds
v_mfma_f32_32x32x16_bf16 v[64:79], v[116:119], a[220:223], v[64:79]
ds_read_b128 v[116:119], v2 offset:5120
s_waitcnt lgkmcnt(3)
v_mfma_f32_32x32x16_bf16 v[16:31], v[120:123], a[8:11], v[16:31]
v_mfma_f32_32x32x16_bf16 v[32:47], v[120:123], a[80:83], v[32:47]
v_mfma_f32_32x32x16_bf16 v[48:63], v[120:123], a[152:155], v[48:63]
v_mfma_f32_32x32x16_bf16 v[64:79], v[120:123], a[224:227], v[64:79]
ds_read_b128 v[120:123], v2 offset:6144
s_waitcnt lgkmcnt(3)
v_mfma_f32_32x32x16_bf16 v[16:31], v[148:151], a[12:15], v[16:31]
v_mfma_f32_32x32x16_bf16 v[32:47], v[148:151], a[84:87], v[32:47]
v_mfma_f32_32x32x16_bf16 v[48:63], v[148:151], a[156:159], v[48:63]
v_mfma_f32_32x32x16_bf16 v[64:79], v[148:151], a[228:231], v[64:79]
ds_read_b128 v[148:151], v2 offset:7168
s_waitcnt lgkmcnt(3)
v_mfma_f32_32x32x16_bf16 v[16:31], v[112:115], a[16:19], v[16:31]
v_mfma_f32_32x32x16_bf16 v[32:47], v[112:115], a[88:91], v[32:47]
v_mfma_f32_32x32x16_bf16 v[48:63], v[112:115], a[160:163], v[48:63]
v_mfma_f32_32x32x16_bf16 v[64:79], v[112:115], a[232:235], v[64:79]
ds_read_b128 v[112:115], v2 offset:8192
s_waitcnt lgkmcnt(3)
v_mfma_f32_32x32x16_bf16 v[16:31], v[116:119], a[20:23], v[16:31]
v_mfma_f32_32x32x16_bf16 v[32:47], v[116:119], a[92:95], v[32:47]
v_mfma_f32_32x32x16_bf16 v[48:63], v[116:119], a[164:167], v[48:63]
v_mfma_f32_32x32x16_bf16 v[64:79], v[116:119], a[236:239], v[64:79]
ds_read_b128 v[116:119], v2 offset:9216
s_waitcnt lgkmcnt(3)
v_mfma_f32_32x32x16_bf16 v[16:31], v[120:123], a[24:27], v[16:31]
v_mfma_f32_32x32x16_bf16 v[32:47], v[120:123], a[96:99], v[32:47]
v_mfma_f32_32x32x16_bf16 v[48:63], v[120:123], a[168:171], v[48:63]
v_mfma_f32_32x32x16_bf16 v[64:79], v[120:123], a[240:243], v[64:79]
ds_read_b128 v[120:123], v2 offset:10240
s_waitcnt lgkmcnt(3)
v_mfma_f32_32x32x16_bf16 v[16:31], v[148:151], a[28:31], v[16:31]
v_mfma_f32_32x32x16_bf16 v[32:47], v[148:151], a[100:103], v[32:47]
v_mfma_f32_32x32x16_bf16 v[48:63], v[148:151], a[172:175], v[48:63]
v_mfma_f32_32x32x16_bf16 v[64:79], v[148:151], a[244:247], v[64:79]
ds_read_b128 v[148:151], v2 offset:11264
s_waitcnt lgkmcnt(3)
v_mfma_f32_32x32x16_bf16 v[16:31], v[112:115], a[32:35], v[16:31]
v_mfma_f32_32x32x16_bf16 v[32:47], v[112:115], a[104:107], v[32:47]
v_mfma_f32_32x32x16_bf16 v[48:63], v[112:115], a[176:179], v[48:63]
v_mfma_f32_32x32x16_bf16 v[64:79], v[112:115], a[248:251], v[64:79]
ds_read_b128 v[112:115], v2 offset:12288
s_waitcnt lgkmcnt(3)
v_mfma_f32_32x32x16_bf16 v[16:31], v[116:119], a[36:39], v[16:31]
v_mfma_f32_32x32x16_bf16 v[32:47], v[116:119], a[108:111], v[32:47]
v_mfma_f32_32x32x16_bf16 v[48:63], v[116:119], a[180:183], v[48:63]
v_mfma_f32_32x32x16_bf16 v[64:79], v[116:119], a[252:255], v[64:79]
ds_read_b128 v[116:119], v2 offset:13312
s_waitcnt lgkmcnt(3)
v_mfma_f32_32x32x16_bf16 v[16:31], v[120:123], a[40:43], v[16:31]
v_mfma_f32_32x32x16_bf16 v[32:47], v[120:123], a[112:115], v[32:47]
v_mfma_f32_32x32x16_bf16 v[48:63], v[120:123], a[184:187], v[48:63]
v_mfma_f32_32x32x16_bf16 v[64:79], v[120:123], v[152:155], v[64:79]
ds_read_b128 v[120:123], v2 offset:14336
s_waitcnt lgkmcnt(3)
v_mfma_f32_32x32x16_bf16 v[16:31], v[148:151], a[44:47], v[16:31]
v_mfma_f32_32x32x16_bf16 v[32:47], v[148:151], a[116:119], v[32:47]
v_mfma_f32_32x32x16_bf16 v[48:63], v[148:151], a[188:191], v[48:63]
v_mfma_f32_32x32x16_bf16 v[64:79], v[148:151], v[156:159], v[64:79]
ds_read_b128 v[148:151], v2 offset:15360
s_waitcnt lgkmcnt(3)
v_mfma_f32_32x32x16_bf16 v[16:31], v[112:115], a[48:51], v[16:31]
v_mfma_f32_32x32x16_bf16 v[32:47], v[112:115], a[120:123], v[32:47]
v_mfma_f32_32x32x16_bf16 v[48:63], v[112:115], a[192:195], v[48:63]
v_mfma_f32_32x32x16_bf16 v[64:79], v[112:115], v[160:163], v[64:79]
ds_read_b128 v[112:115], v2 offset:16384
s_waitcnt lgkmcnt(3)
v_mfma_f32_32x32x16_bf16 v[16:31], v[116:119], a[52:55], v[16:31]
v_mfma_f32_32x32x16_bf16 v[32:47], v[116:119], a[124:127], v[32:47]
v_mfma_f32_32x32x16_bf16 v[48:63], v[116:119], a[196:199], v[48:63]
v_mfma_f32_32x32x16_bf16 v[64:79], v[116:119], v[164:167], v[64:79]
ds_read_b128 v[116:119], v2 offset:17408
v_xor_b32 v2, 0x8000, v2
s_waitcnt lgkmcnt(3)
v_mfma_f32_32x32x16_bf16 v[16:31], v[120:123], a[56:59], v[16:31]
v_mfma_f32_32x32x16_bf16 v[32:47], v[120:123], a[128:131], v[32:47]
v_mfma_f32_32x32x16_bf16 v[48:63], v[120:123], a[200:203], v[48:63]
v_mfma_f32_32x32x16_bf16 v[64:79], v[120:123], v[168:171], v[64:79]
s_waitcnt lgkmcnt(2)
v_mfma_f32_32x32x16_bf16 v[16:31], v[148:151], a[60:63], v[16:31]
v_mfma_f32_32x32x16_bf16 v[32:47], v[148:151], a[132:135], v[32:47]
v_mfma_f32_32x32x16_bf16 v[48:63], v[148:151], a[204:207], v[48:63]
v_mfma_f32_32x32x16_bf16 v[64:79], v[148:151], v[172:175], v[64:79]
s_waitcnt lgkmcnt(1)
v_mfma_f32_32x32x16_bf16 v[16:31], v[112:115], a[64:67], v[16:31]
v_mfma_f32_32x32x16_bf16 v[32:47], v[112:115], a[136:139], v[32:47]
v_mfma_f32_32x32x16_bf16 v[48:63], v[112:115], a[208:211], v[48:63]
v_mfma_f32_32x32x16_bf16 v[64:79], v[112:115], v[176:179], v[64:79]
s_waitcnt lgkmcnt(0)
v_mfma_f32_32x32x16_bf16 v[16:31], v[116:119], a[68:71], v[16:31]
v_mfma_f32_32x32x16_bf16 v[32:47], v[116:119], a[140:143], v[32:47]
v_mfma_f32_32x32x16_bf16 v[48:63], v[116:119], a[212:215], v[48:63]
s_nop 3
v_cvt_pk_bf16_f32 v80, v16, v32
v_cvt_pk_bf16_f32 v82, v18, v34
v_cvt_pk_bf16_f32 v84, v17, v33
v_mfma_f32_32x32x16_bf16 v[64:79], v[116:119], v[180:183], v[64:79]
v_permlane16_swap_b32 v80, v82
v_cvt_pk_bf16_f32 v86, v19, v35
v_cvt_pk_bf16_f32 v88, v20, v36
v_cvt_pk_bf16_f32 v90, v22, v38
v_permlane16_swap_b32 v84, v86
s_nop 0
v_permlane16_swap_b32 v88, v90
v_cvt_pk_bf16_f32 v92, v21, v37
v_cvt_pk_bf16_f32 v94, v23, v39
s_nop 2
v_cvt_pk_bf16_f32 v81, v48, v64
v_cvt_pk_bf16_f32 v83, v50, v66
v_cvt_pk_bf16_f32 v85, v49, v65
v_cvt_pk_bf16_f32 v87, v51, v67
v_permlane16_swap_b32 v81, v83
buffer_store_dwordx4 v[80:83], v3, s[4:7], s57 offen offset:0
v_permlane16_swap_b32 v85, v87
v_cvt_pk_bf16_f32 v89, v52, v68
v_cvt_pk_bf16_f32 v91, v54, v70
v_cvt_pk_bf16_f32 v93, v53, v69
v_cvt_pk_bf16_f32 v95, v55, v71
v_permlane16_swap_b32 v89, v91
v_permlane16_swap_b32 v92, v94
buffer_store_dwordx4 v[84:87], v3, s[4:7], s57 offen offset:1152
v_permlane16_swap_b32 v93, v95
v_cvt_pk_bf16_f32 v96, v24, v40
v_cvt_pk_bf16_f32 v98, v26, v42
v_cvt_pk_bf16_f32 v97, v56, v72
v_cvt_pk_bf16_f32 v99, v58, v74
v_permlane16_swap_b32 v96, v98
s_nop 0
v_permlane16_swap_b32 v97, v99
buffer_store_dwordx4 v[88:91], v3, s[4:7], s58 offen offset:0
v_cvt_pk_bf16_f32 v100, v25, v41
v_cvt_pk_bf16_f32 v102, v27, v43
v_cvt_pk_bf16_f32 v101, v57, v73
v_cvt_pk_bf16_f32 v103, v59, v75
v_permlane16_swap_b32 v100, v102
s_nop 0
v_permlane16_swap_b32 v101, v103
v_cvt_pk_bf16_f32 v104, v28, v44
v_cvt_pk_bf16_f32 v106, v30, v46
buffer_store_dwordx4 v[92:95], v3, s[4:7], s58 offen offset:1152
v_cvt_pk_bf16_f32 v105, v60, v76
v_cvt_pk_bf16_f32 v107, v62, v78
v_permlane16_swap_b32 v104, v106
s_nop 0
v_permlane16_swap_b32 v105, v107
v_cvt_pk_bf16_f32 v108, v29, v45
v_cvt_pk_bf16_f32 v110, v31, v47
v_cvt_pk_bf16_f32 v109, v61, v77
v_cvt_pk_bf16_f32 v111, v63, v79
buffer_store_dwordx4 v[96:99], v3, s[4:7], s59 offen offset:0
v_permlane16_swap_b32 v108, v110
v_permlane16_swap_b32 v109, v111
buffer_store_dwordx4 v[100:103], v3, s[4:7], s59 offen offset:1152
buffer_store_dwordx4 v[104:107], v3, s[4:7], s60 offen offset:0
buffer_store_dwordx4 v[108:111], v3, s[4:7], s60 offen offset:1152
v_xor_b32 v3, 1048576, v3
s_add_u32 s38, s38, 1
s_add_u32 s65, s65, 1
s_add_u32 s66, s66, 1
s_waitcnt vmcnt(8)
v_cmp_gt_u32 vcc, s38, v9
s_nop 0
s_cbranch_vccnz L_slow32
L_ret32:
s_barrier
v_mov_b32 v11, s65
s_and_b32 s61, s38, 3
s_cselect_b32 s61, 1, -3
s_mul_i32 s61, s61, 18432
s_add_u32 s48, s48, s61
s_xor_b32 s51, s51, 0x8000
ds_read_b128 v[112:115], v2 offset:0
ds_read_b128 v[116:119], v2 offset:1024
s_mov_b32 m0, s47
s_nop 0
buffer_load_dwordx4 v1, s[4:7], s94 offen sc1 lds
ds_read_b128 v[120:123], v2 offset:2048
ds_read_b128 v[148:151], v2 offset:3072
s_add_u32 m0, s47, 1024
s_nop 0
buffer_load_dwordx4 v15, s[4:7], s94 offen sc1 lds
s_add_u32 s94, s94, 36864
s_waitcnt lgkmcnt(3)
v_mfma_f32_32x32x16_bf16 v[16:31], v[112:115], a[0:3], 0
v_mfma_f32_32x32x16_bf16 v[32:47], v[112:115], a[72:75], 0
v_mfma_f32_32x32x16_bf16 v[48:63], v[112:115], a[144:147], 0
v_mfma_f32_32x32x16_bf16 v[64:79], v[112:115], a[216:219], 0
ds_read_b128 v[112:115], v2 offset:4096
s_waitcnt vmcnt(2)
s_cmp_eq_u32 s36, 0
s_cbranch_scc1 L_slow33
L_ret33:
buffer_store_dword v11, v7, s[4:7], s55 offen
s_waitcnt lgkmcnt(3)
v_mfma_f32_32x32x16_bf16 v[16:31], v[116:119], a[4:7], v[16:31]
v_mfma_f32_32x32x16_bf16 v[32:47], v[116:119], a[76:79], v[32:47]
v_mfma_f32_32x32x16_bf16 v[48:63], v[116:119], a[148:151], v[48:63]
v_mfma_f32_32x32x16_bf16 v[64:79], v[116:119], a[220:223], v[64:79]
ds_read_b128 v[116:119], v2 offset:5120
s_waitcnt lgkmcnt(3)
v_mfma_f32_32x32x16_bf16 v[16:31], v[120:123], a[8:11], v[16:31]
v_mfma_f32_32x32x16_bf16 v[32:47], v[120:123], a[80:83], v[32:47]
v_mfma_f32_32x32x16_bf16 v[48:63], v[120:123], a[152:155], v[48:63]
v_mfma_f32_32x32x16_bf16 v[64:79], v[120:123], a[224:227], v[64:79]
ds_read_b128 v[120:123], v2 offset:6144
s_waitcnt lgkmcnt(3)
v_mfma_f32_32x32x16_bf16 v[16:31], v[148:151], a[12:15], v[16:31]
v_mfma_f32_32x32x16_bf16 v[32:47], v[148:151], a[84:87], v[32:47]
v_mfma_f32_32x32x16_bf16 v[48:63], v[148:151], a[156:159], v[48:63]
v_mfma_f32_32x32x16_bf16 v[64:79], v[148:151], a[228:231], v[64:79]
ds_read_b128 v[148:151], v2 offset:7168
s_waitcnt lgkmcnt(3)
v_mfma_f32_32x32x16_bf16 v[16:31], v[112:115], a[16:19], v[16:31]
v_mfma_f32_32x32x16_bf16 v[32:47], v[112:115], a[88:91], v[32:47]
v_mfma_f32_32x32x16_bf16 v[48:63], v[112:115], a[160:163], v[48:63]
v_mfma_f32_32x32x16_bf16 v[64:79], v[112:115], a[232:235], v[64:79]
ds_read_b128 v[112:115], v2 offset:8192
buffer_load_dword v10, v5, s[4:7], s54 offen sc1
s_waitcnt lgkmcnt(3)
v_mfma_f32_32x32x16_bf16 v[16:31], v[116:119], a[20:23], v[16:31]
v_mfma_f32_32x32x16_bf16 v[32:47], v[116:119], a[92:95], v[32:47]
v_mfma_f32_32x32x16_bf16 v[48:63], v[116:119], a[164:167], v[48:63]
v_mfma_f32_32x32x16_bf16 v[64:79], v[116:119], a[236:239], v[64:79]
ds_read_b128 v[116:119], v2 offset:9216
s_waitcnt lgkmcnt(3)
v_mfma_f32_32x32x16_bf16 v[16:31], v[120:123], a[24:27], v[16:31]
v_mfma_f32_32x32x16_bf16 v[32:47], v[120:123], a[96:99], v[32:47]
v_mfma_f32_32x32x16_bf16 v[48:63], v[120:123], a[168:171], v[48:63]
v_mfma_f32_32x32x16_bf16 v[64:79], v[120:123], a[240:243], v[64:79]
ds_read_b128 v[120:123], v2 offset:10240
s_waitcnt lgkmcnt(3)
v_mfma_f32_32x32x16_bf16 v[16:31], v[148:151], a[28:31], v[16:31]
s_waitcnt vmcnt(2)
ds_read_b32 v140, v13 offset:0
ds_read_b32 v141, v13 offset:256
v_mfma_f32_32x32x16_bf16 v[32:47], v[148:151], a[100:103], v[32:47]
s_waitcnt vmcnt(0)
v_cmp_gt_u32 vcc, s65, v10
s_nop 0
s_cbranch_vccnz L_slow34
L_ret34:
buffer_load_dwordx4 v[184:187], v4, s[4:7], s10 offen offset:0 sc1
ds_read_b32 v142, v13 offset:512
v_mfma_f32_32x32x16_bf16 v[48:63], v[148:151], a[172:175], v[48:63]
ds_read_b32 v143, v13 offset:768
ds_read_b32 v144, v14 offset:0
buffer_load_dwordx4 v[188:191], v4, s[4:7], s11 offen offset:0 sc1
v_mfma_f32_32x32x16_bf16 v[64:79], v[148:151], a[244:247], v[64:79]
ds_read_b128 v[148:151], v2 offset:11264
buffer_load_dwordx4 v[192:195], v4, s[4:7], s12 offen offset:0 sc1
s_waitcnt lgkmcnt(8)
v_mfma_f32_32x32x16_bf16 v[16:31], v[112:115], a[32:35], v[16:31]
buffer_load_dwordx4 v[196:199], v4, s[4:7], s13 offen offset:0 sc1
v_mfma_f32_32x32x16_bf16 v[32:47], v[112:115], a[104:107], v[32:47]
buffer_load_dwordx4 v[200:203], v4, s[4:7], s10 offen offset:256 sc1
v_mfma_f32_32x32x16_bf16 v[48:63], v[112:115], a[176:179], v[48:63]
buffer_load_dwordx4 v[204:207], v4, s[4:7], s11 offen offset:256 sc1
v_mfma_f32_32x32x16_bf16 v[64:79], v[112:115], a[248:251], v[64:79]
ds_read_b128 v[112:115], v2 offset:12288
s_waitcnt lgkmcnt(6)
v_lshlrev_b32 v244, 16, v140
v_mfma_f32_32x32x16_bf16 v[16:31], v[116:119], a[36:39], v[16:31]
buffer_load_dwordx4 v[208:211], v4, s[4:7], s12 offen offset:256 sc1
v_and_b32 v245, 0xffff0000, v140
s_waitcnt lgkmcnt(5)
v_lshlrev_b32 v246, 16, v141
v_and_b32 v247, 0xffff0000, v141
v_mfma_f32_32x32x16_bf16 v[32:47], v[116:119], a[108:111], v[32:47]
s_waitcnt lgkmcnt(4)
v_lshlrev_b32 v248, 16, v142
buffer_load_dwordx4 v[212:215], v4, s[4:7], s13 offen offset:256 sc1
v_and_b32 v249, 0xffff0000, v142
s_waitcnt lgkmcnt(3)
v_lshlrev_b32 v250, 16, v143
v_mfma_f32_32x32x16_bf16 v[48:63], v[116:119], a[180:183], v[48:63]
v_and_b32 v251, 0xffff0000, v143
s_waitcnt lgkmcnt(2)
v_lshlrev_b32 v252, 16, v144
buffer_load_dwordx4 v[216:219], v4, s[4:7], s10 offen offset:512 sc1
v_and_b32 v253, 0xffff0000, v144
v_mfma_f32_32x32x16_bf16 v[64:79], v[116:119], a[252:255], v[64:79]
ds_read_b128 v[116:119], v2 offset:13312
buffer_load_dwordx4 v[220:223], v4, s[4:7], s11 offen offset:512 sc1
v_mfma_f32_32x32x16_bf16 v[16:31], v[120:123], a[40:43], v[16:31]
v_mfma_f32_32x32x16_bf16 v[32:47], v[120:123], a[112:115], v[32:47]
v_mfma_f32_32x32x16_bf16 v[48:63], v[120:123], a[184:187], v[48:63]
s_waitcnt vmcnt(9)
v_mfma_f32_16x16x32_bf16 v[224:227], v[124:127], v[184:187], v[128:131]
buffer_load_dwordx4 v[184:187], v4, s[4:7], s12 offen offset:512 sc1
s_waitcnt vmcnt(9)
v_mfma_f32_16x16x32_bf16 v[224:227], v[124:127], v[188:191], v[224:227]
v_mfma_f32_32x32x16_bf16 v[64:79], v[120:123], v[152:155], v[64:79]
ds_read_b128 v[120:123], v2 offset:14336
buffer_load_dwordx4 v[188:191], v4, s[4:7], s13 offen offset:512 sc1
s_waitcnt vmcnt(9)
v_mfma_f32_16x16x32_bf16 v[224:227], v[124:127], v[192:195], v[224:227]
s_waitcnt lgkmcnt(3)
v_mfma_f32_32x32x16_bf16 v[16:31], v[148:151], a[44:47], v[16:31]
buffer_load_dwordx4 v[192:195], v4, s[4:7], s10 offen offset:768 sc1
s_waitcnt vmcnt(9)
v_mfma_f32_16x16x32_bf16 v[224:227], v[124:127], v[196:199], v[224:227]
v_mfma_f32_32x32x16_bf16 v[32:47], v[148:151], a[116:119], v[32:47]
buffer_load_dwordx4 v[196:199], v4, s[4:7], s11 offen offset:768 sc1
s_nop 2
v_mov_b32_dpp v226, v224 quad_perm:[1,0,3,2] row_mask:0xf bank_mask:0xf
v_mov_b32_dpp v227, v225 quad_perm:[1,0,3,2] row_mask:0xf bank_mask:0xf
v_cndmask_b32 v225, v226, v225, s[8:9]
s_waitcnt vmcnt(9)
v_mfma_f32_16x16x32_bf16 v[228:231], v[124:127], v[200:203], v[130:133]
v_cndmask_b32 v224, v224, v227, s[8:9]
s_waitcnt vmcnt(8)
v_mfma_f32_16x16x32_bf16 v[228:231], v[124:127], v[204:207], v[228:231]
buffer_load_dwordx4 v[200:203], v4, s[4:7], s12 offen offset:768 sc1
v_mfma_f32_32x32x16_bf16 v[48:63], v[148:151], a[188:191], v[48:63]
v_add_f32 v244, v244, v224
v_add_f32 v245, v245, v225
v_cvt_pk_bf16_f32 v226, v244, v245
ds_write_b32 v13, v226 offset:4096
s_waitcnt vmcnt(8)
v_mfma_f32_16x16x32_bf16 v[228:231], v[124:127], v[208:211], v[228:231]
buffer_load_dwordx4 v[204:207], v4, s[4:7], s13 offen offset:768 sc1
v_mfma_f32_32x32x16_bf16 v[64:79], v[148:151], v[156:159], v[64:79]
ds_read_b128 v[148:151], v2 offset:15360
v_lshlrev_b32 v244, 16, v226
v_and_b32 v245, 0xffff0000, v226
v_mul_f32 v255, v244, v244
v_add_f32 v254, v244, v245
v_fmac_f32 v255, v245, v245
s_waitcnt vmcnt(8)
v_mfma_f32_16x16x32_bf16 v[228:231], v[124:127], v[212:215], v[228:231]
buffer_load_dwordx4 v[208:211], v12, s[4:7], s10 offen offset:1024 sc1
s_waitcnt lgkmcnt(4)
v_mfma_f32_32x32x16_bf16 v[16:31], v[112:115], a[48:51], v[16:31]
v_xor_b32 v4, 1048576, v4
s_nop 2
v_mov_b32_dpp v230, v228 quad_perm:[1,0,3,2] row_mask:0xf bank_mask:0xf
v_mov_b32_dpp v231, v229 quad_perm:[1,0,3,2] row_mask:0xf bank_mask:0xf
v_cndmask_b32 v229, v230, v229, s[8:9]
v_cndmask_b32 v228, v228, v231, s[8:9]
v_mfma_f32_32x32x16_bf16 v[32:47], v[112:115], a[120:123], v[32:47]
buffer_load_dwordx4 v[212:215], v12, s[4:7], s12 offen offset:1024 sc1
v_add_f32 v246, v246, v228
v_add_f32 v247, v247, v229
v_xor_b32 v12, 1048576, v12
v_cvt_pk_bf16_f32 v230, v246, v247
v_mfma_f32_32x32x16_bf16 v[48:63], v[112:115], a[192:195], v[48:63]
ds_write_b32 v13, v230 offset:4352
v_lshlrev_b32 v246, 16, v230
v_and_b32 v247, 0xffff0000, v230
buffer_load_dword v9, v8, s[4:7], s53 offen sc1
v_mfma_f32_32x32x16_bf16 v[64:79], v[112:115], v[160:163], v[64:79]
ds_read_b128 v[112:115], v2 offset:16384
v_add_f32 v254, v254, v246
v_fmac_f32 v255, v246, v246
v_add_f32 v254, v254, v247
v_fmac_f32 v255, v247, v247
s_waitcnt lgkmcnt(5)
v_mfma_f32_32x32x16_bf16 v[16:31], v[116:119], a[52:55], v[16:31]
v_mfma_f32_32x32x16_bf16 v[32:47], v[116:119], a[124:127], v[32:47]
v_mfma_f32_32x32x16_bf16 v[48:63], v[116:119], a[196:199], v[48:63]
v_mfma_f32_32x32x16_bf16 v[64:79], v[116:119], v[164:167], v[64:79]
ds_read_b128 v[116:119], v2 offset:17408
v_xor_b32 v2, 0x8000, v2
s_waitcnt vmcnt(10)
v_mfma_f32_16x16x32_bf16 v[232:235], v[124:127], v[216:219], v[132:135]
s_waitcnt vmcnt(6)
v_mfma_f32_16x16x32_bf16 v[236:239], v[124:127], v[192:195], v[134:137]
v_mfma_f32_16x16x32_bf16 v[232:235], v[124:127], v[220:223], v[232:235]
s_waitcnt vmcnt(5)
v_mfma_f32_16x16x32_bf16 v[236:239], v[124:127], v[196:199], v[236:239]
v_mfma_f32_16x16x32_bf16 v[232:235], v[124:127], v[184:187], v[232:235]
v_mfma_f32_16x16x32_bf16 v[232:235], v[124:127], v[188:191], v[232:235]
s_waitcnt vmcnt(4)
v_mfma_f32_16x16x32_bf16 v[236:239], v[124:127], v[200:203], v[236:239]
s_waitcnt lgkmcnt(5)
v_mfma_f32_32x32x16_bf16 v[16:31], v[120:123], a[56:59], v[16:31]
v_mov_b32_dpp v235, v233 quad_perm:[1,0,3,2] row_mask:0xf bank_mask:0xf
v_mov_b32_dpp v234, v232 quad_perm:[1,0,3,2] row_mask:0xf bank_mask:0xf
v_cndmask_b32 v232, v232, v235, s[8:9]
v_cndmask_b32 v233, v234, v233, s[8:9]
v_add_f32 v248, v248, v232
s_waitcnt vmcnt(3)
v_mfma_f32_16x16x32_bf16 v[236:239], v[124:127], v[204:207], v[236:239]
v_add_f32 v249, v249, v233
v_mfma_f32_32x32x16_bf16 v[32:47], v[120:123], a[128:131], v[32:47]
v_cvt_pk_bf16_f32 v234, v248, v249
v_lshlrev_b32 v248, 16, v234
ds_write_b32 v13, v234 offset:4608
s_nop 0
v_mov_b32_dpp v238, v236 quad_perm:[1,0,3,2] row_mask:0xf bank_mask:0xf
v_mov_b32_dpp v239, v237 quad_perm:[1,0,3,2] row_mask:0xf bank_mask:0xf
s_waitcnt vmcnt(2)
v_mfma_f32_16x16x32_bf16 v[240:243], v[124:127], v[208:211], v[136:139]
v_cndmask_b32 v236, v236, v239, s[8:9]
v_mfma_f32_32x32x16_bf16 v[48:63], v[120:123], a[200:203], v[48:63]
v_cndmask_b32 v237, v238, v237, s[8:9]
v_add_f32 v250, v250, v236
v_add_f32 v251, v251, v237
v_and_b32 v249, 0xffff0000, v234
v_add_f32 v254, v254, v248
v_fmac_f32 v255, v248, v248
s_waitcnt vmcnt(1)
v_mfma_f32_16x16x32_bf16 v[240:243], v[124:127], v[212:215], v[240:243]
s_waitcnt vmcnt(0)
s_mov_b32 m0, s51
s_nop 0
buffer_load_dwordx4 v1, s[4:7], s48 offen offset:0 sc1 lds
v_mfma_f32_32x32x16_bf16 v[64:79], v[120:123], v[168:171], v[64:79]
s_nop 3
v_add_f32_dpp v240, v240, v240 row_ror:8 row_mask:0xf bank_mask:0xf
v_add_f32_dpp v241, v241, v241 row_ror:8 row_mask:0xf bank_mask:0xf
v_add_f32 v252, v252, v240
s_mov_b32 m0, s51
s_nop 0
buffer_load_dwordx4 v1, s[4:7], s48 offen offset:1024 sc1 lds
s_waitcnt lgkmcnt(4)
v_mfma_f32_32x32x16_bf16 v[16:31], v[148:151], a[60:63], v[16:31]
v_add_f32 v253, v253, v241
v_cvt_pk_bf16_f32 v238, v250, v251
v_cvt_pk_bf16_f32 v242, v252, v253
s_mov_b32 m0, s51
s_nop 0
buffer_load_dwordx4 v1, s[4:7], s48 offen offset:2048 sc1 lds
v_mfma_f32_32x32x16_bf16 v[32:47], v[148:151], a[132:135], v[32:47]
ds_write_b32 v13, v238 offset:4864
v_add_f32 v254, v254, v249
v_fmac_f32 v255, v249, v249
s_mov_b32 m0, s51
s_nop 0
buffer_load_dwordx4 v1, s[4:7], s48 offen offset:3072 sc1 lds
v_mfma_f32_32x32x16_bf16 v[48:63], v[148:151], a[204:207], v[48:63]
ds_write_b32 v14, v242 offset:4096
v_lshlrev_b32 v250, 16, v238
v_lshlrev_b32 v252, 16, v242
v_and_b32 v251, 0xffff0000, v238
v_add_f32 v254, v254, v250
v_mfma_f32_32x32x16_bf16 v[64:79], v[148:151], v[172:175], v[64:79]
v_fmac_f32 v255, v250, v250
v_and_b32 v253, 0xffff0000, v242
v_mul_f32 v241, v252, v252
v_add_f32 v254, v254, v251
v_fmac_f32 v255, v251, v251
v_add_f32 v240, v252, v253
s_waitcnt lgkmcnt(4)
v_mfma_f32_32x32x16_bf16 v[16:31], v[112:115], a[64:67], v[16:31]
v_fmac_f32 v241, v253, v253
v_fmac_f32 v254, 0.5, v240
v_fmac_f32 v255, 0.5, v241
s_nop 0
v_add_f32_dpp v254, v254, v254 row_ror:8 row_mask:0xf bank_mask:0xf
v_mfma_f32_32x32x16_bf16 v[32:47], v[112:115], a[136:139], v[32:47]
v_add_f32_dpp v255, v255, v255 row_ror:8 row_mask:0xf bank_mask:0xf
v_add_f32_dpp v254, v254, v254 row_ror:4 row_mask:0xf bank_mask:0xf
s_nop 0
v_add_f32_dpp v255, v255, v255 row_ror:4 row_mask:0xf bank_mask:0xf
v_add_f32_dpp v254, v254, v254 row_ror:2 row_mask:0xf bank_mask:0xf
s_nop 0
v_add_f32_dpp v255, v255, v255 row_ror:2 row_mask:0xf bank_mask:0xf
s_waitcnt lgkmcnt(3)
v_mfma_f32_32x32x16_bf16 v[16:31], v[116:119], a[68:71], v[16:31]
v_add_f32_dpp v254, v254, v254 row_ror:1 row_mask:0xf bank_mask:0xf
v_add_f32_dpp v255, v255, v255 row_ror:1 row_mask:0xf bank_mask:0xf
v_mov_b32 v231, v254
v_mov_b32 v227, v255
s_nop 0
v_permlane16_swap_b32 v254, v231
v_mfma_f32_32x32x16_bf16 v[32:47], v[116:119], a[140:143], v[32:47]
v_permlane16_swap_b32 v255, v227
v_add_f32 v254, v254, v231
v_add_f32 v255, v255, v227
v_mov_b32 v231, v254
v_mov_b32 v227, v255
v_mfma_f32_32x32x16_bf16 v[48:63], v[112:115], a[208:211], v[48:63]
v_permlane32_swap_b32 v254, v231
v_permlane32_swap_b32 v255, v227
v_add_f32 v254, v254, v231
v_add_f32 v255, v255, v227
v_mfma_f32_32x32x16_bf16 v[64:79], v[112:115], v[176:179], v[64:79]
v_mul_f32 v254, 0x3ae38e39, v254
v_mul_f32 v255, 0x3ae38e39, v255
v_cvt_pk_bf16_f32 v80, v16, v32
v_fma_f32 v255, -v254, v254, v255
v_cvt_pk_bf16_f32 v82, v18, v34
v_max_f32 v255, 0, v255
v_mfma_f32_32x32x16_bf16 v[48:63], v[116:119], a[212:215], v[48:63]
v_cvt_pk_bf16_f32 v254, v254, v255
v_cvt_pk_bf16_f32 v84, v17, v33
v_and_b32 v255, 0xffff0000, v254
v_lshlrev_b32 v254, 16, v254
v_add_f32 v255, 0x3727c5ac, v255
v_sub_f32 v244, v244, v254
v_mfma_f32_32x32x16_bf16 v[64:79], v[116:119], v[180:183], v[64:79]
v_cvt_pk_bf16_f32 v255, v255, v255
v_sub_f32 v245, v245, v254
v_and_b32 v255, 0xffff0000, v255
v_sub_f32 v246, v246, v254
v_sqrt_f32 v255, v255
v_sub_f32 v247, v247, v254
v_cvt_pk_bf16_f32 v255, v255, v255
v_sub_f32 v248, v248, v254
v_and_b32 v255, 0xffff0000, v255
v_sub_f32 v249, v249, v254
v_rcp_f32 v255, v255
v_sub_f32 v250, v250, v254
v_sub_f32 v251, v251, v254
v_sub_f32 v252, v252, v254
v_sub_f32 v253, v253, v254
v_cvt_pk_bf16_f32 v81, v48, v64
v_cvt_pk_bf16_f32 v83, v50, v66
v_cvt_pk_bf16_f32 v86, v19, v35
v_cvt_pk_bf16_f32 v85, v49, v65
v_cvt_pk_bf16_f32 v87, v51, v67
v_cvt_pk_bf16_f32 v88, v20, v36
v_cvt_pk_bf16_f32 v90, v22, v38
v_cvt_pk_bf16_f32 v89, v52, v68
v_cvt_pk_bf16_f32 v91, v54, v70
v_cvt_pk_bf16_f32 v92, v21, v37
v_cvt_pk_bf16_f32 v94, v23, v39
v_cvt_pk_bf16_f32 v93, v53, v69
v_cvt_pk_bf16_f32 v95, v55, v71
v_cvt_pk_bf16_f32 v96, v24, v40
v_cvt_pk_bf16_f32 v98, v26, v42
v_permlane16_swap_b32 v80, v82
v_permlane16_swap_b32 v81, v83
buffer_store_dwordx4 v[80:83], v3, s[4:7], s57 offen offset:0
v_cvt_pk_bf16_f32 v97, v56, v72
v_cvt_pk_bf16_f32 v99, v58, v74
v_cvt_pk_bf16_f32 v100, v25, v41
v_cvt_pk_bf16_f32 v102, v27, v43
v_cvt_pk_bf16_f32 v101, v57, v73
v_cvt_pk_bf16_f32 v103, v59, v75
v_permlane16_swap_b32 v84, v86
v_permlane16_swap_b32 v85, v87
buffer_store_dwordx4 v[84:87], v3, s[4:7], s57 offen offset:1152
v_cvt_pk_bf16_f32 v104, v28, v44
v_cvt_pk_bf16_f32 v106, v30, v46
v_cvt_pk_bf16_f32 v105, v60, v76
v_cvt_pk_bf16_f32 v107, v62, v78
v_mul_f32 v244, v244, v255
v_mul_f32 v245, v245, v255
v_permlane16_swap_b32 v88, v90
v_permlane16_swap_b32 v89, v91
buffer_store_dwordx4 v[88:91], v3, s[4:7], s58 offen offset:0
v_mul_f32 v246, v246, v255
v_mul_f32 v247, v247, v255
v_mul_f32 v248, v248, v255
v_mul_f32 v249, v249, v255
v_mul_f32 v250, v250, v255
v_cvt_pk_bf16_f32 v224, v244, v245
v_permlane16_swap_b32 v92, v94
ds_write_b32 v13, v224 offset:2048
v_permlane16_swap_b32 v93, v95
buffer_store_dwordx4 v[92:95], v3, s[4:7], s58 offen offset:1152
v_mul_f32 v251, v251, v255
v_cvt_pk_bf16_f32 v228, v246, v247
v_cvt_pk_bf16_f32 v232, v248, v249
ds_write_b32 v13, v228 offset:2304
v_permlane16_swap_b32 v96, v98
v_permlane16_swap_b32 v97, v99
ds_write_b32 v13, v232 offset:2560
buffer_store_dwordx4 v[96:99], v3, s[4:7], s59 offen offset:0
v_mul_f32 v252, v252, v255
v_mul_f32 v253, v253, v255
v_cvt_pk_bf16_f32 v236, v250, v251
v_permlane16_swap_b32 v100, v102
ds_write_b32 v13, v236 offset:2816
v_permlane16_swap_b32 v101, v103
v_cvt_pk_bf16_f32 v108, v29, v45
buffer_store_dwordx4 v[100:103], v3, s[4:7], s59 offen offset:1152
v_cvt_pk_bf16_f32 v240, v252, v253
v_add_u32 v254, s47, v1
ds_write_b32 v14, v240 offset:2048
v_permlane16_swap_b32 v104, v106
v_permlane16_swap_b32 v105, v107
ds_read_b128 v[224:227], v254 offset:2048
v_cvt_pk_bf16_f32 v110, v31, v47
buffer_store_dwordx4 v[104:107], v3, s[4:7], s60 offen offset:0
ds_read_b128 v[228:231], v254 offset:3072
v_cvt_pk_bf16_f32 v109, v61, v77
v_cvt_pk_bf16_f32 v111, v63, v79
v_permlane16_swap_b32 v108, v110
ds_read_b128 v[232:235], v254 offset:4096
v_permlane16_swap_b32 v109, v111
ds_read_b128 v[236:239], v254 offset:5120
buffer_store_dwordx4 v[108:111], v3, s[4:7], s60 offen offset:1152
v_xor_b32 v3, 1048576, v3
s_add_u32 s38, s38, 1
s_add_u32 s65, s65, 1
s_add_u32 s66, s66, 1
s_waitcnt vmcnt(0)
L_o_loopmhi:
s_waitcnt vmcnt(8)
v_cmp_gt_u32 vcc, s38, v9
s_nop 0
s_cbranch_vccnz L_slow35
L_ret35:
s_barrier
v_mov_b32 v11, s65
v_mov_b32 v146, s66
s_xor_b32 s51, s51, 0x8000
s_and_b32 s61, s38, 3
s_cselect_b32 s61, 1, -3
s_mul_i32 s61, s61, 18432
s_add_u32 s48, s48, s61
ds_read_b128 v[112:115], v2 offset:0
ds_read_b128 v[116:119], v2 offset:1024
s_waitcnt lgkmcnt(5)
buffer_store_dwordx4 v[224:227], v1, s[4:7], s96 offen sc1
ds_read_b128 v[120:123], v2 offset:2048
ds_read_b128 v[148:151], v2 offset:3072
s_waitcnt lgkmcnt(5)
buffer_store_dwordx4 v[228:231], v15, s[4:7], s96 offen sc1
s_add_u32 s96, s96, 36864
s_waitcnt lgkmcnt(5)
buffer_store_dwordx4 v[232:235], v1, s[16:19], s95 offen sc1
s_waitcnt lgkmcnt(3)
v_mfma_f32_32x32x16_bf16 v[16:31], v[112:115], a[0:3], 0
buffer_store_dwordx4 v[236:239], v15, s[16:19], s95 offen sc1
s_add_u32 s95, s95, 36864
v_mfma_f32_32x32x16_bf16 v[32:47], v[112:115], a[72:75], 0
s_mov_b32 m0, s47
s_nop 0
buffer_load_dwordx4 v1, s[4:7], s94 offen sc1 lds
v_mfma_f32_32x32x16_bf16 v[48:63], v[112:115], a[144:147], 0
s_add_u32 m0, s47, 1024
s_nop 0
buffer_load_dwordx4 v15, s[4:7], s94 offen sc1 lds
v_mfma_f32_32x32x16_bf16 v[64:79], v[112:115], a[216:219], 0
s_waitcnt vmcnt(6)
s_cmp_eq_u32 s36, 0
s_cbranch_scc1 L_slow36
L_ret36:
ds_read_b128 v[112:115], v2 offset:4096
s_add_u32 s94, s94, 36864
buffer_store_dword v11, v7, s[4:7], s55 offen
s_waitcnt lgkmcnt(3)
v_mfma_f32_32x32x16_bf16 v[16:31], v[116:119], a[4:7], v[16:31]
v_mfma_f32_32x32x16_bf16 v[48:63], v[116:119], a[148:151], v[48:63]
v_mfma_f32_32x32x16_bf16 v[32:47], v[116:119], a[76:79], v[32:47]
v_mfma_f32_32x32x16_bf16 v[64:79], v[116:119], a[220:223], v[64:79]
ds_read_b128 v[116:119], v2 offset:5120
s_waitcnt lgkmcnt(3)
v_mfma_f32_32x32x16_bf16 v[16:31], v[120:123], a[8:11], v[16:31]
v_mfma_f32_32x32x16_bf16 v[32:47], v[120:123], a[80:83], v[32:47]
v_mfma_f32_32x32x16_bf16 v[64:79], v[120:123], a[224:227], v[64:79]
v_mfma_f32_32x32x16_bf16 v[48:63], v[120:123], a[152:155], v[48:63]
ds_read_b128 v[120:123], v2 offset:6144
s_waitcnt lgkmcnt(3)
v_mfma_f32_32x32x16_bf16 v[16:31], v[148:151], a[12:15], v[16:31]
v_mfma_f32_32x32x16_bf16 v[32:47], v[148:151], a[84:87], v[32:47]
v_mfma_f32_32x32x16_bf16 v[48:63], v[148:151], a[156:159], v[48:63]
s_waitcnt lgkmcnt(2)
v_mfma_f32_32x32x16_bf16 v[16:31], v[112:115], a[16:19], v[16:31]
v_mfma_f32_32x32x16_bf16 v[64:79], v[148:151], a[228:231], v[64:79]
ds_read_b128 v[148:151], v2 offset:7168
v_mfma_f32_32x32x16_bf16 v[48:63], v[112:115], a[160:163], v[48:63]
v_mfma_f32_32x32x16_bf16 v[32:47], v[112:115], a[88:91], v[32:47]
buffer_load_dword v10, v5, s[4:7], s54 offen sc1
v_mfma_f32_32x32x16_bf16 v[64:79], v[112:115], a[232:235], v[64:79]
ds_read_b128 v[112:115], v2 offset:8192
s_waitcnt lgkmcnt(3)
v_mfma_f32_32x32x16_bf16 v[16:31], v[116:119], a[20:23], v[16:31]
v_mfma_f32_32x32x16_bf16 v[32:47], v[116:119], a[92:95], v[32:47]
v_mfma_f32_32x32x16_bf16 v[48:63], v[116:119], a[164:167], v[48:63]
v_mfma_f32_32x32x16_bf16 v[64:79], v[116:119], a[236:239], v[64:79]
ds_read_b128 v[116:119], v2 offset:9216
s_waitcnt lgkmcnt(3)
v_mfma_f32_32x32x16_bf16 v[16:31], v[120:123], a[24:27], v[16:31]
v_mfma_f32_32x32x16_bf16 v[48:63], v[120:123], a[168:171], v[48:63]
v_mfma_f32_32x32x16_bf16 v[32:47], v[120:123], a[96:99], v[32:47]
v_mfma_f32_32x32x16_bf16 v[64:79], v[120:123], a[240:243], v[64:79]
s_waitcnt vmcnt(4)
s_cmp_eq_u32 s36, 0
s_cbranch_scc1 L_slow38
L_ret38:
buffer_store_dword v146, v7, s[4:7], s55 offen offset:2048
ds_read_b128 v[120:123], v2 offset:10240
s_waitcnt lgkmcnt(3)
v_mfma_f32_32x32x16_bf16 v[16:31], v[148:151], a[28:31], v[16:31]
s_waitcnt vmcnt(1)
v_cmp_gt_u32 vcc, s65, v10
s_nop 0
s_cbranch_vccnz L_slow37
L_ret37:
buffer_load_dwordx4 v[184:187], v4, s[4:7], s10 offen offset:0 sc1
v_mfma_f32_32x32x16_bf16 v[32:47], v[148:151], a[100:103], v[32:47]
ds_read_b32 v142, v13 offset:512
ds_read_b32 v143, v13 offset:768
ds_read_b32 v144, v14 offset:0
buffer_load_dwordx4 v[188:191], v4, s[4:7], s11 offen offset:0 sc1
v_mfma_f32_32x32x16_bf16 v[48:63], v[148:151], a[172:175], v[48:63]
ds_read_b32 v140, v13 offset:0
ds_read_b32 v141, v13 offset:256
buffer_load_dwordx4 v[192:195], v4, s[4:7], s12 offen offset:0 sc1
v_mfma_f32_32x32x16_bf16 v[64:79], v[148:151], a[244:247], v[64:79]
ds_read_b128 v[148:151], v2 offset:11264
buffer_load_dwordx4 v[196:199], v4, s[4:7], s13 offen offset:0 sc1
s_waitcnt lgkmcnt(8)
v_mfma_f32_32x32x16_bf16 v[16:31], v[112:115], a[32:35], v[16:31]
buffer_load_dwordx4 v[200:203], v4, s[4:7], s10 offen offset:256 sc1
v_mfma_f32_32x32x16_bf16 v[32:47], v[112:115], a[104:107], v[32:47]
v_mfma_f32_32x32x16_bf16 v[48:63], v[112:115], a[176:179], v[48:63]
buffer_load_dwordx4 v[204:207], v4, s[4:7], s11 offen offset:256 sc1
v_mfma_f32_32x32x16_bf16 v[64:79], v[112:115], a[248:251], v[64:79]
ds_read_b128 v[112:115], v2 offset:12288
buffer_load_dwordx4 v[208:211], v4, s[4:7], s12 offen offset:256 sc1
s_waitcnt lgkmcnt(8)
v_mfma_f32_32x32x16_bf16 v[32:47], v[116:119], a[108:111], v[32:47]
s_waitcnt lgkmcnt(6)
v_lshlrev_b32 v248, 16, v142
v_and_b32 v249, 0xffff0000, v142
buffer_load_dwordx4 v[212:215], v4, s[4:7], s13 offen offset:256 sc1
v_mfma_f32_32x32x16_bf16 v[16:31], v[116:119], a[36:39], v[16:31]
s_waitcnt lgkmcnt(3)
v_and_b32 v245, 0xffff0000, v140
v_lshlrev_b32 v252, 16, v144
v_lshlrev_b32 v250, 16, v143
v_and_b32 v253, 0xffff0000, v144
v_lshlrev_b32 v244, 16, v140
v_mfma_f32_32x32x16_bf16 v[48:63], v[116:119], a[180:183], v[48:63]
buffer_load_dwordx4 v[216:219], v4, s[4:7], s10 offen offset:512 sc1
s_waitcnt lgkmcnt(2)
v_lshlrev_b32 v246, 16, v141
v_and_b32 v251, 0xffff0000, v143
v_and_b32 v247, 0xffff0000, v141
v_mfma_f32_32x32x16_bf16 v[16:31], v[120:123], a[40:43], v[16:31]
buffer_load_dwordx4 v[220:223], v4, s[4:7], s11 offen offset:512 sc1
v_mfma_f32_32x32x16_bf16 v[64:79], v[116:119], a[252:255], v[64:79]
ds_read_b128 v[116:119], v2 offset:13312
buffer_load_dword v147, v0, s[4:7], s41 offen sc1
v_mfma_f32_32x32x16_bf16 v[32:47], v[120:123], a[112:115], v[32:47]
s_waitcnt vmcnt(10)
v_mfma_f32_16x16x32_bf16 v[224:227], v[124:127], v[184:187], v[128:131]
buffer_load_dwordx4 v[184:187], v4, s[4:7], s12 offen offset:512 sc1
v_mfma_f32_32x32x16_bf16 v[48:63], v[120:123], a[184:187], v[48:63]
s_waitcnt vmcnt(10)
v_mfma_f32_16x16x32_bf16 v[224:227], v[124:127], v[188:191], v[224:227]
buffer_load_dwordx4 v[188:191], v4, s[4:7], s13 offen offset:512 sc1
v_mfma_f32_32x32x16_bf16 v[64:79], v[120:123], v[152:155], v[64:79]
ds_read_b128 v[120:123], v2 offset:14336
s_waitcnt vmcnt(10)
v_mfma_f32_16x16x32_bf16 v[224:227], v[124:127], v[192:195], v[224:227]
buffer_load_dwordx4 v[192:195], v4, s[4:7], s10 offen offset:768 sc1
s_waitcnt vmcnt(10)
v_mfma_f32_16x16x32_bf16 v[224:227], v[124:127], v[196:199], v[224:227]
s_waitcnt lgkmcnt(3)
v_mfma_f32_32x32x16_bf16 v[16:31], v[148:151], a[44:47], v[16:31]
buffer_load_dwordx4 v[196:199], v4, s[4:7], s11 offen offset:768 sc1
s_nop 2
v_mov_b32_dpp v227, v225 quad_perm:[1,0,3,2] row_mask:0xf bank_mask:0xf
v_mov_b32_dpp v226, v224 quad_perm:[1,0,3,2] row_mask:0xf bank_mask:0xf
s_waitcnt vmcnt(10)
v_mfma_f32_16x16x32_bf16 v[228:231], v[124:127], v[200:203], v[130:133]
v_cndmask_b32 v225, v226, v225, s[8:9]
v_mfma_f32_32x32x16_bf16 v[32:47], v[148:151], a[116:119], v[32:47]
buffer_load_dwordx4 v[200:203], v4, s[4:7], s12 offen offset:768 sc1
v_cndmask_b32 v224, v224, v227, s[8:9]
v_add_f32 v245, v245, v225
v_add_f32 v244, v244, v224
v_cvt_pk_bf16_f32 v226, v244, v245
s_waitcnt vmcnt(10)
v_mfma_f32_16x16x32_bf16 v[228:231], v[124:127], v[204:207], v[228:231]
ds_write_b32 v13, v226 offset:4096
v_mfma_f32_32x32x16_bf16 v[48:63], v[148:151], a[188:191], v[48:63]
buffer_load_dwordx4 v[204:207], v4, s[4:7], s13 offen offset:768 sc1
v_xor_b32 v4, 1048576, v4
v_and_b32 v245, 0xffff0000, v226
v_lshlrev_b32 v244, 16, v226
v_mul_f32 v255, v244, v244
s_waitcnt vmcnt(10)
v_mfma_f32_16x16x32_bf16 v[228:231], v[124:127], v[208:211], v[228:231]
v_fmac_f32 v255, v245, v245
s_waitcnt vmcnt(9)
v_mfma_f32_16x16x32_bf16 v[228:231], v[124:127], v[212:215], v[228:231]
buffer_load_dwordx4 v[208:211], v12, s[4:7], s10 offen offset:1024 sc1
v_mfma_f32_32x32x16_bf16 v[64:79], v[148:151], v[156:159], v[64:79]
ds_read_b128 v[148:151], v2 offset:15360
v_add_f32 v254, v244, v245
s_nop 1
v_mov_b32_dpp v230, v228 quad_perm:[1,0,3,2] row_mask:0xf bank_mask:0xf
v_mov_b32_dpp v231, v229 quad_perm:[1,0,3,2] row_mask:0xf bank_mask:0xf
v_cndmask_b32 v229, v230, v229, s[8:9]
v_cndmask_b32 v228, v228, v231, s[8:9]
s_waitcnt lgkmcnt(4)
v_mfma_f32_32x32x16_bf16 v[16:31], v[112:115], a[48:51], v[16:31]
buffer_load_dwordx4 v[212:215], v12, s[4:7], s12 offen offset:1024 sc1
v_add_f32 v246, v246, v228
v_add_f32 v247, v247, v229
v_xor_b32 v12, 1048576, v12
v_mfma_f32_32x32x16_bf16 v[32:47], v[112:115], a[120:123], v[32:47]
v_cvt_pk_bf16_f32 v230, v246, v247
s_waitcnt vmcnt(8)
v_cmp_gt_u32 s[14:15], s66, v147
ds_write_b32 v13, v230 offset:4352
buffer_load_dword v9, v8, s[4:7], s53 offen sc1
v_mfma_f32_32x32x16_bf16 v[48:63], v[112:115], a[192:195], v[48:63]
s_cmp_lg_u64 s[14:15], 0
s_subb_u32 s42, s66, 0
s_cmp_eq_u32 s40, 0
s_cbranch_scc1 L_skip39
s_buffer_atomic_umax s42, s[4:7], s56
L_skip39:
v_lshlrev_b32 v246, 16, v230
v_and_b32 v247, 0xffff0000, v230
v_mfma_f32_32x32x16_bf16 v[64:79], v[112:115], v[160:163], v[64:79]
ds_read_b128 v[112:115], v2 offset:16384
v_add_f32 v254, v254, v246
v_fmac_f32 v255, v246, v246
v_add_f32 v254, v254, v247
v_fmac_f32 v255, v247, v247
s_waitcnt lgkmcnt(5)
v_mfma_f32_32x32x16_bf16 v[16:31], v[116:119], a[52:55], v[16:31]
v_mfma_f32_32x32x16_bf16 v[32:47], v[116:119], a[124:127], v[32:47]
v_mfma_f32_32x32x16_bf16 v[48:63], v[116:119], a[196:199], v[48:63]
s_waitcnt vmcnt(6)
v_mfma_f32_16x16x32_bf16 v[236:239], v[124:127], v[192:195], v[134:137]
v_mfma_f32_32x32x16_bf16 v[64:79], v[116:119], v[164:167], v[64:79]
ds_read_b128 v[116:119], v2 offset:17408
v_xor_b32 v2, 0x8000, v2
v_mfma_f32_16x16x32_bf16 v[232:235], v[124:127], v[216:219], v[132:135]
s_waitcnt vmcnt(5)
v_mfma_f32_16x16x32_bf16 v[236:239], v[124:127], v[196:199], v[236:239]
s_waitcnt vmcnt(4)
v_mfma_f32_16x16x32_bf16 v[236:239], v[124:127], v[200:203], v[236:239]
v_mfma_f32_16x16x32_bf16 v[232:235], v[124:127], v[220:223], v[232:235]
v_mfma_f32_16x16x32_bf16 v[232:235], v[124:127], v[184:187], v[232:235]
v_mfma_f32_16x16x32_bf16 v[232:235], v[124:127], v[188:191], v[232:235]
s_waitcnt lgkmcnt(5)
v_mfma_f32_32x32x16_bf16 v[16:31], v[120:123], a[56:59], v[16:31]
s_nop 3
v_mov_b32_dpp v234, v232 quad_perm:[1,0,3,2] row_mask:0xf bank_mask:0xf
v_mov_b32_dpp v235, v233 quad_perm:[1,0,3,2] row_mask:0xf bank_mask:0xf
v_cndmask_b32 v233, v234, v233, s[8:9]
s_waitcnt vmcnt(3)
v_mfma_f32_16x16x32_bf16 v[236:239], v[124:127], v[204:207], v[236:239]
v_cndmask_b32 v232, v232, v235, s[8:9]
s_waitcnt vmcnt(2)
v_mfma_f32_16x16x32_bf16 v[240:243], v[124:127], v[208:211], v[136:139]
v_add_f32 v248, v248, v232
v_mfma_f32_32x32x16_bf16 v[32:47], v[120:123], a[128:131], v[32:47]
v_mov_b32_dpp v238, v236 quad_perm:[1,0,3,2] row_mask:0xf bank_mask:0xf
v_mov_b32_dpp v239, v237 quad_perm:[1,0,3,2] row_mask:0xf bank_mask:0xf
v_cndmask_b32 v237, v238, v237, s[8:9]
v_add_f32 v249, v249, v233
v_cndmask_b32 v236, v236, v239, s[8:9]
v_cvt_pk_bf16_f32 v234, v248, v249
s_waitcnt vmcnt(1)
v_mfma_f32_16x16x32_bf16 v[240:243], v[124:127], v[212:215], v[240:243]
s_waitcnt vmcnt(0)
s_mov_b32 m0, s51
s_nop 0
buffer_load_dwordx4 v1, s[4:7], s48 offen offset:0 sc1 lds
s_waitcnt lgkmcnt(3)
v_mfma_f32_32x32x16_bf16 v[16:31], v[148:151], a[60:63], v[16:31]
ds_write_b32 v13, v234 offset:4608
s_mov_b32 m0, s51
s_nop 0
buffer_load_dwordx4 v1, s[4:7], s48 offen offset:1024 sc1 lds
s_waitcnt lgkmcnt(2)
v_mfma_f32_32x32x16_bf16 v[16:31], v[112:115], a[64:67], v[16:31]
v_add_f32 v250, v250, v236
v_add_f32_dpp v241, v241, v241 row_ror:8 row_mask:0xf bank_mask:0xf
v_add_f32_dpp v240, v240, v240 row_ror:8 row_mask:0xf bank_mask:0xf
s_mov_b32 m0, s51
s_nop 0
buffer_load_dwordx4 v1, s[4:7], s48 offen offset:2048 sc1 lds
v_mfma_f32_32x32x16_bf16 v[32:47], v[148:151], a[132:135], v[32:47]
v_add_f32 v252, v252, v240
v_add_f32 v253, v253, v241
v_add_f32 v251, v251, v237
v_and_b32 v249, 0xffff0000, v234
s_mov_b32 m0, s51
s_nop 0
buffer_load_dwordx4 v1, s[4:7], s48 offen offset:3072 sc1 lds
v_mfma_f32_32x32x16_bf16 v[32:47], v[112:115], a[136:139], v[32:47]
v_lshlrev_b32 v248, 16, v234
v_cvt_pk_bf16_f32 v242, v252, v253
v_fmac_f32 v255, v248, v248
ds_write_b32 v14, v242 offset:4096
v_fmac_f32 v255, v249, v249
s_waitcnt lgkmcnt(2)
v_mfma_f32_32x32x16_bf16 v[16:31], v[116:119], a[68:71], v[16:31]
v_cvt_pk_bf16_f32 v238, v250, v251
v_and_b32 v253, 0xffff0000, v242
ds_write_b32 v13, v238 offset:4864
v_add_f32 v254, v254, v248
v_mfma_f32_32x32x16_bf16 v[32:47], v[116:119], a[140:143], v[32:47]
v_and_b32 v251, 0xffff0000, v238
v_lshlrev_b32 v252, 16, v242
v_add_f32 v254, v254, v249
v_mul_f32 v241, v252, v252
v_add_f32 v240, v252, v253
v_lshlrev_b32 v250, 16, v238
v_mfma_f32_32x32x16_bf16 v[48:63], v[120:123], a[200:203], v[48:63]
v_add_f32 v254, v254, v250
v_fmac_f32 v241, v253, v253
v_add_f32 v254, v254, v251
v_fmac_f32 v255, v250, v250
v_fmac_f32 v254, 0.5, v240
v_fmac_f32 v255, v251, v251
v_mfma_f32_32x32x16_bf16 v[64:79], v[120:123], v[168:171], v[64:79]
v_cvt_pk_bf16_f32 v84, v17, v33
v_add_f32_dpp v254, v254, v254 row_ror:8 row_mask:0xf bank_mask:0xf
v_fmac_f32 v255, 0.5, v241
v_cvt_pk_bf16_f32 v82, v18, v34
v_add_f32_dpp v254, v254, v254 row_ror:4 row_mask:0xf bank_mask:0xf
v_add_f32_dpp v255, v255, v255 row_ror:8 row_mask:0xf bank_mask:0xf
v_mfma_f32_32x32x16_bf16 v[48:63], v[148:151], a[204:207], v[48:63]
s_nop 0
v_add_f32_dpp v255, v255, v255 row_ror:4 row_mask:0xf bank_mask:0xf
v_add_f32_dpp v254, v254, v254 row_ror:2 row_mask:0xf bank_mask:0xf
v_cvt_pk_bf16_f32 v86, v19, v35
v_add_f32_dpp v255, v255, v255 row_ror:2 row_mask:0xf bank_mask:0xf
v_add_f32_dpp v254, v254, v254 row_ror:1 row_mask:0xf bank_mask:0xf
v_cvt_pk_bf16_f32 v80, v16, v32
v_mfma_f32_32x32x16_bf16 v[64:79], v[148:151], v[172:175], v[64:79]
v_add_f32_dpp v255, v255, v255 row_ror:1 row_mask:0xf bank_mask:0xf
v_mov_b32 v231, v254
v_mov_b32 v227, v255
v_cvt_pk_bf16_f32 v88, v20, v36
v_permlane16_swap_b32 v254, v231
v_mfma_f32_32x32x16_bf16 v[48:63], v[112:115], a[208:211], v[48:63]
v_permlane16_swap_b32 v255, v227
v_add_f32 v254, v254, v231
v_add_f32 v255, v255, v227
v_mov_b32 v231, v254
v_mov_b32 v227, v255
v_mfma_f32_32x32x16_bf16 v[48:63], v[116:119], a[212:215], v[48:63]
v_permlane32_swap_b32 v254, v231
v_permlane32_swap_b32 v255, v227
v_add_f32 v255, v255, v227
v_add_f32 v254, v254, v231
v_mfma_f32_32x32x16_bf16 v[64:79], v[112:115], v[176:179], v[64:79]
v_mul_f32 v254, 0x3ae38e39, v254
v_mul_f32 v255, 0x3ae38e39, v255
v_cvt_pk_bf16_f32 v92, v21, v37
v_fma_f32 v255, -v254, v254, v255
v_cvt_pk_bf16_f32 v98, v26, v42
v_max_f32 v255, 0, v255
v_mfma_f32_32x32x16_bf16 v[64:79], v[116:119], v[180:183], v[64:79]
v_cvt_pk_bf16_f32 v254, v254, v255
v_permlane16_swap_b32 v80, v82
v_and_b32 v255, 0xffff0000, v254
v_lshlrev_b32 v254, 16, v254
v_add_f32 v255, 0x3727c5ac, v255
v_sub_f32 v246, v246, v254
v_sub_f32 v245, v245, v254
v_sub_f32 v248, v248, v254
v_cvt_pk_bf16_f32 v255, v255, v255
v_sub_f32 v244, v244, v254
s_nop 1
v_cvt_pk_bf16_f32 v83, v50, v66
v_and_b32 v255, 0xffff0000, v255
v_sub_f32 v253, v253, v254
v_sqrt_f32 v255, v255
v_sub_f32 v247, v247, v254
v_cvt_pk_bf16_f32 v95, v55, v71
v_sub_f32 v251, v251, v254
v_sub_f32 v250, v250, v254
v_sub_f32 v252, v252, v254
v_cvt_pk_bf16_f32 v255, v255, v255
v_sub_f32 v249, v249, v254
v_and_b32 v255, 0xffff0000, v255
v_cvt_pk_bf16_f32 v87, v51, v67
v_rcp_f32 v255, v255
v_cvt_pk_bf16_f32 v81, v48, v64
v_cvt_pk_bf16_f32 v89, v52, v68
v_cvt_pk_bf16_f32 v91, v54, v70
v_cvt_pk_bf16_f32 v85, v49, v65
v_cvt_pk_bf16_f32 v90, v22, v38
v_cvt_pk_bf16_f32 v93, v53, v69
v_cvt_pk_bf16_f32 v94, v23, v39
v_permlane16_swap_b32 v81, v83
buffer_store_dwordx4 v[80:83], v3, s[4:7], s57 offen offset:0
v_cvt_pk_bf16_f32 v103, v59, v75
v_permlane16_swap_b32 v85, v87
v_cvt_pk_bf16_f32 v96, v24, v40
v_mul_f32 v245, v245, v255
v_cvt_pk_bf16_f32 v97, v56, v72
v_cvt_pk_bf16_f32 v101, v57, v73
v_permlane16_swap_b32 v84, v86
v_permlane16_swap_b32 v88, v90
buffer_store_dwordx4 v[84:87], v3, s[4:7], s57 offen offset:1152
v_cvt_pk_bf16_f32 v99, v58, v74
v_mul_f32 v244, v244, v255
v_permlane16_swap_b32 v89, v91
v_cvt_pk_bf16_f32 v102, v27, v43
v_mul_f32 v246, v246, v255
v_cvt_pk_bf16_f32 v107, v62, v78
v_mul_f32 v247, v247, v255
v_permlane16_swap_b32 v92, v94
buffer_store_dwordx4 v[88:91], v3, s[4:7], s58 offen offset:0
v_permlane16_swap_b32 v93, v95
v_cvt_pk_bf16_f32 v224, v244, v245
v_mul_f32 v249, v249, v255
ds_write_b32 v13, v224 offset:2048
v_mul_f32 v251, v251, v255
v_mul_f32 v248, v248, v255
v_cvt_pk_bf16_f32 v228, v246, v247
v_cvt_pk_bf16_f32 v232, v248, v249
ds_write_b32 v13, v228 offset:2304
buffer_store_dwordx4 v[92:95], v3, s[4:7], s58 offen offset:1152
v_mul_f32 v250, v250, v255
ds_write_b32 v13, v232 offset:2560
v_permlane16_swap_b32 v97, v99
v_permlane16_swap_b32 v96, v98
v_cvt_pk_bf16_f32 v236, v250, v251
v_mul_f32 v253, v253, v255
ds_write_b32 v13, v236 offset:2816
buffer_store_dwordx4 v[96:99], v3, s[4:7], s59 offen offset:0
v_cvt_pk_bf16_f32 v100, v25, v41
v_mul_f32 v252, v252, v255
v_permlane16_swap_b32 v101, v103
v_cvt_pk_bf16_f32 v240, v252, v253
v_cvt_pk_bf16_f32 v106, v30, v46
ds_write_b32 v14, v240 offset:2048
v_permlane16_swap_b32 v100, v102
v_cvt_pk_bf16_f32 v111, v63, v79
buffer_store_dwordx4 v[100:103], v3, s[4:7], s59 offen offset:1152
v_cvt_pk_bf16_f32 v104, v28, v44
v_add_u32 v254, s47, v1
v_cvt_pk_bf16_f32 v105, v60, v76
ds_read_b128 v[224:227], v254 offset:2048
v_permlane16_swap_b32 v104, v106
v_cvt_pk_bf16_f32 v108, v29, v45
ds_read_b128 v[232:235], v254 offset:4096
v_permlane16_swap_b32 v105, v107
buffer_store_dwordx4 v[104:107], v3, s[4:7], s60 offen offset:0
ds_read_b128 v[228:231], v254 offset:3072
v_cvt_pk_bf16_f32 v109, v61, v77
v_cvt_pk_bf16_f32 v110, v31, v47
s_nop 0
v_permlane16_swap_b32 v109, v111
ds_read_b128 v[236:239], v254 offset:5120
v_permlane16_swap_b32 v108, v110
buffer_store_dwordx4 v[108:111], v3, s[4:7], s60 offen offset:1152
v_xor_b32 v3, 1048576, v3
s_add_u32 s38, s38, 1
s_add_u32 s65, s65, 1
s_add_u32 s66, s66, 1
s_cmp_le_u32 s38, 64
s_cbranch_scc1 L_o_loopmhi
v_mov_b32 v11, s65
s_mov_b32 m0, s47
s_nop 0
buffer_load_dwordx4 v1, s[4:7], s94 offen sc1 lds
s_waitcnt vmcnt(1)
s_cmp_eq_u32 s36, 0
s_cbranch_scc1 L_slow40
L_ret40:
v_mov_b32 v146, s66
buffer_store_dword v11, v7, s[4:7], s55 offen
buffer_load_dword v10, v5, s[4:7], s54 offen sc1
s_add_u32 m0, s47, 1024
s_nop 0
buffer_load_dwordx4 v15, s[4:7], s94 offen sc1 lds
s_add_u32 s94, s94, 36864
s_waitcnt lgkmcnt(3)
buffer_store_dwordx4 v[224:227], v1, s[4:7], s96 offen sc1
s_waitcnt lgkmcnt(1)
buffer_store_dwordx4 v[228:231], v15, s[4:7], s96 offen sc1
s_add_u32 s96, s96, 36864
buffer_store_dwordx4 v[232:235], v1, s[16:19], s95 offen sc1
s_waitcnt lgkmcnt(0)
buffer_store_dwordx4 v[236:239], v15, s[16:19], s95 offen sc1
s_waitcnt vmcnt(0)
s_cmp_eq_u32 s36, 0
s_cbranch_scc1 L_slow42
L_ret42:
s_add_u32 s95, s95, 36864
buffer_store_dword v146, v7, s[4:7], s55 offen offset:2048
buffer_load_dword v147, v0, s[4:7], s41 offen sc1
v_cmp_gt_u32 vcc, s65, v10
s_nop 0
s_cbranch_vccnz L_slow41
L_ret41:
buffer_load_dwordx4 v[184:187], v4, s[4:7], s10 offen offset:0 sc1
ds_read_b32 v140, v13 offset:0
ds_read_b32 v141, v13 offset:256
ds_read_b32 v142, v13 offset:512
buffer_load_dwordx4 v[188:191], v4, s[4:7], s11 offen offset:0 sc1
ds_read_b32 v143, v13 offset:768
ds_read_b32 v144, v14 offset:0
buffer_load_dwordx4 v[192:195], v4, s[4:7], s12 offen offset:0 sc1
s_waitcnt vmcnt(3)
v_cmp_gt_u32 s[14:15], s66, v147
buffer_load_dwordx4 v[200:203], v4, s[4:7], s10 offen offset:256 sc1
s_cmp_lg_u64 s[14:15], 0
s_subb_u32 s42, s66, 0
s_cmp_eq_u32 s40, 0
s_cbranch_scc1 L_skip43
s_buffer_atomic_umax s42, s[4:7], s56
L_skip43:
buffer_load_dwordx4 v[196:199], v4, s[4:7], s13 offen offset:0 sc1
s_waitcnt lgkmcnt(4)
v_lshlrev_b32 v244, 16, v140
v_and_b32 v245, 0xffff0000, v140
s_waitcnt lgkmcnt(3)
v_lshlrev_b32 v246, 16, v141
v_and_b32 v247, 0xffff0000, v141
s_waitcnt lgkmcnt(2)
v_lshlrev_b32 v248, 16, v142
buffer_load_dwordx4 v[204:207], v4, s[4:7], s11 offen offset:256 sc1
v_and_b32 v249, 0xffff0000, v142
s_waitcnt lgkmcnt(1)
v_lshlrev_b32 v250, 16, v143
v_and_b32 v251, 0xffff0000, v143
s_waitcnt lgkmcnt(0)
v_lshlrev_b32 v252, 16, v144
v_and_b32 v253, 0xffff0000, v144
buffer_load_dwordx4 v[208:211], v4, s[4:7], s12 offen offset:256 sc1
buffer_load_dwordx4 v[212:215], v4, s[4:7], s13 offen offset:256 sc1
buffer_load_dwordx4 v[216:219], v4, s[4:7], s10 offen offset:512 sc1
buffer_load_dwordx4 v[220:223], v4, s[4:7], s11 offen offset:512 sc1
s_waitcnt vmcnt(9)
v_mfma_f32_16x16x32_bf16 v[224:227], v[124:127], v[184:187], v[128:131]
buffer_load_dwordx4 v[184:187], v4, s[4:7], s12 offen offset:512 sc1
s_waitcnt vmcnt(9)
v_mfma_f32_16x16x32_bf16 v[224:227], v[124:127], v[188:191], v[224:227]
buffer_load_dwordx4 v[188:191], v4, s[4:7], s13 offen offset:512 sc1
s_waitcnt vmcnt(9)
v_mfma_f32_16x16x32_bf16 v[224:227], v[124:127], v[192:195], v[224:227]
buffer_load_dwordx4 v[192:195], v4, s[4:7], s10 offen offset:768 sc1
s_waitcnt vmcnt(9)
v_mfma_f32_16x16x32_bf16 v[228:231], v[124:127], v[200:203], v[130:133]
buffer_load_dwordx4 v[200:203], v4, s[4:7], s12 offen offset:768 sc1
s_waitcnt vmcnt(9)
v_mfma_f32_16x16x32_bf16 v[224:227], v[124:127], v[196:199], v[224:227]
buffer_load_dwordx4 v[196:199], v4, s[4:7], s11 offen offset:768 sc1
s_nop 6
v_mov_b32_dpp v226, v224 quad_perm:[1,0,3,2] row_mask:0xf bank_mask:0xf
s_waitcnt vmcnt(9)
v_mfma_f32_16x16x32_bf16 v[228:231], v[124:127], v[204:207], v[228:231]
buffer_load_dwordx4 v[204:207], v4, s[4:7], s13 offen offset:768 sc1
v_mov_b32_dpp v227, v225 quad_perm:[1,0,3,2] row_mask:0xf bank_mask:0xf
v_cndmask_b32 v225, v226, v225, s[8:9]
v_cndmask_b32 v224, v224, v227, s[8:9]
v_add_f32 v245, v245, v225
v_add_f32 v244, v244, v224
s_waitcnt vmcnt(9)
v_mfma_f32_16x16x32_bf16 v[228:231], v[124:127], v[208:211], v[228:231]
buffer_load_dwordx4 v[208:211], v12, s[4:7], s10 offen offset:1024 sc1
v_cvt_pk_bf16_f32 v226, v244, v245
v_xor_b32 v4, 1048576, v4
v_lshlrev_b32 v244, 16, v226
v_and_b32 v245, 0xffff0000, v226
v_mul_f32 v255, v244, v244
s_waitcnt vmcnt(9)
v_mfma_f32_16x16x32_bf16 v[228:231], v[124:127], v[212:215], v[228:231]
buffer_load_dwordx4 v[212:215], v12, s[4:7], s12 offen offset:1024 sc1
v_add_f32 v254, v244, v245
v_fmac_f32 v255, v245, v245
ds_write_b32 v13, v226 offset:4096
s_nop 3
v_mov_b32_dpp v230, v228 quad_perm:[1,0,3,2] row_mask:0xf bank_mask:0xf
s_waitcnt vmcnt(9)
v_mfma_f32_16x16x32_bf16 v[232:235], v[124:127], v[216:219], v[132:135]
v_mov_b32_dpp v231, v229 quad_perm:[1,0,3,2] row_mask:0xf bank_mask:0xf
v_cndmask_b32 v229, v230, v229, s[8:9]
v_cndmask_b32 v228, v228, v231, s[8:9]
v_add_f32 v247, v247, v229
v_add_f32 v246, v246, v228
v_xor_b32 v12, 1048576, v12
v_cvt_pk_bf16_f32 v230, v246, v247
s_waitcnt vmcnt(8)
v_mfma_f32_16x16x32_bf16 v[232:235], v[124:127], v[220:223], v[232:235]
v_lshlrev_b32 v246, 16, v230
v_and_b32 v247, 0xffff0000, v230
v_add_f32 v254, v254, v246
v_fmac_f32 v255, v246, v246
v_add_f32 v254, v254, v247
v_fmac_f32 v255, v247, v247
ds_write_b32 v13, v230 offset:4352
s_waitcnt vmcnt(7)
v_mfma_f32_16x16x32_bf16 v[232:235], v[124:127], v[184:187], v[232:235]
s_waitcnt vmcnt(6)
v_mfma_f32_16x16x32_bf16 v[232:235], v[124:127], v[188:191], v[232:235]
s_nop 7
v_mov_b32_dpp v234, v232 quad_perm:[1,0,3,2] row_mask:0xf bank_mask:0xf
s_waitcnt vmcnt(5)
v_mfma_f32_16x16x32_bf16 v[236:239], v[124:127], v[192:195], v[134:137]
v_mov_b32_dpp v235, v233 quad_perm:[1,0,3,2] row_mask:0xf bank_mask:0xf
v_cndmask_b32 v233, v234, v233, s[8:9]
v_cndmask_b32 v232, v232, v235, s[8:9]
v_add_f32 v249, v249, v233
v_add_f32 v248, v248, v232
v_cvt_pk_bf16_f32 v234, v248, v249
v_lshlrev_b32 v248, 16, v234
v_and_b32 v249, 0xffff0000, v234
v_add_f32 v254, v254, v248
v_fmac_f32 v255, v248, v248
v_add_f32 v254, v254, v249
v_fmac_f32 v255, v249, v249
ds_write_b32 v13, v234 offset:4608
s_waitcnt vmcnt(3)
v_mfma_f32_16x16x32_bf16 v[236:239], v[124:127], v[196:199], v[236:239]
v_mfma_f32_16x16x32_bf16 v[236:239], v[124:127], v[200:203], v[236:239]
s_waitcnt vmcnt(2)
v_mfma_f32_16x16x32_bf16 v[236:239], v[124:127], v[204:207], v[236:239]
s_nop 7
v_mov_b32_dpp v238, v236 quad_perm:[1,0,3,2] row_mask:0xf bank_mask:0xf
s_waitcnt vmcnt(1)
v_mfma_f32_16x16x32_bf16 v[240:243], v[124:127], v[208:211], v[136:139]
v_mov_b32_dpp v239, v237 quad_perm:[1,0,3,2] row_mask:0xf bank_mask:0xf
v_cndmask_b32 v237, v238, v237, s[8:9]
v_cndmask_b32 v236, v236, v239, s[8:9]
v_add_f32 v251, v251, v237
v_add_f32 v250, v250, v236
v_cvt_pk_bf16_f32 v238, v250, v251
s_waitcnt vmcnt(0)
v_mfma_f32_16x16x32_bf16 v[240:243], v[124:127], v[212:215], v[240:243]
v_lshlrev_b32 v250, 16, v238
v_and_b32 v251, 0xffff0000, v238
v_add_f32 v254, v254, v250
v_fmac_f32 v255, v250, v250
v_add_f32 v254, v254, v251
v_fmac_f32 v255, v251, v251
s_nop 1
v_add_f32_dpp v240, v240, v240 row_ror:8 row_mask:0xf bank_mask:0xf
v_add_f32_dpp v241, v241, v241 row_ror:8 row_mask:0xf bank_mask:0xf
v_add_f32 v252, v252, v240
v_add_f32 v253, v253, v241
ds_write_b32 v13, v238 offset:4864
v_cvt_pk_bf16_f32 v242, v252, v253
v_lshlrev_b32 v252, 16, v242
v_and_b32 v253, 0xffff0000, v242
v_mul_f32 v241, v252, v252
v_add_f32 v240, v252, v253
v_fmac_f32 v241, v253, v253
v_fmac_f32 v254, 0.5, v240
v_fmac_f32 v255, 0.5, v241
ds_write_b32 v14, v242 offset:4096
v_add_f32_dpp v254, v254, v254 row_ror:8 row_mask:0xf bank_mask:0xf
v_add_f32_dpp v255, v255, v255 row_ror:8 row_mask:0xf bank_mask:0xf
s_nop 0
v_add_f32_dpp v254, v254, v254 row_ror:4 row_mask:0xf bank_mask:0xf
v_add_f32_dpp v255, v255, v255 row_ror:4 row_mask:0xf bank_mask:0xf
s_nop 0
v_add_f32_dpp v254, v254, v254 row_ror:2 row_mask:0xf bank_mask:0xf
v_add_f32_dpp v255, v255, v255 row_ror:2 row_mask:0xf bank_mask:0xf
s_nop 0
v_add_f32_dpp v254, v254, v254 row_ror:1 row_mask:0xf bank_mask:0xf
v_add_f32_dpp v255, v255, v255 row_ror:1 row_mask:0xf bank_mask:0xf
v_mov_b32 v231, v254
v_mov_b32 v227, v255
s_nop 0
v_permlane16_swap_b32 v254, v231
v_permlane16_swap_b32 v255, v227
v_add_f32 v254, v254, v231
v_add_f32 v255, v255, v227
v_mov_b32 v231, v254
v_mov_b32 v227, v255
s_nop 0
v_permlane32_swap_b32 v254, v231
v_permlane32_swap_b32 v255, v227
v_add_f32 v254, v254, v231
v_add_f32 v255, v255, v227
v_mul_f32 v254, 0x3ae38e39, v254
v_mul_f32 v255, 0x3ae38e39, v255
v_fma_f32 v255, -v254, v254, v255
v_max_f32 v255, 0, v255
v_cvt_pk_bf16_f32 v254, v254, v255
v_and_b32 v255, 0xffff0000, v254
v_lshlrev_b32 v254, 16, v254
v_add_f32 v255, 0x3727c5ac, v255
v_sub_f32 v244, v244, v254
v_cvt_pk_bf16_f32 v255, v255, v255
v_sub_f32 v245, v245, v254
v_and_b32 v255, 0xffff0000, v255
v_sub_f32 v246, v246, v254
v_sqrt_f32 v255, v255
v_sub_f32 v247, v247, v254
v_cvt_pk_bf16_f32 v255, v255, v255
v_sub_f32 v248, v248, v254
v_and_b32 v255, 0xffff0000, v255
v_sub_f32 v249, v249, v254
v_rcp_f32 v255, v255
v_sub_f32 v250, v250, v254
v_sub_f32 v251, v251, v254
v_sub_f32 v252, v252, v254
v_mul_f32 v244, v244, v255
v_mul_f32 v245, v245, v255
v_mul_f32 v246, v246, v255
v_cvt_pk_bf16_f32 v224, v244, v245
v_mul_f32 v247, v247, v255
ds_write_b32 v13, v224 offset:2048
v_mul_f32 v248, v248, v255
v_cvt_pk_bf16_f32 v228, v246, v247
v_mul_f32 v249, v249, v255
ds_write_b32 v13, v228 offset:2304
v_mul_f32 v250, v250, v255
v_cvt_pk_bf16_f32 v232, v248, v249
v_mul_f32 v251, v251, v255
ds_write_b32 v13, v232 offset:2560
v_sub_f32 v253, v253, v254
v_cvt_pk_bf16_f32 v236, v250, v251
v_mul_f32 v252, v252, v255
ds_write_b32 v13, v236 offset:2816
v_mul_f32 v253, v253, v255
v_add_u32 v254, s47, v1
v_cvt_pk_bf16_f32 v240, v252, v253
ds_write_b32 v14, v240 offset:2048
ds_read_b128 v[224:227], v254 offset:2048
ds_read_b128 v[228:231], v254 offset:3072
ds_read_b128 v[232:235], v254 offset:4096
ds_read_b128 v[236:239], v254 offset:5120
s_add_u32 s38, s38, 1
s_add_u32 s65, s65, 1
s_add_u32 s66, s66, 1
s_waitcnt lgkmcnt(3)
buffer_store_dwordx4 v[224:227], v1, s[4:7], s96 offen sc1
s_waitcnt lgkmcnt(2)
buffer_store_dwordx4 v[228:231], v15, s[4:7], s96 offen sc1
s_waitcnt lgkmcnt(1)
buffer_store_dwordx4 v[232:235], v1, s[16:19], s95 offen sc1
s_waitcnt lgkmcnt(0)
buffer_store_dwordx4 v[236:239], v15, s[16:19], s95 offen sc1
v_mov_b32 v146, s66
s_waitcnt vmcnt(0)
s_cmp_eq_u32 s36, 0
s_cbranch_scc1 L_slow44
L_ret44:
buffer_store_dword v146, v7, s[4:7], s55 offen offset:2048
buffer_load_dword v147, v0, s[4:7], s41 offen sc1
s_and_b32 s42, s66, s40
s_waitcnt vmcnt(0)
v_cmp_gt_u32 vcc, s42, v147
s_nop 0
s_cbranch_vccnz L_slow45
L_ret45:
s_cmp_eq_u32 s40, 0
s_cbranch_scc1 L_skip46
s_buffer_atomic_umax s42, s[4:7], s56
L_skip46:
s_endpgm
L_slow22:
L_oom_w1:
buffer_load_dword v9, v8, s[4:7], s53 offen sc1
s_waitcnt vmcnt(0)
v_cmp_gt_u32 vcc, s38, v9
s_nop 0
s_cbranch_vccz L_oom_wd2
s_sleep 1
s_sub_u32 s37, s37, 1
s_cbranch_scc0 L_oom_w1
s_movk_i32 s39, 82
s_branch L_bail
L_oom_wd2:
s_mov_b32 m0, s51
s_nop 0
buffer_load_dwordx4 v1, s[4:7], s48 offen offset:0 sc1 lds
s_mov_b32 m0, s51
s_nop 0
buffer_load_dwordx4 v1, s[4:7], s48 offen offset:1024 sc1 lds
s_mov_b32 m0, s51
s_nop 0
buffer_load_dwordx4 v1, s[4:7], s48 offen offset:2048 sc1 lds
s_mov_b32 m0, s51
s_nop 0
buffer_load_dwordx4 v1, s[4:7], s48 offen offset:3072 sc1 lds
s_add_u32 s44, s48, s49
s_add_u32 m0, s51, s49
s_nop 0
buffer_load_dwordx4 v1, s[4:7], s44 offen sc1 lds
s_waitcnt vmcnt(0)
s_branch L_ret22
L_slow23:
s_waitcnt vmcnt(0)
v_mov_b32 v11, s65
buffer_store_dword v11, v7, s[4:7], s55 offen
L_oom_w4:
buffer_load_dword v9, v8, s[4:7], s53 offen sc1
s_waitcnt vmcnt(0)
v_cmp_gt_u32 vcc, s38, v9
s_nop 0
s_cbranch_vccz L_oom_wd5
s_sleep 1
s_sub_u32 s37, s37, 1
s_cbranch_scc0 L_oom_w4
s_movk_i32 s39, 82
s_branch L_bail
L_oom_wd5:
s_mov_b32 m0, s51
s_nop 0
buffer_load_dwordx4 v1, s[4:7], s48 offen offset:0 sc1 lds
s_mov_b32 m0, s51
s_nop 0
buffer_load_dwordx4 v1, s[4:7], s48 offen offset:1024 sc1 lds
s_mov_b32 m0, s51
s_nop 0
buffer_load_dwordx4 v1, s[4:7], s48 offen offset:2048 sc1 lds
s_mov_b32 m0, s51
s_nop 0
buffer_load_dwordx4 v1, s[4:7], s48 offen offset:3072 sc1 lds
s_add_u32 s44, s48, s49
s_add_u32 m0, s51, s49
s_nop 0
buffer_load_dwordx4 v1, s[4:7], s44 offen sc1 lds
s_waitcnt vmcnt(0)
s_branch L_ret23
L_slow24:
s_waitcnt vmcnt(0)
buffer_wbl2 sc1
s_waitcnt vmcnt(0)
buffer_store_dword v11, v6, s[4:7], s55 offen sc1
s_branch L_ret24
L_slow25:
L_oom_poll7:
buffer_load_dword v10, v5, s[4:7], s54 offen sc1
s_waitcnt vmcnt(0)
v_cmp_gt_u32 vcc, s65, v10
s_nop 0
s_cbranch_vccz L_oom_pd8
s_sleep 1
s_sub_u32 s37, s37, 1
s_cbranch_scc0 L_oom_poll7
s_movk_i32 s39, 52
s_branch L_bail
L_oom_pd8:
s_branch L_ret25
L_slow26:
s_waitcnt vmcnt(0)
v_mov_b32 v11, s65
buffer_store_dword v11, v7, s[4:7], s55 offen
L_oom_w9:
buffer_load_dword v9, v8, s[4:7], s53 offen sc1
s_waitcnt vmcnt(0)
v_cmp_gt_u32 vcc, s38, v9
s_nop 0
s_cbranch_vccz L_oom_wd10
s_sleep 1
s_sub_u32 s37, s37, 1
s_cbranch_scc0 L_oom_w9
s_movk_i32 s39, 82
s_branch L_bail
L_oom_wd10:
s_mov_b32 m0, s51
s_nop 0
buffer_load_dwordx4 v1, s[4:7], s48 offen offset:0 sc1 lds
s_mov_b32 m0, s51
s_nop 0
buffer_load_dwordx4 v1, s[4:7], s48 offen offset:1024 sc1 lds
s_mov_b32 m0, s51
s_nop 0
buffer_load_dwordx4 v1, s[4:7], s48 offen offset:2048 sc1 lds
s_mov_b32 m0, s51
s_nop 0
buffer_load_dwordx4 v1, s[4:7], s48 offen offset:3072 sc1 lds
s_add_u32 s44, s48, s49
s_add_u32 m0, s51, s49
s_nop 0
buffer_load_dwordx4 v1, s[4:7], s44 offen sc1 lds
s_waitcnt vmcnt(0)
s_branch L_ret26
L_slow27:
s_waitcnt vmcnt(0)
buffer_wbl2 sc1
s_waitcnt vmcnt(0)
buffer_store_dword v11, v6, s[4:7], s55 offen sc1
s_branch L_ret27
L_slow28:
L_oom_poll12:
buffer_load_dword v10, v5, s[4:7], s54 offen sc1
s_waitcnt vmcnt(0)
v_cmp_gt_u32 vcc, s65, v10
s_nop 0
s_cbranch_vccz L_oom_pd13
s_sleep 1
s_sub_u32 s37, s37, 1
s_cbranch_scc0 L_oom_poll12
s_movk_i32 s39, 52
s_branch L_bail
L_oom_pd13:
s_branch L_ret28
L_slow29:
s_waitcnt vmcnt(0)
buffer_wbl2 sc1
s_waitcnt vmcnt(0)
buffer_store_dword v11, v6, s[4:7], s55 offen sc1
s_branch L_ret29
L_slow30:
L_oom_poll14:
buffer_load_dword v10, v5, s[4:7], s54 offen sc1
s_waitcnt vmcnt(0)
v_cmp_gt_u32 vcc, s65, v10
s_nop 0
s_cbranch_vccz L_oom_pd15
s_sleep 1
s_sub_u32 s37, s37, 1
s_cbranch_scc0 L_oom_poll14
s_movk_i32 s39, 52
s_branch L_bail
L_oom_pd15:
s_branch L_ret30
L_slow31:
L_oom_w16:
buffer_load_dword v9, v8, s[4:7], s53 offen sc1
s_waitcnt vmcnt(0)
v_cmp_gt_u32 vcc, s38, v9
s_nop 0
s_cbranch_vccz L_oom_wd17
s_sleep 1
s_sub_u32 s37, s37, 1
s_cbranch_scc0 L_oom_w16
s_movk_i32 s39, 82
s_branch L_bail
L_oom_wd17:
s_mov_b32 m0, s51
s_nop 0
buffer_load_dwordx4 v1, s[4:7], s48 offen offset:0 sc1 lds
s_mov_b32 m0, s51
s_nop 0
buffer_load_dwordx4 v1, s[4:7], s48 offen offset:1024 sc1 lds
s_mov_b32 m0, s51
s_nop 0
buffer_load_dwordx4 v1, s[4:7], s48 offen offset:2048 sc1 lds
s_mov_b32 m0, s51
s_nop 0
buffer_load_dwordx4 v1, s[4:7], s48 offen offset:3072 sc1 lds
s_waitcnt vmcnt(0)
s_branch L_ret31
L_slow32:
s_waitcnt vmcnt(0)
v_mov_b32 v11, s65
buffer_store_dword v11, v7, s[4:7], s55 offen
L_oom_w19:
buffer_load_dword v9, v8, s[4:7], s53 offen sc1
s_waitcnt vmcnt(0)
v_cmp_gt_u32 vcc, s38, v9
s_nop 0
s_cbranch_vccz L_oom_wd20
s_sleep 1
s_sub_u32 s37, s37, 1
s_cbranch_scc0 L_oom_w19
s_movk_i32 s39, 82
s_branch L_bail
L_oom_wd20:
s_mov_b32 m0, s51
s_nop 0
buffer_load_dwordx4 v1, s[4:7], s48 offen offset:0 sc1 lds
s_mov_b32 m0, s51
s_nop 0
buffer_load_dwordx4 v1, s[4:7], s48 offen offset:1024 sc1 lds
s_mov_b32 m0, s51
s_nop 0
buffer_load_dwordx4 v1, s[4:7], s48 offen offset:2048 sc1 lds
s_mov_b32 m0, s51
s_nop 0
buffer_load_dwordx4 v1, s[4:7], s48 offen offset:3072 sc1 lds
s_waitcnt vmcnt(0)
s_branch L_ret32
L_slow33:
s_waitcnt vmcnt(0)
buffer_wbl2 sc1
s_waitcnt vmcnt(0)
buffer_store_dword v11, v6, s[4:7], s55 offen sc1
s_branch L_ret33
L_slow34:
L_oom_poll22:
buffer_load_dword v10, v5, s[4:7], s54 offen sc1
s_waitcnt vmcnt(0)
v_cmp_gt_u32 vcc, s65, v10
s_nop 0
s_cbranch_vccz L_oom_pd23
s_sleep 1
s_sub_u32 s37, s37, 1
s_cbranch_scc0 L_oom_poll22
s_movk_i32 s39, 52
s_branch L_bail
L_oom_pd23:
s_branch L_ret34
L_slow35:
s_waitcnt lgkmcnt(0)
buffer_store_dwordx4 v[224:227], v1, s[4:7], s96 offen sc1
buffer_store_dwordx4 v[228:231], v15, s[4:7], s96 offen sc1
buffer_store_dwordx4 v[232:235], v1, s[16:19], s95 offen sc1
buffer_store_dwordx4 v[236:239], v15, s[16:19], s95 offen sc1
s_waitcnt vmcnt(4)
v_mov_b32 v11, s65
buffer_store_dword v11, v7, s[4:7], s55 offen
s_waitcnt vmcnt(0)
v_mov_b32 v11, s66
buffer_store_dword v11, v7, s[4:7], s55 offen offset:2048
s_mov_b32 s43, s40
L_oom_w24:
buffer_load_dword v9, v8, s[4:7], s53 offen sc1
s_cmp_eq_u32 s43, 0
s_cbranch_scc1 L_oom_ws26
buffer_load_dword v147, v0, s[4:7], s41 offen sc1
s_waitcnt vmcnt(0)
v_cmp_gt_u32 vcc, s66, v147
s_nop 0
s_cbranch_vccnz L_oom_ws26
s_mov_b32 s42, s66
s_buffer_atomic_umax s42, s[4:7], s56
s_mov_b32 s43, 0
L_oom_ws26:
s_waitcnt vmcnt(0)
v_cmp_gt_u32 vcc, s38, v9
s_nop 0
s_cbranch_vccz L_oom_wd25
s_sleep 1
s_sub_u32 s37, s37, 1
s_cbranch_scc0 L_oom_w24
s_movk_i32 s39, 82
s_branch L_bail
L_oom_wd25:
s_mov_b32 m0, s51
s_nop 0
buffer_load_dwordx4 v1, s[4:7], s48 offen offset:0 sc1 lds
s_mov_b32 m0, s51
s_nop 0
buffer_load_dwordx4 v1, s[4:7], s48 offen offset:1024 sc1 lds
s_mov_b32 m0, s51
s_nop 0
buffer_load_dwordx4 v1, s[4:7], s48 offen offset:2048 sc1 lds
s_mov_b32 m0, s51
s_nop 0
buffer_load_dwordx4 v1, s[4:7], s48 offen offset:3072 sc1 lds
s_waitcnt vmcnt(0)
s_branch L_ret35
L_slow36:
s_waitcnt vmcnt(0)
buffer_wbl2 sc1
s_waitcnt vmcnt(0)
buffer_store_dword v11, v6, s[4:7], s55 offen sc1
s_branch L_ret36
L_slow37:
L_oom_poll27:
buffer_load_dword v10, v5, s[4:7], s54 offen sc1
s_waitcnt vmcnt(0)
v_cmp_gt_u32 vcc, s65, v10
s_nop 0
s_cbranch_vccz L_oom_pd28
s_sleep 1
s_sub_u32 s37, s37, 1
s_cbranch_scc0 L_oom_poll27
s_movk_i32 s39, 52
s_branch L_bail
L_oom_pd28:
s_branch L_ret37
L_slow38:
buffer_store_dword v146, v6, s[4:7], s55 offen offset:2048 sc1
s_branch L_ret38
L_slow40:
s_waitcnt vmcnt(0)
buffer_wbl2 sc1
s_waitcnt vmcnt(0)
buffer_store_dword v11, v6, s[4:7], s55 offen sc1
s_branch L_ret40
L_slow41:
L_oom_poll29:
buffer_load_dword v10, v5, s[4:7], s54 offen sc1
s_waitcnt vmcnt(0)
v_cmp_gt_u32 vcc, s65, v10
s_nop 0
s_cbranch_vccz L_oom_pd30
s_sleep 1
s_sub_u32 s37, s37, 1
s_cbranch_scc0 L_oom_poll29
s_movk_i32 s39, 52
s_branch L_bail
L_oom_pd30:
s_branch L_ret41
L_slow42:
buffer_store_dword v146, v6, s[4:7], s55 offen offset:2048 sc1
s_branch L_ret42
L_slow44:
buffer_store_dword v146, v6, s[4:7], s55 offen offset:2048 sc1
s_branch L_ret44
L_slow45:
L_oom_poll31:
buffer_load_dword v147, v0, s[4:7], s41 offen sc1
s_waitcnt vmcnt(0)
v_cmp_gt_u32 vcc, s42, v147
s_nop 0
s_cbranch_vccz L_oom_pd32
s_sleep 1
s_sub_u32 s37, s37, 1
s_cbranch_scc0 L_oom_poll31
s_movk_i32 s39, 55
s_branch L_bail
L_oom_pd32:
s_branch L_ret45
L_ML_end:
.section .rodata,"a"
.p2align 6
.amdhsa_kernel interleave_layers__memory_aug_recurrent_mem_tr__dense_activation_gelu__prompt_kernel
  .amdhsa_next_free_vgpr 512
  .amdhsa_next_free_sgpr 102
  .amdhsa_accum_offset 256
  .amdhsa_group_segment_fixed_size 0
  .amdhsa_kernarg_size 120
  .amdhsa_user_sgpr_count 2
  .amdhsa_user_sgpr_kernarg_segment_ptr 1
  .amdhsa_system_sgpr_workgroup_id_x 1
  .amdhsa_float_denorm_mode_32 3
.end_amdhsa_kernel
```
